```python
import torch

def _softmax(x, axis=-1):
    return torch.softmax(x, dim=axis)
def _gelu(x):
    return torch.nn.functional.gelu(x, approximate="tanh")
def _silu(x):
    return torch.nn.functional.silu(x)
def _sigmoid(x):
    return torch.sigmoid(x)
def _layernorm(x, axis=-1, eps=1e-5):
    m = x.mean(dim=axis, keepdim=True)
    v = x.var(dim=axis, keepdim=True, unbiased=False)
    return (x - m) / torch.sqrt(v + eps)
def _scatter_add(tgt, idx, src, axis=0):
    return tgt.clone().index_add_(axis, idx, src)
def _segment_sum(src, seg, n):
    out = torch.zeros((n,) + src.shape[1:], dtype=src.dtype)
    return out.index_add_(0, seg, src)
def _pad(x, pw):
    flat = tuple(v for pair in reversed(pw) for v in pair)
    return torch.nn.functional.pad(x, flat)

kernel_name = 'sequential_preLN__mha_block__mixer_channel_mlp__prompt'

def setup_inputs():

    _w = (lambda a: (lambda t: t.to(torch.bfloat16) if t.is_floating_point() else t)(torch.as_tensor(a)))
    def _A_setup():
        B, S, D, H = 1, 2048, 1024, 32
        return {
            "x": _w((lambda *s: torch.randn(*s, dtype=torch.bfloat16) * 0.05)(B, S, D)),
            "wqkv": _w((lambda *s: torch.randn(*s, dtype=torch.bfloat16) * 0.05)(D, 3 * D)),
            "wo": _w((lambda *s: torch.randn(*s, dtype=torch.bfloat16) * 0.05)(D, D)),
        }
    _A_in = _A_setup()

    def _B_setup():
        B, S, D, F = 1, 2048, 1024, 3584
        return {
            "x": _w((lambda *s: torch.randn(*s, dtype=torch.bfloat16) * 0.05)(B, S, D)),
            "w1": _w((lambda *s: torch.randn(*s, dtype=torch.bfloat16) * 3.2)(D, F) * (D ** -0.5)),
            "b1": _w((lambda *s: torch.randn(*s, dtype=torch.bfloat16) * 1.6)(F)),
            "w2": _w((lambda *s: torch.randn(*s, dtype=torch.bfloat16) * 0.8)(F, D) * (F ** -0.5)),
            "b2": _w((lambda *s: torch.randn(*s, dtype=torch.bfloat16) * 1.6)(D)),
        }
    _B_in = _B_setup()

    return {
        "A_x": _A_in["x"],
        "A_wqkv": _A_in["wqkv"],
        "A_wo": _A_in["wo"],
        "B_x": _B_in["x"],
        "B_w1": _B_in["w1"],
        "B_b1": _B_in["b1"],
        "B_w2": _B_in["w2"],
        "B_b2": _B_in["b2"],
    }

def reference(A_x, A_wqkv, A_wo, B_x, B_w1, B_b1, B_w2, B_b2):
    def _A_ref(x, wqkv, wo):
        B, S, D = x.shape
        H = 32
        Dh = D // H
        qkv = (lambda x, *d: x.permute(*d))((x @ wqkv).reshape(B, S, 3, H, Dh), 2, 0, 3, 1, 4)
        q, k, v = qkv[0], qkv[1], qkv[2]
        scores = torch.einsum("bhqd,bhkd->bhqk", q, k) * (Dh ** -0.5)
        p = _softmax(scores, axis=-1)
        o = torch.einsum("bhqk,bhkd->bhqd", p, v)
        return (lambda x, *d: x.permute(*d))(o, 0, 2, 1, 3).reshape(B, S, D) @ wo

    def _B_ref(x, w1, b1, w2, b2):
        y = _layernorm(x, axis=-1)
        h = _gelu(torch.einsum("bsd,df->bsf", y, w1) + b1)
        return torch.einsum("bsf,fd->bsd", h, w2) + b2

    x = A_x
    h = x + _A_ref(_layernorm(x, axis=-1), A_wqkv, A_wo)
    h2 = h + _B_ref(_layernorm(h, axis=-1), B_w1, B_b1, B_w2, B_b2)
    return h2
```

```asm
; @launch kernel=qkv_kernel grid=(256,1,1) block=(512,1,1) lds=126976
; @launch kernel=attn_kernel grid=(256,1,1) block=(512,1,1) lds=157696
.amdgcn_target "amdgcn-amd-amdhsa--gfx950"
.text
.globl qkv_kernel
.p2align 8
.type qkv_kernel,@function
qkv_kernel:
    s_cmp_ge_u32 s2, 256
    s_cbranch_scc1 qkv_kernel_end
    s_load_dwordx2 s[8:9], s[0:1], 0
    s_load_dwordx2 s[12:13], s[0:1], 8
    s_load_dwordx2 s[16:17], s[0:1], 80
    s_load_dwordx2 s[44:45], s[0:1], 72
    v_lshrrev_b32 v2, 6, v0
    v_and_b32 v1, 63, v0
    v_readfirstlane_b32 s3, v2
    s_and_b32 s34, s2, 7
    s_lshr_b32 s35, s2, 3
    s_and_b32 s28, s34, 1
    s_lshl_b32 s28, s28, 3
    s_and_b32 s36, s35, 7
    s_add_u32 s28, s28, s36
    s_lshr_b32 s29, s34, 1
    s_mul_i32 s29, s29, 4
    s_lshr_b32 s36, s35, 3
    s_add_u32 s29, s29, s36
    s_mov_b32 s10, 4194304
    s_mov_b32 s11, 0x20000
    s_mov_b32 s14, 6291456
    s_mov_b32 s15, 0x20000
    s_mov_b32 s18, 268435456
    s_mov_b32 s19, 0x20000
    s_mov_b32 s46, 256
    s_mov_b32 s47, 0x20000
    s_cmp_lt_u32 s3, 4
    s_cbranch_scc1 qkv_kernel_cons
    s_sub_u32 s37, s3, 4
    v_lshrrev_b32 v2, 3, v1
    s_lshl_b32 s35, s28, 7
    s_lshl_b32 s36, s37, 5
    s_add_u32 s35, s35, s36
    v_add_u32 v2, s35, v2
    v_lshlrev_b32 v2, 11, v2
    v_lshrrev_b32 v3, 4, v1
    v_and_b32 v4, 7, v1
    v_xor_b32 v3, v3, v4
    v_lshl_add_u32 v4, v3, 4, v2
    v_xor_b32 v5, 64, v4
    v_add_u32 v5, 16384, v5
    v_add_u32 v6, 32768, v4
    v_add_u32 v7, 32768, v5
    s_lshl_b32 s38, s37, 12
    s_mov_b32 s32, 0
    v_lshrrev_b32 v2, 3, v1
    s_lshl_b32 s35, s37, 4
    v_add_u32 v2, s35, v2
    v_mul_u32_u24 v2, 6144, v2
    v_lshrrev_b32 v3, 3, v1
    v_and_b32 v3, 2, v3
    v_and_b32 v8, 7, v1
    v_xor_b32 v3, v3, v8
    v_lshl_add_u32 v2, v3, 4, v2
    v_xor_b32 v3, 64, v2
    v_add_u32 v3, 49152, v3
    s_add_u32 s48, s29, 0
    s_and_b32 s48, s48, 15
    s_lshl_b32 s35, s48, 7
    s_add_u32 s35, s35, 0
    v_add_u32 v8, s35, v2
    v_add_u32 v9, s35, v3
    s_add_u32 s49, s29, 3
    s_and_b32 s49, s49, 15
    s_lshl_b32 s35, s49, 7
    s_add_u32 s35, s35, 2048
    v_add_u32 v10, s35, v2
    v_add_u32 v11, s35, v3
    s_add_u32 s50, s29, 6
    s_and_b32 s50, s50, 15
    s_lshl_b32 s35, s50, 7
    s_add_u32 s35, s35, 4096
    v_add_u32 v12, s35, v2
    v_add_u32 v13, s35, v3
    s_lshl_b32 s39, s37, 11
    s_add_u32 s39, s39, 16384
    s_mov_b32 s33, 0
    s_mov_b32 s31, 0
    s_mov_b32 s52, 0
    s_waitcnt lgkmcnt(0)
    s_call_b64 s[82:83], qkv_kernel_issue
    s_call_b64 s[82:83], qkv_kernel_issue
    s_waitcnt vmcnt(10)
    s_barrier
    s_call_b64 s[82:83], qkv_kernel_issue
    s_waitcnt vmcnt(10)
    s_barrier
    s_call_b64 s[82:83], qkv_kernel_issue
    s_waitcnt vmcnt(10)
    s_barrier
    s_call_b64 s[82:83], qkv_kernel_issue
    s_waitcnt vmcnt(10)
    s_barrier
    s_call_b64 s[82:83], qkv_kernel_issue
    s_waitcnt vmcnt(10)
    s_barrier
    s_call_b64 s[82:83], qkv_kernel_issue
    s_waitcnt vmcnt(10)
    s_barrier
    s_call_b64 s[82:83], qkv_kernel_issue
    s_waitcnt vmcnt(10)
    s_barrier
    s_call_b64 s[82:83], qkv_kernel_issue
    v_mov_b32 v32, -1
    v_mov_b32 v36, 0
    v_mov_b32 v33, -1
    v_mov_b32 v37, 0
    v_mov_b32 v34, -1
    v_mov_b32 v38, 0
    v_mov_b32 v35, -1
    v_mov_b32 v39, 0
    v_lshlrev_b32 v40, 4, v1
    s_lshl_b32 s84, s2, 2
    s_add_u32 s84, s84, s37
    s_min_u32 s85, s84, 4
    s_lshl_b32 s85, s85, 10
    s_add_u32 s85, s85, 39976960
    s_lshl_b32 s86, s84, 7
    s_add_u32 s86, s86, 39845888
    v_and_b32 v41, 3, v1
    v_lshlrev_b32 v41, 5, v41
    s_lshl_b32 s84, s84, 12
    s_add_u32 s84, s84, 67108864
    buffer_store_dwordx4 v[32:35], v40, s[16:19], s84 offen offset:0 sc1
    s_waitcnt vmcnt(11)
    s_barrier
    s_call_b64 s[82:83], qkv_kernel_issue
    s_waitcnt vmcnt(11)
    s_barrier
    s_call_b64 s[82:83], qkv_kernel_issue
    buffer_store_dwordx4 v[32:35], v40, s[16:19], s84 offen offset:1024 sc1
    s_waitcnt vmcnt(11)
    s_barrier
    s_call_b64 s[82:83], qkv_kernel_issue
    s_waitcnt vmcnt(11)
    s_barrier
    s_call_b64 s[82:83], qkv_kernel_issue
    buffer_store_dwordx4 v[32:35], v40, s[16:19], s84 offen offset:2048 sc1
    s_waitcnt vmcnt(11)
    s_barrier
    s_call_b64 s[82:83], qkv_kernel_issue
    s_waitcnt vmcnt(11)
    s_barrier
    s_call_b64 s[82:83], qkv_kernel_issue
    buffer_store_dwordx4 v[32:35], v40, s[16:19], s84 offen offset:3072 sc1
    buffer_store_dword v36, v41, s[16:19], s86 offen sc1
    s_cmp_lt_u32 s2, 2
    s_cbranch_scc1 qkv_kernel_cf
    buffer_store_dwordx4 v[32:35], v40, s[16:19], s84 offen sc1
    s_branch qkv_kernel_cg
qkv_kernel_cf:
    buffer_store_dwordx4 v[36:39], v40, s[16:19], s85 offen sc1
qkv_kernel_cg:
    s_waitcnt vmcnt(13)
    s_barrier
    s_call_b64 s[82:83], qkv_kernel_issue
    s_waitcnt vmcnt(13)
    s_barrier
    s_waitcnt vmcnt(0)
    s_barrier
    s_waitcnt vmcnt(0)
    s_barrier
    v_lshlrev_b32 v12, 7, v1
    s_getpc_b64 s[90:91]
qkv_kernel_cp1:
    s_add_u32 s90, s90, attn_kernel-qkv_kernel_cp1
    s_addc_u32 s91, s91, 0
    global_load_dword v13, v12, s[90:91]
    s_add_u32 s90, s90, 8192
    s_addc_u32 s91, s91, 0
    global_load_dword v13, v12, s[90:91]
    s_add_u32 s90, s90, 8192
    s_addc_u32 s91, s91, 0
    global_load_dword v13, v12, s[90:91]
    s_add_u32 s90, s90, 8192
    s_addc_u32 s91, s91, 0
    v_min_u32 v12, text_end-attn_kernel-24580, v12
    global_load_dword v13, v12, s[90:91]
    s_endpgm
qkv_kernel_issue:
    s_add_u32 s40, s31, s38
    s_add_u32 s41, s31, s39
    s_add_u32 m0, s40, 0
    s_nop 0
    buffer_load_dwordx4 v4, s[8:11], s32 offen  lds
    s_add_u32 m0, s40, 1024
    s_nop 0
    buffer_load_dwordx4 v5, s[8:11], s32 offen  lds
    s_add_u32 m0, s40, 2048
    s_nop 0
    buffer_load_dwordx4 v6, s[8:11], s32 offen  lds
    s_add_u32 m0, s40, 3072
    s_nop 0
    buffer_load_dwordx4 v7, s[8:11], s32 offen  lds
    s_add_u32 m0, s41, 0
    s_nop 0
    buffer_load_dwordx4 v8, s[12:15], s33 offen  lds
    s_add_u32 m0, s41, 1024
    s_nop 0
    buffer_load_dwordx4 v9, s[12:15], s33 offen  lds
    s_add_u32 m0, s41, 8192
    s_nop 0
    buffer_load_dwordx4 v10, s[12:15], s33 offen  lds
    s_add_u32 m0, s41, 9216
    s_nop 0
    buffer_load_dwordx4 v11, s[12:15], s33 offen  lds
    s_add_u32 m0, s41, 16384
    s_nop 0
    buffer_load_dwordx4 v12, s[12:15], s33 offen  lds
    s_add_u32 m0, s41, 17408
    s_nop 0
    buffer_load_dwordx4 v13, s[12:15], s33 offen  lds
    s_add_u32 s32, s32, 128
    s_add_u32 s33, s33, 393216
    s_add_u32 s31, s31, 40960
    s_cmp_eq_u32 s31, 122880
    s_cselect_b32 s31, 0, s31
    s_setpc_b64 s[82:83]
qkv_kernel_end:
    s_endpgm
qkv_kernel_cons:
    s_lshr_b32 s38, s3, 1
    s_and_b32 s39, s3, 1
    v_lshrrev_b32 v14, 4, v1
    v_and_b32 v15, 15, v1
    s_lshl_b32 s34, s38, 13
    v_lshl_add_u32 v200, v15, 7, s34
    v_lshrrev_b32 v201, 1, v15
    v_xor_b32 v2, v14, v201
    v_lshl_add_u32 v2, v2, 4, v200
    v_xor_b32 v3, 64, v2
    v_lshrrev_b32 v200, 2, v1
    v_and_b32 v200, 3, v200
    v_lshl_add_u32 v201, v14, 3, v200
    v_mul_u32_u24 v6, 128, v201
    v_and_b32 v201, 3, v1
    v_lshl_add_u32 v6, v201, 3, v6
    v_and_b32 v201, 1, v14
    v_lshrrev_b32 v200, 1, v200
    v_lshl_add_u32 v200, v201, 1, v200
    s_lshl_b32 s34, s39, 1
    v_xor_b32 v200, s34, v200
    v_lshl_add_u32 v6, v200, 5, v6
    v_add_u32 v6, 16384, v6
    v_xor_b32 v7, 32, v6
    s_waitcnt lgkmcnt(0)
    v_and_b32 v200, 7, v1
    s_lshl_b32 s34, s2, 3
    v_add_u32 v200, s34, v200
    v_lshlrev_b32 v200, 11, v200
    v_bfe_u32 v201, v1, 3, 2
    v_lshl_add_u32 v200, v201, 7, v200
    v_lshrrev_b32 v201, 5, v1
    v_lshl_add_u32 v12, v201, 6, v200
    s_mul_i32 s34, s2, 6144
    v_min_u32 v13, 47, v1
    v_lshl_add_u32 v13, v13, 7, s34
    s_mov_b32 s92, 256
    s_mov_b32 s93, 786432
    s_mul_i32 s94, s2, 49152
    v_lshlrev_b32 v8, 7, v1
    s_cmp_lg_u32 s3, 3
    s_cbranch_scc1 qkv_kernel_nopf
    buffer_load_dword v9, v12, s[8:11], s92 offen
    buffer_load_dword v9, v13, s[12:15], s93 offen
    s_add_u32 s92, s92, 512
    s_add_u32 s93, s93, 1572864
qkv_kernel_nopf:
    s_cmp_lg_u32 s3, 3
    s_cbranch_scc1 qkv_kernel_nocp
    v_lshlrev_b32 v200, 7, v1
    s_getpc_b64 s[90:91]
qkv_kernel_cp0:
    s_sub_u32 s90, s90, qkv_kernel_cp0-qkv_kernel
    s_subb_u32 s91, s91, 0
    global_load_dword v9, v200, s[90:91]
    s_add_u32 s90, s90, 8192
    s_addc_u32 s91, s91, 0
    global_load_dword v9, v200, s[90:91]
    s_add_u32 s90, s90, 8192
    s_addc_u32 s91, s91, 0
    global_load_dword v9, v200, s[90:91]
    s_add_u32 s90, s90, 8192
    s_addc_u32 s91, s91, 0
    global_load_dword v9, v200, s[90:91]
    s_add_u32 s90, s90, 8192
    s_addc_u32 s91, s91, 0
    v_min_u32 v200, text_end-qkv_kernel-32772, v200
    global_load_dword v9, v200, s[90:91]
qkv_kernel_nocp:
    v_mov_b32 v16, 0
    v_mov_b32 v17, 0
    v_mov_b32 v18, 0
    v_mov_b32 v19, 0
    v_mov_b32 v20, 0
    v_mov_b32 v21, 0
    v_mov_b32 v22, 0
    v_mov_b32 v23, 0
    v_mov_b32 v24, 0
    v_mov_b32 v25, 0
    v_mov_b32 v26, 0
    v_mov_b32 v27, 0
    v_mov_b32 v28, 0
    v_mov_b32 v29, 0
    v_mov_b32 v30, 0
    v_mov_b32 v31, 0
    v_mov_b32 v32, 0
    v_mov_b32 v33, 0
    v_mov_b32 v34, 0
    v_mov_b32 v35, 0
    v_mov_b32 v36, 0
    v_mov_b32 v37, 0
    v_mov_b32 v38, 0
    v_mov_b32 v39, 0
    v_mov_b32 v40, 0
    v_mov_b32 v41, 0
    v_mov_b32 v42, 0
    v_mov_b32 v43, 0
    v_mov_b32 v44, 0
    v_mov_b32 v45, 0
    v_mov_b32 v46, 0
    v_mov_b32 v47, 0
    v_mov_b32 v48, 0
    v_mov_b32 v49, 0
    v_mov_b32 v50, 0
    v_mov_b32 v51, 0
    v_mov_b32 v52, 0
    v_mov_b32 v53, 0
    v_mov_b32 v54, 0
    v_mov_b32 v55, 0
    v_mov_b32 v56, 0
    v_mov_b32 v57, 0
    v_mov_b32 v58, 0
    v_mov_b32 v59, 0
    v_mov_b32 v60, 0
    v_mov_b32 v61, 0
    v_mov_b32 v62, 0
    v_mov_b32 v63, 0
    v_mov_b32 v64, 0
    v_mov_b32 v65, 0
    v_mov_b32 v66, 0
    v_mov_b32 v67, 0
    v_mov_b32 v68, 0
    v_mov_b32 v69, 0
    v_mov_b32 v70, 0
    v_mov_b32 v71, 0
    v_mov_b32 v72, 0
    v_mov_b32 v73, 0
    v_mov_b32 v74, 0
    v_mov_b32 v75, 0
    v_mov_b32 v76, 0
    v_mov_b32 v77, 0
    v_mov_b32 v78, 0
    v_mov_b32 v79, 0
    v_mov_b32 v80, 0
    v_mov_b32 v81, 0
    v_mov_b32 v82, 0
    v_mov_b32 v83, 0
    v_mov_b32 v84, 0
    v_mov_b32 v85, 0
    v_mov_b32 v86, 0
    v_mov_b32 v87, 0
    v_mov_b32 v88, 0
    v_mov_b32 v89, 0
    v_mov_b32 v90, 0
    v_mov_b32 v91, 0
    v_mov_b32 v92, 0
    v_mov_b32 v93, 0
    v_mov_b32 v94, 0
    v_mov_b32 v95, 0
    v_mov_b32 v96, 0
    v_mov_b32 v97, 0
    v_mov_b32 v98, 0
    v_mov_b32 v99, 0
    v_mov_b32 v100, 0
    v_mov_b32 v101, 0
    v_mov_b32 v102, 0
    v_mov_b32 v103, 0
    v_mov_b32 v104, 0
    v_mov_b32 v105, 0
    v_mov_b32 v106, 0
    v_mov_b32 v107, 0
    v_mov_b32 v108, 0
    v_mov_b32 v109, 0
    v_mov_b32 v110, 0
    v_mov_b32 v111, 0
    s_mov_b32 s31, 0
    v_add_u32 v4, s31, v2
    v_add_u32 v5, s31, v3
    v_add_u32 v10, s31, v6
    v_add_u32 v11, s31, v7
    s_add_u32 s31, s31, 40960
    s_cmp_eq_u32 s31, 122880
    s_cselect_b32 s31, 0, s31
    s_barrier
    ds_read_b64_tr_b16 v[144:145], v10 offset:0
    ds_read_b64_tr_b16 v[146:147], v10 offset:512
    ds_read_b128 v[112:115], v4 offset:0
    ds_read_b128 v[120:123], v4 offset:2048
    ds_read_b128 v[128:131], v4 offset:4096
    ds_read_b128 v[136:139], v4 offset:6144
    ds_read_b64_tr_b16 v[152:153], v11 offset:0
    ds_read_b64_tr_b16 v[154:155], v11 offset:512
    ds_read_b64_tr_b16 v[160:161], v10 offset:8192
    ds_read_b64_tr_b16 v[162:163], v10 offset:8704
    ds_read_b64_tr_b16 v[168:169], v11 offset:8192
    ds_read_b64_tr_b16 v[170:171], v11 offset:8704
    ds_read_b64_tr_b16 v[176:177], v10 offset:16384
    ds_read_b64_tr_b16 v[178:179], v10 offset:16896
    ds_read_b64_tr_b16 v[184:185], v11 offset:16384
    ds_read_b64_tr_b16 v[186:187], v11 offset:16896
    s_mov_b32 s30, 0
    v_mov_b32 v192, 0
    v_mov_b32 v193, 0
    v_mov_b32 v194, 0
    v_mov_b32 v195, 0
    v_mov_b32 v196, 0
    v_mov_b32 v197, 0
    v_mov_b32 v198, 0
    v_mov_b32 v199, 0
    v_mov_b32 v200, 0
    v_mov_b32 v201, 0
    v_mov_b32 v202, 0
    v_mov_b32 v203, 0
    v_mov_b32 v204, 0
    v_mov_b32 v205, 0
    v_mov_b32 v206, 0
    v_mov_b32 v207, 0
    v_mov_b32 v208, 0
    v_mov_b32 v209, 0
    v_mov_b32 v210, 0
    v_mov_b32 v211, 0
    v_mov_b32 v212, 0
    v_mov_b32 v213, 0
    v_mov_b32 v214, 0
    v_mov_b32 v215, 0
    v_mov_b32 v216, 0
    v_mov_b32 v217, 0
    v_mov_b32 v218, 0
    v_mov_b32 v219, 0
    v_mov_b32 v220, 0x3f803f80
    v_mov_b32 v221, 0x3f803f80
    v_mov_b32 v222, 0x3f803f80
    v_mov_b32 v223, 0x3f803f80
    v_and_b32 v225, 1, v1
    v_cmp_eq_u32 vcc, 0, v225
    v_mov_b32 v225, 0x44444444
    v_mov_b32 v226, 0xeeeeeeee
    v_cndmask_b32 v224, v226, v225, vcc
    s_cmp_eq_u32 s3, 3
    s_cselect_b32 s53, 1, 16
    s_mov_b32 s54, 1050372
    s_cmp_lg_u32 s38, s39
    s_cbranch_scc1 qkv_kernel_cloop1
.p2align 6
qkv_kernel_cloop0:
    s_waitcnt lgkmcnt(13)
    v_mfma_f32_16x16x32_bf16 v[16:19], v[144:147], v[112:115], v[16:19]
    ds_read_b64_tr_b16 v[148:149], v10 offset:4096
    s_waitcnt lgkmcnt(13)
    v_mfma_f32_16x16x32_bf16 v[40:43], v[144:147], v[120:123], v[40:43]
    ds_read_b64_tr_b16 v[150:151], v10 offset:4608
    s_waitcnt lgkmcnt(13)
    v_mfma_f32_16x16x32_bf16 v[64:67], v[144:147], v[128:131], v[64:67]
    ds_read_b128 v[116:119], v5 offset:0
    s_waitcnt lgkmcnt(13)
    v_mfma_f32_16x16x32_bf16 v[88:91], v[144:147], v[136:139], v[88:91]
    ds_read_b128 v[124:127], v5 offset:2048
    s_waitcnt lgkmcnt(12)
    v_mfma_f32_16x16x32_bf16 v[20:23], v[152:155], v[112:115], v[20:23]
    ds_read_b128 v[132:135], v5 offset:4096
    v_mfma_f32_16x16x32_bf16 v[44:47], v[152:155], v[120:123], v[44:47]
    ds_read_b128 v[140:143], v5 offset:6144
    v_mfma_f32_16x16x32_bf16 v[68:71], v[152:155], v[128:131], v[68:71]
    ds_read_b64_tr_b16 v[156:157], v11 offset:4096
    v_mfma_f32_16x16x32_bf16 v[92:95], v[152:155], v[136:139], v[92:95]
    ds_read_b64_tr_b16 v[158:159], v11 offset:4608
    s_waitcnt lgkmcnt(14)
    v_mfma_f32_16x16x32_bf16 v[24:27], v[160:163], v[112:115], v[24:27]
    ds_read_b64_tr_b16 v[164:165], v10 offset:12288
    v_mfma_f32_16x16x32_bf16 v[48:51], v[160:163], v[120:123], v[48:51]
    ds_read_b64_tr_b16 v[166:167], v10 offset:12800
    v_mfma_f32_16x16x32_bf16 v[72:75], v[160:163], v[128:131], v[72:75]
    ds_read_b64_tr_b16 v[172:173], v11 offset:12288
    v_mfma_f32_16x16x32_bf16 v[96:99], v[160:163], v[136:139], v[96:99]
    ds_read_b64_tr_b16 v[174:175], v11 offset:12800
    s_waitcnt lgkmcnt(15)
    v_mfma_f32_16x16x32_bf16 v[28:31], v[168:171], v[112:115], v[28:31]
    ds_read_b64_tr_b16 v[180:181], v10 offset:20480
    v_mfma_f32_16x16x32_bf16 v[52:55], v[168:171], v[120:123], v[52:55]
    ds_read_b64_tr_b16 v[182:183], v10 offset:20992
    v_mfma_f32_16x16x32_bf16 v[76:79], v[168:171], v[128:131], v[76:79]
    ds_read_b64_tr_b16 v[188:189], v11 offset:20480
    v_mfma_f32_16x16x32_bf16 v[100:103], v[168:171], v[136:139], v[100:103]
    ds_read_b64_tr_b16 v[190:191], v11 offset:20992
    s_waitcnt lgkmcnt(15)
    v_mfma_f32_16x16x32_bf16 v[32:35], v[112:115], v[176:179], v[32:35]
    v_mfma_f32_16x16x32_bf16 v[56:59], v[120:123], v[176:179], v[56:59]
    v_mfma_f32_16x16x32_bf16 v[80:83], v[128:131], v[176:179], v[80:83]
    v_mfma_f32_16x16x32_bf16 v[104:107], v[136:139], v[176:179], v[104:107]
    v_mfma_f32_16x16x32_bf16 v[212:215], v[112:115], v[112:115], v[212:215]
    v_mfma_f32_16x16x32_bf16 v[36:39], v[112:115], v[184:187], v[36:39]
    v_mfma_f32_16x16x32_bf16 v[60:63], v[120:123], v[184:187], v[60:63]
    v_mfma_f32_16x16x32_bf16 v[216:219], v[120:123], v[120:123], v[216:219]
    v_mfma_f32_16x16x32_bf16 v[84:87], v[128:131], v[184:187], v[84:87]
    v_mfma_f32_16x16x32_bf16 v[108:111], v[136:139], v[184:187], v[108:111]
    s_waitcnt lgkmcnt(0)
    v_smfmac_f32_16x16x64_bf16 v[192:195], v[220:223], v[144:151], v224
    v_add_u32 v4, s31, v2
    v_add_u32 v5, s31, v3
    v_smfmac_f32_16x16x64_bf16 v[196:199], v[220:223], v[152:159], v224
    v_add_u32 v10, s31, v6
    v_add_u32 v11, s31, v7
    v_smfmac_f32_16x16x64_bf16 v[200:203], v[220:223], v[160:167], v224
    v_smfmac_f32_16x16x64_bf16 v[204:207], v[220:223], v[112:119], v224
    v_smfmac_f32_16x16x64_bf16 v[208:211], v[220:223], v[120:127], v224
    s_barrier
    v_mfma_f32_16x16x32_bf16 v[16:19], v[148:151], v[116:119], v[16:19]
    ds_read_b64_tr_b16 v[144:145], v10 offset:0
    v_mfma_f32_16x16x32_bf16 v[40:43], v[148:151], v[124:127], v[40:43]
    ds_read_b64_tr_b16 v[146:147], v10 offset:512
    v_mfma_f32_16x16x32_bf16 v[64:67], v[148:151], v[132:135], v[64:67]
    ds_read_b128 v[112:115], v4 offset:0
    v_mfma_f32_16x16x32_bf16 v[88:91], v[148:151], v[140:143], v[88:91]
    ds_read_b128 v[120:123], v4 offset:2048
    v_mfma_f32_16x16x32_bf16 v[20:23], v[156:159], v[116:119], v[20:23]
    ds_read_b128 v[128:131], v4 offset:4096
    v_mfma_f32_16x16x32_bf16 v[44:47], v[156:159], v[124:127], v[44:47]
    ds_read_b128 v[136:139], v4 offset:6144
    v_mfma_f32_16x16x32_bf16 v[68:71], v[156:159], v[132:135], v[68:71]
    ds_read_b64_tr_b16 v[152:153], v11 offset:0
    v_mfma_f32_16x16x32_bf16 v[92:95], v[156:159], v[140:143], v[92:95]
    ds_read_b64_tr_b16 v[154:155], v11 offset:512
    v_mfma_f32_16x16x32_bf16 v[24:27], v[164:167], v[116:119], v[24:27]
    ds_read_b64_tr_b16 v[160:161], v10 offset:8192
    v_mfma_f32_16x16x32_bf16 v[48:51], v[164:167], v[124:127], v[48:51]
    ds_read_b64_tr_b16 v[162:163], v10 offset:8704
    v_mfma_f32_16x16x32_bf16 v[72:75], v[164:167], v[132:135], v[72:75]
    ds_read_b64_tr_b16 v[168:169], v11 offset:8192
    v_mfma_f32_16x16x32_bf16 v[96:99], v[164:167], v[140:143], v[96:99]
    ds_read_b64_tr_b16 v[170:171], v11 offset:8704
    v_mfma_f32_16x16x32_bf16 v[28:31], v[172:175], v[116:119], v[28:31]
    ds_read_b64_tr_b16 v[176:177], v10 offset:16384
    v_mfma_f32_16x16x32_bf16 v[52:55], v[172:175], v[124:127], v[52:55]
    ds_read_b64_tr_b16 v[178:179], v10 offset:16896
    v_mfma_f32_16x16x32_bf16 v[76:79], v[172:175], v[132:135], v[76:79]
    ds_read_b64_tr_b16 v[184:185], v11 offset:16384
    v_mfma_f32_16x16x32_bf16 v[100:103], v[172:175], v[140:143], v[100:103]
    ds_read_b64_tr_b16 v[186:187], v11 offset:16896
    v_mfma_f32_16x16x32_bf16 v[32:35], v[116:119], v[180:183], v[32:35]
    s_add_u32 s31, s31, 40960
    s_cmp_eq_u32 s31, 122880
    v_mfma_f32_16x16x32_bf16 v[56:59], v[124:127], v[180:183], v[56:59]
    s_cselect_b32 s31, 0, s31
    v_mfma_f32_16x16x32_bf16 v[80:83], v[132:135], v[180:183], v[80:83]
    v_mfma_f32_16x16x32_bf16 v[104:107], v[140:143], v[180:183], v[104:107]
    v_mfma_f32_16x16x32_bf16 v[212:215], v[116:119], v[116:119], v[212:215]
    v_mfma_f32_16x16x32_bf16 v[36:39], v[116:119], v[188:191], v[36:39]
    v_mfma_f32_16x16x32_bf16 v[60:63], v[124:127], v[188:191], v[60:63]
    v_mfma_f32_16x16x32_bf16 v[216:219], v[124:127], v[124:127], v[216:219]
    v_mfma_f32_16x16x32_bf16 v[84:87], v[132:135], v[188:191], v[84:87]
    s_add_u32 s30, s30, 1
    s_cmp_lt_u32 s30, s53
    v_mfma_f32_16x16x32_bf16 v[108:111], v[140:143], v[188:191], v[108:111]
    s_cbranch_scc1 qkv_kernel_cloop0
    s_cmp_ge_u32 s30, 16
    s_cbranch_scc1 qkv_kernel_cdone0
    buffer_load_dword v9, v12, s[8:11], s92 offen
    buffer_load_dword v9, v13, s[12:15], s93 offen
    s_add_u32 s92, s92, 512
    s_add_u32 s93, s93, 1572864
    s_and_b32 s53, s54, 0xff
    s_lshr_b32 s54, s54, 8
    s_branch qkv_kernel_cloop0
qkv_kernel_cdone0:
    s_waitcnt lgkmcnt(0)
    v_and_b32 v224, 3, v1
    s_lshl_b32 s34, s39, 7
    s_add_u32 s34, s34, 123904
    v_lshl_add_u32 v2, v15, 2, s34
    s_lshl_b32 s34, s38, 8
    s_add_u32 s34, s34, 122880
    v_lshl_add_u32 v3, v15, 2, s34
    s_nop 2
    v_cmp_eq_u32 vcc, 1, v224
    s_nop 1
    v_cndmask_b32 v212, v212, v213, vcc
    v_cndmask_b32 v216, v216, v217, vcc
    v_cmp_eq_u32 vcc, 2, v224
    s_nop 1
    v_cndmask_b32 v212, v212, v214, vcc
    v_cndmask_b32 v216, v216, v218, vcc
    v_cmp_eq_u32 vcc, 3, v224
    s_nop 1
    v_cndmask_b32 v212, v212, v215, vcc
    v_cndmask_b32 v216, v216, v219, vcc
    v_add_f32 v192, v192, v193
    v_add_f32 v196, v196, v197
    v_add_f32 v200, v200, v201
    v_add_f32 v204, v204, v205
    v_mul_f32 v212, 0x3a800000, v212
    v_add_f32 v208, v208, v209
    v_mul_f32 v216, 0x3a800000, v216
    v_mul_f32 v204, 0x3a800000, v204
    v_mul_f32 v208, 0x3a800000, v208
    v_fma_f32 v212, -v204, v204, v212
    v_fma_f32 v216, -v208, v208, v216
    v_max_f32 v212, 0, v212
    v_max_f32 v216, 0, v216
    v_add_f32 v212, 0x3727c5ac, v212
    v_add_f32 v216, 0x3727c5ac, v216
    v_rsq_f32 v212, v212
    v_rsq_f32 v216, v216
    s_mov_b64 exec, 0xffff
    ds_write_b32 v2, v192 offset:0
    ds_write_b32 v2, v196 offset:64
    ds_write_b32 v2, v200 offset:256
    s_mov_b32 exec_lo, 0x00f0000f
    s_mov_b32 exec_hi, 0xf0000f00
    v_mul_f32 v204, v204, v212
    v_mul_f32 v208, v208, v216
    ds_write_b32 v3, v212 offset:0
    ds_write_b32 v3, v204 offset:512
    ds_write_b32 v3, v216 offset:64
    ds_write_b32 v3, v208 offset:576
    s_mov_b64 exec, -1
    s_branch qkv_kernel_sjoin
.p2align 6
qkv_kernel_cloop1:
    s_waitcnt lgkmcnt(13)
    v_mfma_f32_16x16x32_bf16 v[16:19], v[144:147], v[112:115], v[16:19]
    ds_read_b64_tr_b16 v[148:149], v10 offset:4096
    s_waitcnt lgkmcnt(13)
    v_mfma_f32_16x16x32_bf16 v[40:43], v[144:147], v[120:123], v[40:43]
    ds_read_b64_tr_b16 v[150:151], v10 offset:4608
    s_waitcnt lgkmcnt(13)
    v_mfma_f32_16x16x32_bf16 v[64:67], v[144:147], v[128:131], v[64:67]
    ds_read_b128 v[116:119], v5 offset:0
    s_waitcnt lgkmcnt(13)
    v_mfma_f32_16x16x32_bf16 v[88:91], v[144:147], v[136:139], v[88:91]
    ds_read_b128 v[124:127], v5 offset:2048
    s_waitcnt lgkmcnt(12)
    v_mfma_f32_16x16x32_bf16 v[20:23], v[152:155], v[112:115], v[20:23]
    ds_read_b128 v[132:135], v5 offset:4096
    v_mfma_f32_16x16x32_bf16 v[44:47], v[152:155], v[120:123], v[44:47]
    ds_read_b128 v[140:143], v5 offset:6144
    v_mfma_f32_16x16x32_bf16 v[68:71], v[152:155], v[128:131], v[68:71]
    ds_read_b64_tr_b16 v[156:157], v11 offset:4096
    v_mfma_f32_16x16x32_bf16 v[92:95], v[152:155], v[136:139], v[92:95]
    ds_read_b64_tr_b16 v[158:159], v11 offset:4608
    s_waitcnt lgkmcnt(14)
    v_mfma_f32_16x16x32_bf16 v[24:27], v[160:163], v[112:115], v[24:27]
    ds_read_b64_tr_b16 v[164:165], v10 offset:12288
    v_mfma_f32_16x16x32_bf16 v[48:51], v[160:163], v[120:123], v[48:51]
    ds_read_b64_tr_b16 v[166:167], v10 offset:12800
    v_mfma_f32_16x16x32_bf16 v[72:75], v[160:163], v[128:131], v[72:75]
    ds_read_b64_tr_b16 v[172:173], v11 offset:12288
    v_mfma_f32_16x16x32_bf16 v[96:99], v[160:163], v[136:139], v[96:99]
    ds_read_b64_tr_b16 v[174:175], v11 offset:12800
    s_waitcnt lgkmcnt(15)
    v_mfma_f32_16x16x32_bf16 v[28:31], v[168:171], v[112:115], v[28:31]
    ds_read_b64_tr_b16 v[180:181], v10 offset:20480
    v_mfma_f32_16x16x32_bf16 v[52:55], v[168:171], v[120:123], v[52:55]
    ds_read_b64_tr_b16 v[182:183], v10 offset:20992
    v_mfma_f32_16x16x32_bf16 v[76:79], v[168:171], v[128:131], v[76:79]
    ds_read_b64_tr_b16 v[188:189], v11 offset:20480
    v_mfma_f32_16x16x32_bf16 v[100:103], v[168:171], v[136:139], v[100:103]
    ds_read_b64_tr_b16 v[190:191], v11 offset:20992
    s_waitcnt lgkmcnt(15)
    v_mfma_f32_16x16x32_bf16 v[32:35], v[112:115], v[176:179], v[32:35]
    v_mfma_f32_16x16x32_bf16 v[56:59], v[120:123], v[176:179], v[56:59]
    v_mfma_f32_16x16x32_bf16 v[80:83], v[128:131], v[176:179], v[80:83]
    v_mfma_f32_16x16x32_bf16 v[104:107], v[136:139], v[176:179], v[104:107]
    v_mfma_f32_16x16x32_bf16 v[212:215], v[128:131], v[128:131], v[212:215]
    v_mfma_f32_16x16x32_bf16 v[36:39], v[112:115], v[184:187], v[36:39]
    v_mfma_f32_16x16x32_bf16 v[60:63], v[120:123], v[184:187], v[60:63]
    v_mfma_f32_16x16x32_bf16 v[216:219], v[136:139], v[136:139], v[216:219]
    v_mfma_f32_16x16x32_bf16 v[84:87], v[128:131], v[184:187], v[84:87]
    v_mfma_f32_16x16x32_bf16 v[108:111], v[136:139], v[184:187], v[108:111]
    s_waitcnt lgkmcnt(0)
    v_smfmac_f32_16x16x64_bf16 v[192:195], v[220:223], v[168:175], v224
    v_add_u32 v4, s31, v2
    v_add_u32 v5, s31, v3
    v_smfmac_f32_16x16x64_bf16 v[196:199], v[220:223], v[176:183], v224
    v_add_u32 v10, s31, v6
    v_add_u32 v11, s31, v7
    v_smfmac_f32_16x16x64_bf16 v[200:203], v[220:223], v[184:191], v224
    v_smfmac_f32_16x16x64_bf16 v[204:207], v[220:223], v[128:135], v224
    v_smfmac_f32_16x16x64_bf16 v[208:211], v[220:223], v[136:143], v224
    s_barrier
    v_mfma_f32_16x16x32_bf16 v[16:19], v[148:151], v[116:119], v[16:19]
    ds_read_b64_tr_b16 v[144:145], v10 offset:0
    v_mfma_f32_16x16x32_bf16 v[40:43], v[148:151], v[124:127], v[40:43]
    ds_read_b64_tr_b16 v[146:147], v10 offset:512
    v_mfma_f32_16x16x32_bf16 v[64:67], v[148:151], v[132:135], v[64:67]
    ds_read_b128 v[112:115], v4 offset:0
    v_mfma_f32_16x16x32_bf16 v[88:91], v[148:151], v[140:143], v[88:91]
    ds_read_b128 v[120:123], v4 offset:2048
    v_mfma_f32_16x16x32_bf16 v[20:23], v[156:159], v[116:119], v[20:23]
    ds_read_b128 v[128:131], v4 offset:4096
    v_mfma_f32_16x16x32_bf16 v[44:47], v[156:159], v[124:127], v[44:47]
    ds_read_b128 v[136:139], v4 offset:6144
    v_mfma_f32_16x16x32_bf16 v[68:71], v[156:159], v[132:135], v[68:71]
    ds_read_b64_tr_b16 v[152:153], v11 offset:0
    v_mfma_f32_16x16x32_bf16 v[92:95], v[156:159], v[140:143], v[92:95]
    ds_read_b64_tr_b16 v[154:155], v11 offset:512
    v_mfma_f32_16x16x32_bf16 v[24:27], v[164:167], v[116:119], v[24:27]
    ds_read_b64_tr_b16 v[160:161], v10 offset:8192
    v_mfma_f32_16x16x32_bf16 v[48:51], v[164:167], v[124:127], v[48:51]
    ds_read_b64_tr_b16 v[162:163], v10 offset:8704
    v_mfma_f32_16x16x32_bf16 v[72:75], v[164:167], v[132:135], v[72:75]
    ds_read_b64_tr_b16 v[168:169], v11 offset:8192
    v_mfma_f32_16x16x32_bf16 v[96:99], v[164:167], v[140:143], v[96:99]
    ds_read_b64_tr_b16 v[170:171], v11 offset:8704
    v_mfma_f32_16x16x32_bf16 v[28:31], v[172:175], v[116:119], v[28:31]
    ds_read_b64_tr_b16 v[176:177], v10 offset:16384
    v_mfma_f32_16x16x32_bf16 v[52:55], v[172:175], v[124:127], v[52:55]
    ds_read_b64_tr_b16 v[178:179], v10 offset:16896
    v_mfma_f32_16x16x32_bf16 v[76:79], v[172:175], v[132:135], v[76:79]
    ds_read_b64_tr_b16 v[184:185], v11 offset:16384
    v_mfma_f32_16x16x32_bf16 v[100:103], v[172:175], v[140:143], v[100:103]
    ds_read_b64_tr_b16 v[186:187], v11 offset:16896
    v_mfma_f32_16x16x32_bf16 v[32:35], v[116:119], v[180:183], v[32:35]
    s_add_u32 s31, s31, 40960
    s_cmp_eq_u32 s31, 122880
    v_mfma_f32_16x16x32_bf16 v[56:59], v[124:127], v[180:183], v[56:59]
    s_cselect_b32 s31, 0, s31
    v_mfma_f32_16x16x32_bf16 v[80:83], v[132:135], v[180:183], v[80:83]
    v_mfma_f32_16x16x32_bf16 v[104:107], v[140:143], v[180:183], v[104:107]
    v_mfma_f32_16x16x32_bf16 v[212:215], v[132:135], v[132:135], v[212:215]
    v_mfma_f32_16x16x32_bf16 v[36:39], v[116:119], v[188:191], v[36:39]
    v_mfma_f32_16x16x32_bf16 v[60:63], v[124:127], v[188:191], v[60:63]
    v_mfma_f32_16x16x32_bf16 v[216:219], v[140:143], v[140:143], v[216:219]
    v_mfma_f32_16x16x32_bf16 v[84:87], v[132:135], v[188:191], v[84:87]
    s_add_u32 s30, s30, 1
    s_cmp_lt_u32 s30, s53
    v_mfma_f32_16x16x32_bf16 v[108:111], v[140:143], v[188:191], v[108:111]
    s_cbranch_scc1 qkv_kernel_cloop1
    s_waitcnt lgkmcnt(0)
    v_and_b32 v224, 3, v1
    s_lshl_b32 s34, s39, 7
    s_add_u32 s34, s34, 123904
    v_lshl_add_u32 v2, v15, 2, s34
    s_lshl_b32 s34, s38, 8
    s_add_u32 s34, s34, 122880
    v_lshl_add_u32 v3, v15, 2, s34
    s_nop 2
    v_cmp_eq_u32 vcc, 1, v224
    s_nop 1
    v_cndmask_b32 v212, v212, v213, vcc
    v_cndmask_b32 v216, v216, v217, vcc
    v_cmp_eq_u32 vcc, 2, v224
    s_nop 1
    v_cndmask_b32 v212, v212, v214, vcc
    v_cndmask_b32 v216, v216, v218, vcc
    v_cmp_eq_u32 vcc, 3, v224
    s_nop 1
    v_cndmask_b32 v212, v212, v215, vcc
    v_cndmask_b32 v216, v216, v219, vcc
    v_add_f32 v192, v192, v193
    v_add_f32 v196, v196, v197
    v_add_f32 v200, v200, v201
    v_add_f32 v204, v204, v205
    v_mul_f32 v212, 0x3a800000, v212
    v_add_f32 v208, v208, v209
    v_mul_f32 v216, 0x3a800000, v216
    v_mul_f32 v204, 0x3a800000, v204
    v_mul_f32 v208, 0x3a800000, v208
    v_fma_f32 v212, -v204, v204, v212
    v_fma_f32 v216, -v208, v208, v216
    v_max_f32 v212, 0, v212
    v_max_f32 v216, 0, v216
    v_add_f32 v212, 0x3727c5ac, v212
    v_add_f32 v216, 0x3727c5ac, v216
    v_rsq_f32 v212, v212
    v_rsq_f32 v216, v216
    s_mov_b64 exec, 0xffff
    ds_write_b32 v2, v192 offset:320
    ds_write_b32 v2, v196 offset:512
    ds_write_b32 v2, v200 offset:576
    s_mov_b32 exec_lo, 0x00f0000f
    s_mov_b32 exec_hi, 0xf0000f00
    v_mul_f32 v204, v204, v212
    v_mul_f32 v208, v208, v216
    ds_write_b32 v3, v212 offset:128
    ds_write_b32 v3, v204 offset:640
    ds_write_b32 v3, v216 offset:192
    ds_write_b32 v3, v208 offset:704
    s_mov_b64 exec, -1
qkv_kernel_sjoin:
    s_waitcnt lgkmcnt(0)
    s_barrier
    s_nop 7
    s_lshl_b32 s34, s38, 8
    s_add_u32 s34, s34, 122880
    v_lshl_add_u32 v2, v15, 2, s34
    v_lshl_add_u32 v5, v14, 4, s34
    s_lshl_b32 s35, s39, 7
    s_add_u32 s35, s35, 123904
    v_lshl_add_u32 v3, v14, 4, s35
    v_lshl_add_u32 v4, v15, 2, s35
    ds_read_b32 v112, v2 offset:0
    ds_read_b32 v113, v2 offset:512
    ds_read_b32 v114, v2 offset:64
    ds_read_b32 v115, v2 offset:576
    ds_read_b32 v116, v2 offset:128
    ds_read_b32 v117, v2 offset:640
    ds_read_b32 v118, v2 offset:192
    ds_read_b32 v119, v2 offset:704
    ds_read_b128 v[128:131], v3 offset:0
    ds_read_b128 v[132:135], v3 offset:64
    ds_read_b128 v[136:139], v3 offset:256
    ds_read_b128 v[140:143], v3 offset:320
    ds_read_b32 v144, v4 offset:512
    ds_read_b32 v146, v4 offset:576
    ds_read_b128 v[148:151], v5 offset:0
    ds_read_b128 v[152:155], v5 offset:512
    ds_read_b128 v[156:159], v5 offset:64
    ds_read_b128 v[160:163], v5 offset:576
    ds_read_b128 v[164:167], v5 offset:128
    ds_read_b128 v[168:171], v5 offset:640
    ds_read_b128 v[172:175], v5 offset:192
    ds_read_b128 v[176:179], v5 offset:704
    s_lshl_b32 s34, s28, 2
    s_lshl_b32 s35, s38, 1
    s_add_u32 s34, s34, s35
    s_add_u32 s35, s29, 0
    s_and_b32 s35, s35, 15
    s_lshl_b32 s35, s35, 1
    s_add_u32 s35, s35, s39
    s_lshl_b32 s35, s35, 6
    s_add_u32 s35, s35, s34
    s_lshl_b32 s48, s35, 11
    s_add_u32 s48, s48, 0
    s_add_u32 s49, s48, 2048
    s_add_u32 s35, s29, 3
    s_and_b32 s35, s35, 15
    s_lshl_b32 s35, s35, 1
    s_add_u32 s35, s35, s39
    s_lshl_b32 s35, s35, 6
    s_add_u32 s35, s35, s34
    s_lshl_b32 s50, s35, 12
    s_add_u32 s50, s50, 4194304
    s_add_u32 s51, s50, 4096
    s_add_u32 s35, s29, 6
    s_and_b32 s35, s35, 15
    s_lshl_b32 s35, s35, 1
    s_add_u32 s35, s35, s39
    s_lshl_b32 s35, s35, 6
    s_add_u32 s35, s35, s34
    s_lshl_b32 s52, s35, 12
    s_add_u32 s52, s52, 4196352
    s_add_u32 s53, s52, 4096
    v_lshrrev_b32 v6, 1, v14
    v_lshlrev_b32 v6, 10, v6
    v_and_b32 v7, 1, v14
    v_lshl_add_u32 v6, v7, 9, v6
    v_lshrrev_b32 v7, 3, v15
    v_lshl_add_u32 v7, v7, 8, v6
    v_and_b32 v8, 7, v15
    v_lshl_add_u32 v7, v8, 4, v7
    v_lshl_add_u32 v6, v15, 4, v6
    s_waitcnt lgkmcnt(0)
    v_mul_f32 v120, 0x3e8293ee, v112
    v_mul_f32 v121, 0x3e8293ee, v113
    v_mul_f32 v122, 0x3e8293ee, v114
    v_mul_f32 v123, 0x3e8293ee, v115
    v_mul_f32 v124, 0x3e8293ee, v116
    v_mul_f32 v125, 0x3e8293ee, v117
    v_mul_f32 v126, 0x3e8293ee, v118
    v_mul_f32 v127, 0x3e8293ee, v119
    v_pk_mul_f32 v[180:181], v[128:129], v[120:121] op_sel:[0,1] op_sel_hi:[1,1]
    v_pk_mul_f32 v[182:183], v[130:131], v[120:121] op_sel:[0,1] op_sel_hi:[1,1]
    v_pk_mul_f32 v[184:185], v[132:133], v[120:121] op_sel:[0,1] op_sel_hi:[1,1]
    v_pk_mul_f32 v[186:187], v[134:135], v[120:121] op_sel:[0,1] op_sel_hi:[1,1]
    v_pk_fma_f32 v[16:17], v[16:17], v[120:121], v[180:181] op_sel_hi:[1,0,1] neg_lo:[0,0,1] neg_hi:[0,0,1]
    v_pk_fma_f32 v[18:19], v[18:19], v[120:121], v[182:183] op_sel_hi:[1,0,1] neg_lo:[0,0,1] neg_hi:[0,0,1]
    v_pk_fma_f32 v[20:21], v[20:21], v[120:121], v[184:185] op_sel_hi:[1,0,1] neg_lo:[0,0,1] neg_hi:[0,0,1]
    v_pk_fma_f32 v[22:23], v[22:23], v[120:121], v[186:187] op_sel_hi:[1,0,1] neg_lo:[0,0,1] neg_hi:[0,0,1]
    v_cvt_pk_bf16_f32 v16, v16, v17
    v_cvt_pk_bf16_f32 v17, v18, v19
    v_cvt_pk_bf16_f32 v18, v20, v21
    v_cvt_pk_bf16_f32 v19, v22, v23
    buffer_store_dwordx4 v[16:19], v6, s[16:19], s48 offen offset:0 sc1
    v_pk_mul_f32 v[180:181], v[136:137], v[112:113] op_sel:[0,1] op_sel_hi:[1,1]
    v_pk_mul_f32 v[182:183], v[138:139], v[112:113] op_sel:[0,1] op_sel_hi:[1,1]
    v_pk_mul_f32 v[184:185], v[140:141], v[112:113] op_sel:[0,1] op_sel_hi:[1,1]
    v_pk_mul_f32 v[186:187], v[142:143], v[112:113] op_sel:[0,1] op_sel_hi:[1,1]
    v_pk_fma_f32 v[24:25], v[24:25], v[112:113], v[180:181] op_sel_hi:[1,0,1] neg_lo:[0,0,1] neg_hi:[0,0,1]
    v_pk_fma_f32 v[26:27], v[26:27], v[112:113], v[182:183] op_sel_hi:[1,0,1] neg_lo:[0,0,1] neg_hi:[0,0,1]
    v_pk_fma_f32 v[28:29], v[28:29], v[112:113], v[184:185] op_sel_hi:[1,0,1] neg_lo:[0,0,1] neg_hi:[0,0,1]
    v_pk_fma_f32 v[30:31], v[30:31], v[112:113], v[186:187] op_sel_hi:[1,0,1] neg_lo:[0,0,1] neg_hi:[0,0,1]
    v_cvt_pk_bf16_f32 v24, v24, v25
    v_cvt_pk_bf16_f32 v25, v26, v27
    v_cvt_pk_bf16_f32 v26, v28, v29
    v_cvt_pk_bf16_f32 v27, v30, v31
    buffer_store_dwordx4 v[24:27], v7, s[16:19], s50 offen offset:0 sc1
    v_pk_mul_f32 v[180:181], v[128:129], v[122:123] op_sel:[0,1] op_sel_hi:[1,1]
    v_pk_mul_f32 v[182:183], v[130:131], v[122:123] op_sel:[0,1] op_sel_hi:[1,1]
    v_pk_mul_f32 v[184:185], v[132:133], v[122:123] op_sel:[0,1] op_sel_hi:[1,1]
    v_pk_mul_f32 v[186:187], v[134:135], v[122:123] op_sel:[0,1] op_sel_hi:[1,1]
    v_pk_fma_f32 v[40:41], v[40:41], v[122:123], v[180:181] op_sel_hi:[1,0,1] neg_lo:[0,0,1] neg_hi:[0,0,1]
    v_pk_fma_f32 v[42:43], v[42:43], v[122:123], v[182:183] op_sel_hi:[1,0,1] neg_lo:[0,0,1] neg_hi:[0,0,1]
    v_pk_fma_f32 v[44:45], v[44:45], v[122:123], v[184:185] op_sel_hi:[1,0,1] neg_lo:[0,0,1] neg_hi:[0,0,1]
    v_pk_fma_f32 v[46:47], v[46:47], v[122:123], v[186:187] op_sel_hi:[1,0,1] neg_lo:[0,0,1] neg_hi:[0,0,1]
    v_cvt_pk_bf16_f32 v40, v40, v41
    v_cvt_pk_bf16_f32 v41, v42, v43
    v_cvt_pk_bf16_f32 v42, v44, v45
    v_cvt_pk_bf16_f32 v43, v46, v47
    buffer_store_dwordx4 v[40:43], v6, s[16:19], s48 offen offset:256 sc1
    v_pk_mul_f32 v[180:181], v[136:137], v[114:115] op_sel:[0,1] op_sel_hi:[1,1]
    v_pk_mul_f32 v[182:183], v[138:139], v[114:115] op_sel:[0,1] op_sel_hi:[1,1]
    v_pk_mul_f32 v[184:185], v[140:141], v[114:115] op_sel:[0,1] op_sel_hi:[1,1]
    v_pk_mul_f32 v[186:187], v[142:143], v[114:115] op_sel:[0,1] op_sel_hi:[1,1]
    v_pk_fma_f32 v[48:49], v[48:49], v[114:115], v[180:181] op_sel_hi:[1,0,1] neg_lo:[0,0,1] neg_hi:[0,0,1]
    v_pk_fma_f32 v[50:51], v[50:51], v[114:115], v[182:183] op_sel_hi:[1,0,1] neg_lo:[0,0,1] neg_hi:[0,0,1]
    v_pk_fma_f32 v[52:53], v[52:53], v[114:115], v[184:185] op_sel_hi:[1,0,1] neg_lo:[0,0,1] neg_hi:[0,0,1]
    v_pk_fma_f32 v[54:55], v[54:55], v[114:115], v[186:187] op_sel_hi:[1,0,1] neg_lo:[0,0,1] neg_hi:[0,0,1]
    v_cvt_pk_bf16_f32 v48, v48, v49
    v_cvt_pk_bf16_f32 v49, v50, v51
    v_cvt_pk_bf16_f32 v50, v52, v53
    v_cvt_pk_bf16_f32 v51, v54, v55
    buffer_store_dwordx4 v[48:51], v7, s[16:19], s50 offen offset:128 sc1
    v_pk_mul_f32 v[180:181], v[128:129], v[124:125] op_sel:[0,1] op_sel_hi:[1,1]
    v_pk_mul_f32 v[182:183], v[130:131], v[124:125] op_sel:[0,1] op_sel_hi:[1,1]
    v_pk_mul_f32 v[184:185], v[132:133], v[124:125] op_sel:[0,1] op_sel_hi:[1,1]
    v_pk_mul_f32 v[186:187], v[134:135], v[124:125] op_sel:[0,1] op_sel_hi:[1,1]
    v_pk_fma_f32 v[64:65], v[64:65], v[124:125], v[180:181] op_sel_hi:[1,0,1] neg_lo:[0,0,1] neg_hi:[0,0,1]
    v_pk_fma_f32 v[66:67], v[66:67], v[124:125], v[182:183] op_sel_hi:[1,0,1] neg_lo:[0,0,1] neg_hi:[0,0,1]
    v_pk_fma_f32 v[68:69], v[68:69], v[124:125], v[184:185] op_sel_hi:[1,0,1] neg_lo:[0,0,1] neg_hi:[0,0,1]
    v_pk_fma_f32 v[70:71], v[70:71], v[124:125], v[186:187] op_sel_hi:[1,0,1] neg_lo:[0,0,1] neg_hi:[0,0,1]
    v_cvt_pk_bf16_f32 v64, v64, v65
    v_cvt_pk_bf16_f32 v65, v66, v67
    v_cvt_pk_bf16_f32 v66, v68, v69
    v_cvt_pk_bf16_f32 v67, v70, v71
    buffer_store_dwordx4 v[64:67], v6, s[16:19], s49 offen offset:0 sc1
    v_pk_mul_f32 v[180:181], v[136:137], v[116:117] op_sel:[0,1] op_sel_hi:[1,1]
    v_pk_mul_f32 v[182:183], v[138:139], v[116:117] op_sel:[0,1] op_sel_hi:[1,1]
    v_pk_mul_f32 v[184:185], v[140:141], v[116:117] op_sel:[0,1] op_sel_hi:[1,1]
    v_pk_mul_f32 v[186:187], v[142:143], v[116:117] op_sel:[0,1] op_sel_hi:[1,1]
    v_pk_fma_f32 v[72:73], v[72:73], v[116:117], v[180:181] op_sel_hi:[1,0,1] neg_lo:[0,0,1] neg_hi:[0,0,1]
    v_pk_fma_f32 v[74:75], v[74:75], v[116:117], v[182:183] op_sel_hi:[1,0,1] neg_lo:[0,0,1] neg_hi:[0,0,1]
    v_pk_fma_f32 v[76:77], v[76:77], v[116:117], v[184:185] op_sel_hi:[1,0,1] neg_lo:[0,0,1] neg_hi:[0,0,1]
    v_pk_fma_f32 v[78:79], v[78:79], v[116:117], v[186:187] op_sel_hi:[1,0,1] neg_lo:[0,0,1] neg_hi:[0,0,1]
    v_cvt_pk_bf16_f32 v72, v72, v73
    v_cvt_pk_bf16_f32 v73, v74, v75
    v_cvt_pk_bf16_f32 v74, v76, v77
    v_cvt_pk_bf16_f32 v75, v78, v79
    buffer_store_dwordx4 v[72:75], v7, s[16:19], s51 offen offset:0 sc1
    v_pk_mul_f32 v[180:181], v[128:129], v[126:127] op_sel:[0,1] op_sel_hi:[1,1]
    v_pk_mul_f32 v[182:183], v[130:131], v[126:127] op_sel:[0,1] op_sel_hi:[1,1]
    v_pk_mul_f32 v[184:185], v[132:133], v[126:127] op_sel:[0,1] op_sel_hi:[1,1]
    v_pk_mul_f32 v[186:187], v[134:135], v[126:127] op_sel:[0,1] op_sel_hi:[1,1]
    v_pk_fma_f32 v[88:89], v[88:89], v[126:127], v[180:181] op_sel_hi:[1,0,1] neg_lo:[0,0,1] neg_hi:[0,0,1]
    v_pk_fma_f32 v[90:91], v[90:91], v[126:127], v[182:183] op_sel_hi:[1,0,1] neg_lo:[0,0,1] neg_hi:[0,0,1]
    v_pk_fma_f32 v[92:93], v[92:93], v[126:127], v[184:185] op_sel_hi:[1,0,1] neg_lo:[0,0,1] neg_hi:[0,0,1]
    v_pk_fma_f32 v[94:95], v[94:95], v[126:127], v[186:187] op_sel_hi:[1,0,1] neg_lo:[0,0,1] neg_hi:[0,0,1]
    v_cvt_pk_bf16_f32 v88, v88, v89
    v_cvt_pk_bf16_f32 v89, v90, v91
    v_cvt_pk_bf16_f32 v90, v92, v93
    v_cvt_pk_bf16_f32 v91, v94, v95
    buffer_store_dwordx4 v[88:91], v6, s[16:19], s49 offen offset:256 sc1
    v_pk_mul_f32 v[180:181], v[136:137], v[118:119] op_sel:[0,1] op_sel_hi:[1,1]
    v_pk_mul_f32 v[182:183], v[138:139], v[118:119] op_sel:[0,1] op_sel_hi:[1,1]
    v_pk_mul_f32 v[184:185], v[140:141], v[118:119] op_sel:[0,1] op_sel_hi:[1,1]
    v_pk_mul_f32 v[186:187], v[142:143], v[118:119] op_sel:[0,1] op_sel_hi:[1,1]
    v_pk_fma_f32 v[96:97], v[96:97], v[118:119], v[180:181] op_sel_hi:[1,0,1] neg_lo:[0,0,1] neg_hi:[0,0,1]
    v_pk_fma_f32 v[98:99], v[98:99], v[118:119], v[182:183] op_sel_hi:[1,0,1] neg_lo:[0,0,1] neg_hi:[0,0,1]
    v_pk_fma_f32 v[100:101], v[100:101], v[118:119], v[184:185] op_sel_hi:[1,0,1] neg_lo:[0,0,1] neg_hi:[0,0,1]
    v_pk_fma_f32 v[102:103], v[102:103], v[118:119], v[186:187] op_sel_hi:[1,0,1] neg_lo:[0,0,1] neg_hi:[0,0,1]
    v_cvt_pk_bf16_f32 v96, v96, v97
    v_cvt_pk_bf16_f32 v97, v98, v99
    v_cvt_pk_bf16_f32 v98, v100, v101
    v_cvt_pk_bf16_f32 v99, v102, v103
    buffer_store_dwordx4 v[96:99], v7, s[16:19], s51 offen offset:128 sc1
    v_pk_mul_f32 v[180:181], v[152:153], v[144:145] op_sel_hi:[1,0]
    v_pk_mul_f32 v[182:183], v[154:155], v[144:145] op_sel_hi:[1,0]
    v_pk_mul_f32 v[184:185], v[160:161], v[144:145] op_sel_hi:[1,0]
    v_pk_mul_f32 v[186:187], v[162:163], v[144:145] op_sel_hi:[1,0]
    v_pk_fma_f32 v[32:33], v[32:33], v[148:149], v[180:181] neg_lo:[0,0,1] neg_hi:[0,0,1]
    v_pk_fma_f32 v[34:35], v[34:35], v[150:151], v[182:183] neg_lo:[0,0,1] neg_hi:[0,0,1]
    v_pk_fma_f32 v[56:57], v[56:57], v[156:157], v[184:185] neg_lo:[0,0,1] neg_hi:[0,0,1]
    v_pk_fma_f32 v[58:59], v[58:59], v[158:159], v[186:187] neg_lo:[0,0,1] neg_hi:[0,0,1]
    v_cvt_pk_bf16_f32 v188, v32, v33
    v_cvt_pk_bf16_f32 v189, v34, v35
    v_cvt_pk_bf16_f32 v190, v56, v57
    v_cvt_pk_bf16_f32 v191, v58, v59
    buffer_store_dwordx4 v[188:191], v6, s[16:19], s52 offen offset:0 sc1
    v_pk_mul_f32 v[180:181], v[152:153], v[146:147] op_sel_hi:[1,0]
    v_pk_mul_f32 v[182:183], v[154:155], v[146:147] op_sel_hi:[1,0]
    v_pk_mul_f32 v[184:185], v[160:161], v[146:147] op_sel_hi:[1,0]
    v_pk_mul_f32 v[186:187], v[162:163], v[146:147] op_sel_hi:[1,0]
    v_pk_fma_f32 v[36:37], v[36:37], v[148:149], v[180:181] neg_lo:[0,0,1] neg_hi:[0,0,1]
    v_pk_fma_f32 v[38:39], v[38:39], v[150:151], v[182:183] neg_lo:[0,0,1] neg_hi:[0,0,1]
    v_pk_fma_f32 v[60:61], v[60:61], v[156:157], v[184:185] neg_lo:[0,0,1] neg_hi:[0,0,1]
    v_pk_fma_f32 v[62:63], v[62:63], v[158:159], v[186:187] neg_lo:[0,0,1] neg_hi:[0,0,1]
    v_cvt_pk_bf16_f32 v192, v36, v37
    v_cvt_pk_bf16_f32 v193, v38, v39
    v_cvt_pk_bf16_f32 v194, v60, v61
    v_cvt_pk_bf16_f32 v195, v62, v63
    buffer_store_dwordx4 v[192:195], v6, s[16:19], s52 offen offset:256 sc1
    v_pk_mul_f32 v[180:181], v[168:169], v[144:145] op_sel_hi:[1,0]
    v_pk_mul_f32 v[182:183], v[170:171], v[144:145] op_sel_hi:[1,0]
    v_pk_mul_f32 v[184:185], v[176:177], v[144:145] op_sel_hi:[1,0]
    v_pk_mul_f32 v[186:187], v[178:179], v[144:145] op_sel_hi:[1,0]
    v_pk_fma_f32 v[80:81], v[80:81], v[164:165], v[180:181] neg_lo:[0,0,1] neg_hi:[0,0,1]
    v_pk_fma_f32 v[82:83], v[82:83], v[166:167], v[182:183] neg_lo:[0,0,1] neg_hi:[0,0,1]
    v_pk_fma_f32 v[104:105], v[104:105], v[172:173], v[184:185] neg_lo:[0,0,1] neg_hi:[0,0,1]
    v_pk_fma_f32 v[106:107], v[106:107], v[174:175], v[186:187] neg_lo:[0,0,1] neg_hi:[0,0,1]
    v_cvt_pk_bf16_f32 v196, v80, v81
    v_cvt_pk_bf16_f32 v197, v82, v83
    v_cvt_pk_bf16_f32 v198, v104, v105
    v_cvt_pk_bf16_f32 v199, v106, v107
    buffer_store_dwordx4 v[196:199], v6, s[16:19], s53 offen offset:0 sc1
    v_pk_mul_f32 v[180:181], v[168:169], v[146:147] op_sel_hi:[1,0]
    v_pk_mul_f32 v[182:183], v[170:171], v[146:147] op_sel_hi:[1,0]
    v_pk_mul_f32 v[184:185], v[176:177], v[146:147] op_sel_hi:[1,0]
    v_pk_mul_f32 v[186:187], v[178:179], v[146:147] op_sel_hi:[1,0]
    v_pk_fma_f32 v[84:85], v[84:85], v[164:165], v[180:181] neg_lo:[0,0,1] neg_hi:[0,0,1]
    v_pk_fma_f32 v[86:87], v[86:87], v[166:167], v[182:183] neg_lo:[0,0,1] neg_hi:[0,0,1]
    v_pk_fma_f32 v[108:109], v[108:109], v[172:173], v[184:185] neg_lo:[0,0,1] neg_hi:[0,0,1]
    v_pk_fma_f32 v[110:111], v[110:111], v[174:175], v[186:187] neg_lo:[0,0,1] neg_hi:[0,0,1]
    v_cvt_pk_bf16_f32 v200, v84, v85
    v_cvt_pk_bf16_f32 v201, v86, v87
    v_cvt_pk_bf16_f32 v202, v108, v109
    v_cvt_pk_bf16_f32 v203, v110, v111
    buffer_store_dwordx4 v[200:203], v6, s[16:19], s53 offen offset:256 sc1
    s_endpgm
.globl attn_kernel
.p2align 8
.type attn_kernel,@function
attn_kernel:
    s_cmp_ge_u32 s2, 256
    s_cbranch_scc1 attn_kernel_end
    s_load_dwordx2 s[16:17], s[0:1], 80
    s_load_dwordx2 s[12:13], s[0:1], 32
    s_load_dwordx2 s[20:21], s[0:1], 16
    s_load_dwordx2 s[24:25], s[0:1], 48
    v_lshrrev_b32 v2, 6, v0
    v_and_b32 v1, 63, v0
    v_readfirstlane_b32 s3, v2
    s_and_b32 s34, s2, 7
    s_lshr_b32 s35, s2, 3
    s_lshl_b32 s28, s34, 2
    s_and_b32 s36, s35, 3
    s_add_u32 s28, s28, s36
    s_lshr_b32 s29, s35, 2
    s_lshl_b32 s37, s28, 18
    s_add_u32 s37, s37, 4194304
    v_lshlrev_b32 v4, 4, v1
    s_mov_b32 s18, 268435456
    s_mov_b32 s19, 0x20000
    s_mov_b32 s14, 7340032
    s_mov_b32 s15, 0x20000
    s_mov_b32 s22, 2097152
    s_mov_b32 s23, 0x20000
    s_mov_b32 s26, 7340032
    s_mov_b32 s27, 0x20000
    s_cmp_lt_u32 s3, 4
    s_cbranch_scc1 attn_kernel_comp
    s_mov_b32 s31, 0
    s_waitcnt lgkmcnt(0)
    s_mov_b32 s8, s16
    s_or_b32 s9, s17, 0x100000
    s_mov_b32 s10, -1
    s_mov_b32 s11, 0x800000
    s_lshr_b32 s40, s2, 4
    s_and_b32 s41, s2, 15
    s_cmp_gt_u32 s3, 4
    s_cbranch_scc1 attn_kernel_side
    s_mov_b32 s84, 16640
    s_mov_b32 s85, 4
    s_mov_b32 s86, 49920
    v_mov_b32 v143, 1
    v_mov_b32 v140, 16640
    v_mov_b32 v142, 49920
    v_mov_b32 v141, 0
    s_add_u32 m0, s31, 0
    s_nop 0
    buffer_load_dwordx4 off, s[8:11], s37 offset:0  lds
    buffer_load_dwordx4 off, s[8:11], s37 offset:1024  lds
    buffer_load_dwordx4 off, s[8:11], s37 offset:2048  lds
    buffer_load_dwordx4 off, s[8:11], s37 offset:3072  lds
    s_add_u32 s37, s37, 4096
    s_add_u32 m0, s31, 4096
    s_nop 0
    buffer_load_dwordx4 off, s[8:11], s37 offset:0  lds
    buffer_load_dwordx4 off, s[8:11], s37 offset:1024  lds
    buffer_load_dwordx4 off, s[8:11], s37 offset:2048  lds
    buffer_load_dwordx4 off, s[8:11], s37 offset:3072  lds
    s_add_u32 s37, s37, 4096
    s_add_u32 m0, s31, 8192
    s_nop 0
    buffer_load_dwordx4 off, s[8:11], s37 offset:0  lds
    buffer_load_dwordx4 off, s[8:11], s37 offset:1024  lds
    buffer_load_dwordx4 off, s[8:11], s37 offset:2048  lds
    buffer_load_dwordx4 off, s[8:11], s37 offset:3072  lds
    s_add_u32 s37, s37, 4096
    s_add_u32 m0, s31, 12288
    s_nop 0
    buffer_load_dwordx4 off, s[8:11], s37 offset:0  lds
    buffer_load_dwordx4 off, s[8:11], s37 offset:1024  lds
    buffer_load_dwordx4 off, s[8:11], s37 offset:2048  lds
    buffer_load_dwordx4 off, s[8:11], s37 offset:3072  lds
    s_add_u32 s37, s37, 4096
    s_add_u32 s31, s31, 16640
    s_cmp_eq_u32 s31, 66560
    s_cselect_b32 s31, 0, s31
    s_add_u32 m0, s31, 0
    s_nop 0
    buffer_load_dwordx4 off, s[8:11], s37 offset:0  lds
    buffer_load_dwordx4 off, s[8:11], s37 offset:1024  lds
    buffer_load_dwordx4 off, s[8:11], s37 offset:2048  lds
    buffer_load_dwordx4 off, s[8:11], s37 offset:3072  lds
    s_add_u32 s37, s37, 4096
    s_add_u32 m0, s31, 4096
    s_nop 0
    buffer_load_dwordx4 off, s[8:11], s37 offset:0  lds
    buffer_load_dwordx4 off, s[8:11], s37 offset:1024  lds
    buffer_load_dwordx4 off, s[8:11], s37 offset:2048  lds
    buffer_load_dwordx4 off, s[8:11], s37 offset:3072  lds
    s_add_u32 s37, s37, 4096
    s_add_u32 m0, s31, 8192
    s_nop 0
    buffer_load_dwordx4 off, s[8:11], s37 offset:0  lds
    buffer_load_dwordx4 off, s[8:11], s37 offset:1024  lds
    buffer_load_dwordx4 off, s[8:11], s37 offset:2048  lds
    buffer_load_dwordx4 off, s[8:11], s37 offset:3072  lds
    s_add_u32 s37, s37, 4096
    s_add_u32 m0, s31, 12288
    s_nop 0
    buffer_load_dwordx4 off, s[8:11], s37 offset:0  lds
    buffer_load_dwordx4 off, s[8:11], s37 offset:1024  lds
    buffer_load_dwordx4 off, s[8:11], s37 offset:2048  lds
    buffer_load_dwordx4 off, s[8:11], s37 offset:3072  lds
    s_add_u32 s37, s37, 4096
    s_add_u32 s31, s31, 16640
    s_cmp_eq_u32 s31, 66560
    s_cselect_b32 s31, 0, s31
    s_barrier
    s_waitcnt vmcnt(16)
    s_mov_b64 exec, 1
    ds_add_u32 v142, v143 offset:16384
    s_mov_b64 exec, -1
    s_add_u32 s86, s86, 16640
    s_cmp_eq_u32 s86, 66560
    s_cselect_b32 s86, 0, s86
    v_mov_b32 v142, s86
    s_add_u32 m0, s31, 0
    s_nop 0
    buffer_load_dwordx4 off, s[8:11], s37 offset:0  lds
    buffer_load_dwordx4 off, s[8:11], s37 offset:1024  lds
    buffer_load_dwordx4 off, s[8:11], s37 offset:2048  lds
    buffer_load_dwordx4 off, s[8:11], s37 offset:3072  lds
    s_add_u32 s37, s37, 4096
    s_add_u32 m0, s31, 4096
    s_nop 0
    buffer_load_dwordx4 off, s[8:11], s37 offset:0  lds
    buffer_load_dwordx4 off, s[8:11], s37 offset:1024  lds
    buffer_load_dwordx4 off, s[8:11], s37 offset:2048  lds
    buffer_load_dwordx4 off, s[8:11], s37 offset:3072  lds
    s_add_u32 s37, s37, 4096
    s_add_u32 m0, s31, 8192
    s_nop 0
    buffer_load_dwordx4 off, s[8:11], s37 offset:0  lds
    buffer_load_dwordx4 off, s[8:11], s37 offset:1024  lds
    buffer_load_dwordx4 off, s[8:11], s37 offset:2048  lds
    buffer_load_dwordx4 off, s[8:11], s37 offset:3072  lds
    s_add_u32 s37, s37, 4096
    s_add_u32 m0, s31, 12288
    s_nop 0
    buffer_load_dwordx4 off, s[8:11], s37 offset:0  lds
    buffer_load_dwordx4 off, s[8:11], s37 offset:1024  lds
    buffer_load_dwordx4 off, s[8:11], s37 offset:2048  lds
    buffer_load_dwordx4 off, s[8:11], s37 offset:3072  lds
    s_add_u32 s37, s37, 4096
    s_add_u32 s31, s31, 16640
    s_cmp_eq_u32 s31, 66560
    s_cselect_b32 s31, 0, s31
    s_waitcnt vmcnt(16)
    s_mov_b64 exec, 1
    ds_add_u32 v142, v143 offset:16384
    s_mov_b64 exec, -1
    s_add_u32 s86, s86, 16640
    s_cmp_eq_u32 s86, 66560
    s_cselect_b32 s86, 0, s86
    v_mov_b32 v142, s86
    ds_read_b32 v141, v140 offset:16388
    s_add_u32 m0, s31, 0
    s_nop 0
    buffer_load_dwordx4 off, s[8:11], s37 offset:0  lds
    buffer_load_dwordx4 off, s[8:11], s37 offset:1024  lds
    buffer_load_dwordx4 off, s[8:11], s37 offset:2048  lds
    buffer_load_dwordx4 off, s[8:11], s37 offset:3072  lds
    s_add_u32 s37, s37, 4096
    s_add_u32 m0, s31, 4096
    s_nop 0
    buffer_load_dwordx4 off, s[8:11], s37 offset:0  lds
    buffer_load_dwordx4 off, s[8:11], s37 offset:1024  lds
    buffer_load_dwordx4 off, s[8:11], s37 offset:2048  lds
    buffer_load_dwordx4 off, s[8:11], s37 offset:3072  lds
    s_add_u32 s37, s37, 4096
    s_add_u32 m0, s31, 8192
    s_nop 0
    buffer_load_dwordx4 off, s[8:11], s37 offset:0  lds
    buffer_load_dwordx4 off, s[8:11], s37 offset:1024  lds
    buffer_load_dwordx4 off, s[8:11], s37 offset:2048  lds
    buffer_load_dwordx4 off, s[8:11], s37 offset:3072  lds
    s_add_u32 s37, s37, 4096
    s_add_u32 m0, s31, 12288
    s_nop 0
    buffer_load_dwordx4 off, s[8:11], s37 offset:0  lds
    buffer_load_dwordx4 off, s[8:11], s37 offset:1024  lds
    buffer_load_dwordx4 off, s[8:11], s37 offset:2048  lds
    buffer_load_dwordx4 off, s[8:11], s37 offset:3072  lds
    s_add_u32 s37, s37, 4096
    s_add_u32 s31, s31, 16640
    s_cmp_eq_u32 s31, 66560
    s_cselect_b32 s31, 0, s31
    s_waitcnt vmcnt(16)
    s_mov_b64 exec, 1
    ds_add_u32 v142, v143 offset:16384
    s_mov_b64 exec, -1
    s_add_u32 s86, s86, 16640
    s_cmp_eq_u32 s86, 66560
    s_cselect_b32 s86, 0, s86
    v_mov_b32 v142, s86
    s_mov_b32 s30, 11
attn_kernel_r4_loop:
    s_waitcnt lgkmcnt(0)
    v_cmp_gt_u32 vcc, s85, v141
    s_cmp_eq_u32 s84, 0
    s_cbranch_vccz attn_kernel_r4_go
attn_kernel_r4_spin:
    s_sleep 4
    ds_read_b32 v141, v140 offset:16388
    s_waitcnt lgkmcnt(0)
    v_cmp_gt_u32 vcc, s85, v141
    s_nop 0
    s_cbranch_vccnz attn_kernel_r4_spin
attn_kernel_r4_go:
    s_cselect_b32 s87, 4, 0
    s_add_u32 s85, s85, s87
    s_add_u32 s84, s84, 16640
    s_cmp_eq_u32 s84, 66560
    s_cselect_b32 s84, 0, s84
    v_mov_b32 v140, s84
    ds_read_b32 v141, v140 offset:16388
    s_add_u32 m0, s31, 0
    s_nop 0
    buffer_load_dwordx4 off, s[8:11], s37 offset:0  lds
    buffer_load_dwordx4 off, s[8:11], s37 offset:1024  lds
    buffer_load_dwordx4 off, s[8:11], s37 offset:2048  lds
    buffer_load_dwordx4 off, s[8:11], s37 offset:3072  lds
    s_add_u32 s37, s37, 4096
    s_add_u32 m0, s31, 4096
    s_nop 0
    buffer_load_dwordx4 off, s[8:11], s37 offset:0  lds
    buffer_load_dwordx4 off, s[8:11], s37 offset:1024  lds
    buffer_load_dwordx4 off, s[8:11], s37 offset:2048  lds
    buffer_load_dwordx4 off, s[8:11], s37 offset:3072  lds
    s_add_u32 s37, s37, 4096
    s_add_u32 m0, s31, 8192
    s_nop 0
    buffer_load_dwordx4 off, s[8:11], s37 offset:0  lds
    buffer_load_dwordx4 off, s[8:11], s37 offset:1024  lds
    buffer_load_dwordx4 off, s[8:11], s37 offset:2048  lds
    buffer_load_dwordx4 off, s[8:11], s37 offset:3072  lds
    s_add_u32 s37, s37, 4096
    s_add_u32 m0, s31, 12288
    s_nop 0
    buffer_load_dwordx4 off, s[8:11], s37 offset:0  lds
    buffer_load_dwordx4 off, s[8:11], s37 offset:1024  lds
    buffer_load_dwordx4 off, s[8:11], s37 offset:2048  lds
    buffer_load_dwordx4 off, s[8:11], s37 offset:3072  lds
    s_add_u32 s37, s37, 4096
    s_add_u32 s31, s31, 16640
    s_cmp_eq_u32 s31, 66560
    s_cselect_b32 s31, 0, s31
    s_waitcnt vmcnt(16)
    s_mov_b64 exec, 1
    ds_add_u32 v142, v143 offset:16384
    s_mov_b64 exec, -1
    s_add_u32 s86, s86, 16640
    s_cmp_eq_u32 s86, 66560
    s_cselect_b32 s86, 0, s86
    v_mov_b32 v142, s86
    s_sub_u32 s30, s30, 1
    s_cmp_lg_u32 s30, 0
    s_cbranch_scc1 attn_kernel_r4_loop
    s_waitcnt lgkmcnt(0)
    v_cmp_gt_u32 vcc, s85, v141
    s_cmp_eq_u32 s84, 0
    s_cbranch_vccz attn_kernel_r15_go
attn_kernel_r15_spin:
    s_sleep 4
    ds_read_b32 v141, v140 offset:16388
    s_waitcnt lgkmcnt(0)
    v_cmp_gt_u32 vcc, s85, v141
    s_nop 0
    s_cbranch_vccnz attn_kernel_r15_spin
attn_kernel_r15_go:
    s_cselect_b32 s87, 4, 0
    s_add_u32 s85, s85, s87
    s_add_u32 s84, s84, 16640
    s_cmp_eq_u32 s84, 66560
    s_cselect_b32 s84, 0, s84
    v_mov_b32 v140, s84
    s_add_u32 m0, s31, 0
    s_nop 0
    buffer_load_dwordx4 off, s[8:11], s37 offset:0  lds
    buffer_load_dwordx4 off, s[8:11], s37 offset:1024  lds
    buffer_load_dwordx4 off, s[8:11], s37 offset:2048  lds
    buffer_load_dwordx4 off, s[8:11], s37 offset:3072  lds
    s_add_u32 s37, s37, 4096
    s_add_u32 m0, s31, 4096
    s_nop 0
    buffer_load_dwordx4 off, s[8:11], s37 offset:0  lds
    buffer_load_dwordx4 off, s[8:11], s37 offset:1024  lds
    buffer_load_dwordx4 off, s[8:11], s37 offset:2048  lds
    buffer_load_dwordx4 off, s[8:11], s37 offset:3072  lds
    s_add_u32 s37, s37, 4096
    s_add_u32 m0, s31, 8192
    s_nop 0
    buffer_load_dwordx4 off, s[8:11], s37 offset:0  lds
    buffer_load_dwordx4 off, s[8:11], s37 offset:1024  lds
    buffer_load_dwordx4 off, s[8:11], s37 offset:2048  lds
    buffer_load_dwordx4 off, s[8:11], s37 offset:3072  lds
    s_add_u32 s37, s37, 4096
    s_add_u32 m0, s31, 12288
    s_nop 0
    buffer_load_dwordx4 off, s[8:11], s37 offset:0  lds
    buffer_load_dwordx4 off, s[8:11], s37 offset:1024  lds
    buffer_load_dwordx4 off, s[8:11], s37 offset:2048  lds
    buffer_load_dwordx4 off, s[8:11], s37 offset:3072  lds
    s_add_u32 s37, s37, 4096
    s_add_u32 s31, s31, 16640
    s_cmp_eq_u32 s31, 66560
    s_cselect_b32 s31, 0, s31
    s_waitcnt vmcnt(16)
    s_mov_b64 exec, 1
    ds_add_u32 v142, v143 offset:16384
    s_mov_b64 exec, -1
    s_add_u32 s86, s86, 16640
    s_cmp_eq_u32 s86, 66560
    s_cselect_b32 s86, 0, s86
    v_mov_b32 v142, s86
    s_waitcnt vmcnt(0)
    s_mov_b64 exec, 1
    ds_add_u32 v142, v143 offset:16384
    s_mov_b64 exec, -1
    s_add_u32 s86, s86, 16640
    s_cmp_eq_u32 s86, 66560
    s_cselect_b32 s86, 0, s86
    v_mov_b32 v142, s86
    s_waitcnt vmcnt(0)
    s_mov_b64 exec, 1
    ds_add_u32 v142, v143 offset:16384
    s_mov_b64 exec, -1
    s_waitcnt lgkmcnt(0)
    s_branch mlp_ld
attn_kernel_side:
    s_barrier
    s_cmp_eq_u32 s3, 6
    s_cbranch_scc1 attn_kernel_side6
    s_cmp_eq_u32 s3, 7
    s_cbranch_scc1 attn_kernel_side7
    v_mov_b32 v28, 16640
attn_kernel_g1:
    ds_read_b32 v29, v28 offset:16384
    s_waitcnt lgkmcnt(0)
    v_cmp_gt_u32 vcc, 1, v29
    s_cbranch_vccz attn_kernel_h1
    s_sleep 16
    s_branch attn_kernel_g1
attn_kernel_h1:
    s_mul_i32 s42, s40, 458752
    s_mul_i32 s43, s41, 448
    s_add_u32 s42, s42, s43
    s_mov_b32 s43, 6720
    v_add_u32 v2, 0, v1
    v_mul_u32_u24 v3, 2341, v2
    v_lshrrev_b32 v3, 16, v3
    v_lshrrev_b32 v8, 1, v3
    v_and_b32 v8, 2, v8
    v_xor_b32 v2, v2, v8
    v_mul_lo_u32 v3, v3, s43
    v_lshl_add_u32 v3, v2, 4, v3
    v_add_u32 v8, s42, v3
    v_add_u32 v2, 64, v1
    v_mul_u32_u24 v3, 2341, v2
    v_lshrrev_b32 v3, 16, v3
    v_lshrrev_b32 v9, 1, v3
    v_and_b32 v9, 2, v9
    v_xor_b32 v2, v2, v9
    v_mul_lo_u32 v3, v3, s43
    v_lshl_add_u32 v3, v2, 4, v3
    v_add_u32 v9, s42, v3
    v_add_u32 v2, 128, v1
    v_mul_u32_u24 v3, 2341, v2
    v_lshrrev_b32 v3, 16, v3
    v_lshrrev_b32 v10, 1, v3
    v_and_b32 v10, 2, v10
    v_xor_b32 v2, v2, v10
    v_mul_lo_u32 v3, v3, s43
    v_lshl_add_u32 v3, v2, 4, v3
    v_add_u32 v10, s42, v3
    v_add_u32 v2, 192, v1
    v_mul_u32_u24 v3, 2341, v2
    v_lshrrev_b32 v3, 16, v3
    v_lshrrev_b32 v11, 1, v3
    v_and_b32 v11, 2, v11
    v_xor_b32 v2, v2, v11
    v_mul_lo_u32 v3, v3, s43
    v_lshl_add_u32 v3, v2, 4, v3
    v_add_u32 v11, s42, v3
    v_add_u32 v2, 256, v1
    v_mul_u32_u24 v3, 2341, v2
    v_lshrrev_b32 v3, 16, v3
    v_lshrrev_b32 v12, 1, v3
    v_and_b32 v12, 2, v12
    v_xor_b32 v2, v2, v12
    v_mul_lo_u32 v3, v3, s43
    v_lshl_add_u32 v3, v2, 4, v3
    v_add_u32 v12, s42, v3
    v_add_u32 v2, 320, v1
    v_mul_u32_u24 v3, 2341, v2
    v_lshrrev_b32 v3, 16, v3
    v_lshrrev_b32 v13, 1, v3
    v_and_b32 v13, 2, v13
    v_xor_b32 v2, v2, v13
    v_mul_lo_u32 v3, v3, s43
    v_lshl_add_u32 v3, v2, 4, v3
    v_add_u32 v13, s42, v3
    v_add_u32 v2, 384, v1
    v_mul_u32_u24 v3, 2341, v2
    v_lshrrev_b32 v3, 16, v3
    v_lshrrev_b32 v14, 1, v3
    v_and_b32 v14, 2, v14
    v_xor_b32 v2, v2, v14
    v_mul_lo_u32 v3, v3, s43
    v_lshl_add_u32 v3, v2, 4, v3
    v_add_u32 v14, s42, v3
    s_mov_b32 s42, 0
    s_mov_b32 m0, 66560
    s_nop 0
    buffer_load_dwordx4 v8, s[12:15], s42 offen lds
    s_mov_b32 m0, 67584
    s_nop 0
    buffer_load_dwordx4 v9, s[12:15], s42 offen lds
    s_mov_b32 m0, 68608
    s_nop 0
    buffer_load_dwordx4 v10, s[12:15], s42 offen lds
    s_mov_b32 m0, 69632
    s_nop 0
    buffer_load_dwordx4 v11, s[12:15], s42 offen lds
    s_mov_b32 m0, 70656
    s_nop 0
    buffer_load_dwordx4 v12, s[12:15], s42 offen lds
    s_mov_b32 m0, 71680
    s_nop 0
    buffer_load_dwordx4 v13, s[12:15], s42 offen lds
    s_mov_b32 m0, 72704
    s_nop 0
    buffer_load_dwordx4 v14, s[12:15], s42 offen lds
    s_add_u32 s42, s42, 114688
    s_mov_b32 m0, 73728
    s_nop 0
    buffer_load_dwordx4 v8, s[12:15], s42 offen lds
    s_mov_b32 m0, 74752
    s_nop 0
    buffer_load_dwordx4 v9, s[12:15], s42 offen lds
    s_mov_b32 m0, 75776
    s_nop 0
    buffer_load_dwordx4 v10, s[12:15], s42 offen lds
    s_mov_b32 m0, 76800
    s_nop 0
    buffer_load_dwordx4 v11, s[12:15], s42 offen lds
    s_mov_b32 m0, 77824
    s_nop 0
    buffer_load_dwordx4 v12, s[12:15], s42 offen lds
    s_mov_b32 m0, 78848
    s_nop 0
    buffer_load_dwordx4 v13, s[12:15], s42 offen lds
    s_mov_b32 m0, 79872
    s_nop 0
    buffer_load_dwordx4 v14, s[12:15], s42 offen lds
    s_add_u32 s42, s42, 114688
    s_waitcnt vmcnt(0)
    v_mov_b32 v28, 0
attn_kernel_g2:
    ds_read_b32 v29, v28 offset:16384
    s_waitcnt lgkmcnt(0)
    v_cmp_gt_u32 vcc, 2, v29
    s_cbranch_vccz attn_kernel_h2
    s_sleep 16
    s_branch attn_kernel_g2
attn_kernel_h2:
    v_lshrrev_b32 v2, 4, v1
    v_lshrrev_b32 v3, 2, v1
    v_and_b32 v3, 3, v3
    v_lshl_add_u32 v3, v2, 2, v3
    v_mul_u32_u24 v3, 448, v3
    v_and_b32 v5, 3, v1
    v_lshl_add_u32 v3, v5, 3, v3
    v_add_u32 v3, 66560, v3
    v_and_b32 v2, 1, v2
    v_lshlrev_b32 v2, 5, v2
    v_add_u32 v6, v3, v2
    v_sub_u32 v7, v3, v2
    v_mov_b32 v24, 0x3f803f80
    v_mov_b32 v25, 0x3f803f80
    v_mov_b32 v26, 0x3f803f80
    v_mov_b32 v27, 0x3f803f80
    s_mul_i32 s45, s40, 14336
    s_mul_i32 s46, s41, 896
    s_add_u32 s45, s45, s46
    s_add_u32 s45, s45, 38273024
    v_and_b32 v5, 15, v1
    v_lshlrev_b32 v5, 2, v5
    s_lshl_b32 s46, s41, 4
    s_add_u32 s46, s46, s40
    s_mul_i32 s46, s46, 28672
    s_add_u32 s46, s46, 50331648
    ds_read_b64_tr_b16 v[32:33], v6 offset:0
    ds_read_b64_tr_b16 v[34:35], v6 offset:7168
    ds_read_b64_tr_b16 v[36:37], v7 offset:32
    ds_read_b64_tr_b16 v[38:39], v7 offset:7200
    ds_read_b64_tr_b16 v[40:41], v6 offset:64
    ds_read_b64_tr_b16 v[42:43], v6 offset:7232
    ds_read_b64_tr_b16 v[44:45], v7 offset:96
    ds_read_b64_tr_b16 v[46:47], v7 offset:7264
    ds_read_b64_tr_b16 v[48:49], v6 offset:128
    ds_read_b64_tr_b16 v[50:51], v6 offset:7296
    ds_read_b64_tr_b16 v[52:53], v7 offset:160
    ds_read_b64_tr_b16 v[54:55], v7 offset:7328
    ds_read_b64_tr_b16 v[56:57], v6 offset:192
    ds_read_b64_tr_b16 v[58:59], v6 offset:7360
    ds_read_b64_tr_b16 v[60:61], v7 offset:224
    ds_read_b64_tr_b16 v[62:63], v7 offset:7392
    ds_read_b64_tr_b16 v[64:65], v6 offset:256
    ds_read_b64_tr_b16 v[66:67], v6 offset:7424
    ds_read_b64_tr_b16 v[68:69], v7 offset:288
    ds_read_b64_tr_b16 v[70:71], v7 offset:7456
    ds_read_b64_tr_b16 v[72:73], v6 offset:320
    ds_read_b64_tr_b16 v[74:75], v6 offset:7488
    ds_read_b64_tr_b16 v[76:77], v7 offset:352
    ds_read_b64_tr_b16 v[78:79], v7 offset:7520
    ds_read_b64_tr_b16 v[80:81], v6 offset:384
    ds_read_b64_tr_b16 v[82:83], v6 offset:7552
    ds_read_b64_tr_b16 v[84:85], v7 offset:416
    ds_read_b64_tr_b16 v[86:87], v7 offset:7584
    s_waitcnt lgkmcnt(0)
    v_mfma_f32_16x16x32_bf16 v[96:99], v[24:27], v[32:35], 0
    buffer_store_dwordx4 v[32:35], v4, s[16:19], s46 offen offset:0 sc1
    v_mfma_f32_16x16x32_bf16 v[100:103], v[24:27], v[36:39], 0
    buffer_store_dwordx4 v[36:39], v4, s[16:19], s46 offen offset:1024 sc1
    v_mfma_f32_16x16x32_bf16 v[104:107], v[24:27], v[40:43], 0
    buffer_store_dwordx4 v[40:43], v4, s[16:19], s46 offen offset:2048 sc1
    v_mfma_f32_16x16x32_bf16 v[108:111], v[24:27], v[44:47], 0
    buffer_store_dwordx4 v[44:47], v4, s[16:19], s46 offen offset:3072 sc1
    s_add_u32 s46, s46, 4096
    v_mfma_f32_16x16x32_bf16 v[112:115], v[24:27], v[48:51], 0
    buffer_store_dwordx4 v[48:51], v4, s[16:19], s46 offen offset:0 sc1
    v_mfma_f32_16x16x32_bf16 v[116:119], v[24:27], v[52:55], 0
    buffer_store_dwordx4 v[52:55], v4, s[16:19], s46 offen offset:1024 sc1
    v_mfma_f32_16x16x32_bf16 v[120:123], v[24:27], v[56:59], 0
    buffer_store_dwordx4 v[56:59], v4, s[16:19], s46 offen offset:2048 sc1
    v_mfma_f32_16x16x32_bf16 v[124:127], v[24:27], v[60:63], 0
    buffer_store_dwordx4 v[60:63], v4, s[16:19], s46 offen offset:3072 sc1
    s_add_u32 s46, s46, 4096
    v_mfma_f32_16x16x32_bf16 v[128:131], v[24:27], v[64:67], 0
    buffer_store_dwordx4 v[64:67], v4, s[16:19], s46 offen offset:0 sc1
    v_mfma_f32_16x16x32_bf16 v[132:135], v[24:27], v[68:71], 0
    buffer_store_dwordx4 v[68:71], v4, s[16:19], s46 offen offset:1024 sc1
    v_mfma_f32_16x16x32_bf16 v[136:139], v[24:27], v[72:75], 0
    buffer_store_dwordx4 v[72:75], v4, s[16:19], s46 offen offset:2048 sc1
    v_mfma_f32_16x16x32_bf16 v[140:143], v[24:27], v[76:79], 0
    buffer_store_dwordx4 v[76:79], v4, s[16:19], s46 offen offset:3072 sc1
    s_add_u32 s46, s46, 4096
    v_mfma_f32_16x16x32_bf16 v[144:147], v[24:27], v[80:83], 0
    buffer_store_dwordx4 v[80:83], v4, s[16:19], s46 offen offset:0 sc1
    v_mfma_f32_16x16x32_bf16 v[148:151], v[24:27], v[84:87], 0
    buffer_store_dwordx4 v[84:87], v4, s[16:19], s46 offen offset:1024 sc1
    s_add_u32 s46, s46, 2048
    v_mov_b32 v28, 49920
attn_kernel_g3:
    ds_read_b32 v29, v28 offset:16384
    s_waitcnt lgkmcnt(0)
    v_cmp_gt_u32 vcc, 3, v29
    s_cbranch_vccz attn_kernel_h3
    s_sleep 16
    s_branch attn_kernel_g3
attn_kernel_h3:
    s_mov_b32 m0, 80896
    s_nop 0
    buffer_load_dwordx4 v8, s[12:15], s42 offen lds
    s_mov_b32 m0, 81920
    s_nop 0
    buffer_load_dwordx4 v9, s[12:15], s42 offen lds
    s_mov_b32 m0, 82944
    s_nop 0
    buffer_load_dwordx4 v10, s[12:15], s42 offen lds
    s_mov_b32 m0, 83968
    s_nop 0
    buffer_load_dwordx4 v11, s[12:15], s42 offen lds
    s_mov_b32 m0, 84992
    s_nop 0
    buffer_load_dwordx4 v12, s[12:15], s42 offen lds
    s_mov_b32 m0, 86016
    s_nop 0
    buffer_load_dwordx4 v13, s[12:15], s42 offen lds
    s_mov_b32 m0, 87040
    s_nop 0
    buffer_load_dwordx4 v14, s[12:15], s42 offen lds
    s_add_u32 s42, s42, 114688
    s_mov_b32 m0, 88064
    s_nop 0
    buffer_load_dwordx4 v8, s[12:15], s42 offen lds
    s_mov_b32 m0, 89088
    s_nop 0
    buffer_load_dwordx4 v9, s[12:15], s42 offen lds
    s_mov_b32 m0, 90112
    s_nop 0
    buffer_load_dwordx4 v10, s[12:15], s42 offen lds
    s_mov_b32 m0, 91136
    s_nop 0
    buffer_load_dwordx4 v11, s[12:15], s42 offen lds
    s_mov_b32 m0, 92160
    s_nop 0
    buffer_load_dwordx4 v12, s[12:15], s42 offen lds
    s_mov_b32 m0, 93184
    s_nop 0
    buffer_load_dwordx4 v13, s[12:15], s42 offen lds
    s_mov_b32 m0, 94208
    s_nop 0
    buffer_load_dwordx4 v14, s[12:15], s42 offen lds
    s_add_u32 s42, s42, 114688
    s_waitcnt vmcnt(0)
    v_mov_b32 v28, 33280
attn_kernel_g4:
    ds_read_b32 v29, v28 offset:16384
    s_waitcnt lgkmcnt(0)
    v_cmp_gt_u32 vcc, 3, v29
    s_cbranch_vccz attn_kernel_h4
    s_sleep 16
    s_branch attn_kernel_g4
attn_kernel_h4:
    ds_read_b64_tr_b16 v[32:33], v6 offset:14336
    ds_read_b64_tr_b16 v[34:35], v6 offset:21504
    ds_read_b64_tr_b16 v[36:37], v7 offset:14368
    ds_read_b64_tr_b16 v[38:39], v7 offset:21536
    ds_read_b64_tr_b16 v[40:41], v6 offset:14400
    ds_read_b64_tr_b16 v[42:43], v6 offset:21568
    ds_read_b64_tr_b16 v[44:45], v7 offset:14432
    ds_read_b64_tr_b16 v[46:47], v7 offset:21600
    ds_read_b64_tr_b16 v[48:49], v6 offset:14464
    ds_read_b64_tr_b16 v[50:51], v6 offset:21632
    ds_read_b64_tr_b16 v[52:53], v7 offset:14496
    ds_read_b64_tr_b16 v[54:55], v7 offset:21664
    ds_read_b64_tr_b16 v[56:57], v6 offset:14528
    ds_read_b64_tr_b16 v[58:59], v6 offset:21696
    ds_read_b64_tr_b16 v[60:61], v7 offset:14560
    ds_read_b64_tr_b16 v[62:63], v7 offset:21728
    ds_read_b64_tr_b16 v[64:65], v6 offset:14592
    ds_read_b64_tr_b16 v[66:67], v6 offset:21760
    ds_read_b64_tr_b16 v[68:69], v7 offset:14624
    ds_read_b64_tr_b16 v[70:71], v7 offset:21792
    ds_read_b64_tr_b16 v[72:73], v6 offset:14656
    ds_read_b64_tr_b16 v[74:75], v6 offset:21824
    ds_read_b64_tr_b16 v[76:77], v7 offset:14688
    ds_read_b64_tr_b16 v[78:79], v7 offset:21856
    ds_read_b64_tr_b16 v[80:81], v6 offset:14720
    ds_read_b64_tr_b16 v[82:83], v6 offset:21888
    ds_read_b64_tr_b16 v[84:85], v7 offset:14752
    ds_read_b64_tr_b16 v[86:87], v7 offset:21920
    s_waitcnt lgkmcnt(0)
    v_mfma_f32_16x16x32_bf16 v[96:99], v[24:27], v[32:35], v[96:99]
    buffer_store_dwordx4 v[32:35], v4, s[16:19], s46 offen offset:0 sc1
    v_mfma_f32_16x16x32_bf16 v[100:103], v[24:27], v[36:39], v[100:103]
    buffer_store_dwordx4 v[36:39], v4, s[16:19], s46 offen offset:1024 sc1
    v_mfma_f32_16x16x32_bf16 v[104:107], v[24:27], v[40:43], v[104:107]
    buffer_store_dwordx4 v[40:43], v4, s[16:19], s46 offen offset:2048 sc1
    v_mfma_f32_16x16x32_bf16 v[108:111], v[24:27], v[44:47], v[108:111]
    buffer_store_dwordx4 v[44:47], v4, s[16:19], s46 offen offset:3072 sc1
    s_add_u32 s46, s46, 4096
    v_mfma_f32_16x16x32_bf16 v[112:115], v[24:27], v[48:51], v[112:115]
    buffer_store_dwordx4 v[48:51], v4, s[16:19], s46 offen offset:0 sc1
    v_mfma_f32_16x16x32_bf16 v[116:119], v[24:27], v[52:55], v[116:119]
    buffer_store_dwordx4 v[52:55], v4, s[16:19], s46 offen offset:1024 sc1
    v_mfma_f32_16x16x32_bf16 v[120:123], v[24:27], v[56:59], v[120:123]
    buffer_store_dwordx4 v[56:59], v4, s[16:19], s46 offen offset:2048 sc1
    v_mfma_f32_16x16x32_bf16 v[124:127], v[24:27], v[60:63], v[124:127]
    buffer_store_dwordx4 v[60:63], v4, s[16:19], s46 offen offset:3072 sc1
    s_add_u32 s46, s46, 4096
    v_mfma_f32_16x16x32_bf16 v[128:131], v[24:27], v[64:67], v[128:131]
    buffer_store_dwordx4 v[64:67], v4, s[16:19], s46 offen offset:0 sc1
    v_mfma_f32_16x16x32_bf16 v[132:135], v[24:27], v[68:71], v[132:135]
    buffer_store_dwordx4 v[68:71], v4, s[16:19], s46 offen offset:1024 sc1
    v_mfma_f32_16x16x32_bf16 v[136:139], v[24:27], v[72:75], v[136:139]
    buffer_store_dwordx4 v[72:75], v4, s[16:19], s46 offen offset:2048 sc1
    v_mfma_f32_16x16x32_bf16 v[140:143], v[24:27], v[76:79], v[140:143]
    buffer_store_dwordx4 v[76:79], v4, s[16:19], s46 offen offset:3072 sc1
    s_add_u32 s46, s46, 4096
    v_mfma_f32_16x16x32_bf16 v[144:147], v[24:27], v[80:83], v[144:147]
    buffer_store_dwordx4 v[80:83], v4, s[16:19], s46 offen offset:0 sc1
    v_mfma_f32_16x16x32_bf16 v[148:151], v[24:27], v[84:87], v[148:151]
    buffer_store_dwordx4 v[84:87], v4, s[16:19], s46 offen offset:1024 sc1
    s_add_u32 s46, s46, 2048
    s_nop 7
    s_mov_b64 exec, 0xffff
    buffer_store_dword v96, v5, s[16:19], s45 offen offset:0 sc1
    buffer_store_dword v100, v5, s[16:19], s45 offen offset:64 sc1
    buffer_store_dword v104, v5, s[16:19], s45 offen offset:128 sc1
    buffer_store_dword v108, v5, s[16:19], s45 offen offset:192 sc1
    buffer_store_dword v112, v5, s[16:19], s45 offen offset:256 sc1
    buffer_store_dword v116, v5, s[16:19], s45 offen offset:320 sc1
    buffer_store_dword v120, v5, s[16:19], s45 offen offset:384 sc1
    buffer_store_dword v124, v5, s[16:19], s45 offen offset:448 sc1
    buffer_store_dword v128, v5, s[16:19], s45 offen offset:512 sc1
    buffer_store_dword v132, v5, s[16:19], s45 offen offset:576 sc1
    buffer_store_dword v136, v5, s[16:19], s45 offen offset:640 sc1
    buffer_store_dword v140, v5, s[16:19], s45 offen offset:704 sc1
    buffer_store_dword v144, v5, s[16:19], s45 offen offset:768 sc1
    buffer_store_dword v148, v5, s[16:19], s45 offen offset:832 sc1
    s_mov_b64 exec, 1
    v_mov_b32 v2, 156684
    v_mov_b32 v3, 1
    ds_add_u32 v2, v3
    s_lshl_b32 s42, s41, 5
    s_add_u32 s42, s42, s40
    s_lshl_b32 s42, s42, 2
    s_add_u32 s42, s42, 39977984
    v_mov_b32 v5, 1
    s_waitcnt vmcnt(0)
    buffer_store_dword v5, off, s[16:19], s42 sc1
    s_mov_b64 exec, -1
    s_branch mlp_ld
attn_kernel_side6:
    v_mov_b32 v28, 33280
attn_kernel_g5:
    ds_read_b32 v29, v28 offset:16384
    s_waitcnt lgkmcnt(0)
    v_cmp_gt_u32 vcc, 1, v29
    s_cbranch_vccz attn_kernel_h5
    s_sleep 16
    s_branch attn_kernel_g5
attn_kernel_h5:
    v_lshrrev_b32 v2, 3, v1
    v_and_b32 v3, 6, v2
    v_and_b32 v15, 7, v1
    v_xor_b32 v3, v3, v15
    v_lshlrev_b32 v2, 11, v2
    v_lshl_add_u32 v15, v3, 4, v2
    s_mul_i32 s42, s40, 458752
    s_lshl_b32 s44, s41, 7
    s_add_u32 s42, s42, s44
    s_mov_b32 m0, 95232
    s_nop 0
    buffer_load_dwordx4 v15, s[24:27], s42 offen lds
    s_add_u32 s42, s42, 16384
    s_mov_b32 m0, 96256
    s_nop 0
    buffer_load_dwordx4 v15, s[24:27], s42 offen lds
    s_add_u32 s42, s42, 16384
    s_mov_b32 m0, 97280
    s_nop 0
    buffer_load_dwordx4 v15, s[24:27], s42 offen lds
    s_add_u32 s42, s42, 16384
    s_mov_b32 m0, 98304
    s_nop 0
    buffer_load_dwordx4 v15, s[24:27], s42 offen lds
    s_add_u32 s42, s42, 16384
    s_waitcnt vmcnt(0)
    v_lshrrev_b32 v2, 4, v1
    v_lshrrev_b32 v3, 2, v1
    v_and_b32 v3, 3, v3
    v_lshl_add_u32 v16, v2, 2, v3
    v_lshlrev_b32 v16, 7, v16
    v_and_b32 v17, 3, v1
    v_lshl_add_u32 v16, v17, 3, v16
    v_add_u32 v16, 95232, v16
    v_and_b32 v2, 1, v2
    v_lshrrev_b32 v3, 1, v3
    v_lshl_add_u32 v2, v2, 1, v3
    v_lshl_add_u32 v16, v2, 5, v16
    v_xor_b32 v17, 32, v16
    v_xor_b32 v18, 64, v16
    v_xor_b32 v19, 96, v16
    s_lshr_b32 s43, s41, 1
    s_mul_i32 s43, s43, 917504
    s_mul_i32 s44, s40, 57344
    s_add_u32 s43, s43, s44
    s_and_b32 s44, s41, 1
    s_lshl_b32 s44, s44, 12
    s_add_u32 s43, s43, s44
    s_add_u32 s43, s43, 58720256
    ds_read_b64_tr_b16 v[32:33], v16 offset:0
    ds_read_b64_tr_b16 v[34:35], v16 offset:2048
    ds_read_b64_tr_b16 v[36:37], v17 offset:0
    ds_read_b64_tr_b16 v[38:39], v17 offset:2048
    ds_read_b64_tr_b16 v[40:41], v18 offset:0
    ds_read_b64_tr_b16 v[42:43], v18 offset:2048
    ds_read_b64_tr_b16 v[44:45], v19 offset:0
    ds_read_b64_tr_b16 v[46:47], v19 offset:2048
    s_waitcnt lgkmcnt(0)
    buffer_store_dwordx4 v[32:35], v4, s[16:19], s43 offen offset:0 sc1
    buffer_store_dwordx4 v[36:39], v4, s[16:19], s43 offen offset:1024 sc1
    buffer_store_dwordx4 v[40:43], v4, s[16:19], s43 offen offset:2048 sc1
    buffer_store_dwordx4 v[44:47], v4, s[16:19], s43 offen offset:3072 sc1
    s_add_u32 s43, s43, 8192
    v_mov_b32 v28, 49920
attn_kernel_g6:
    ds_read_b32 v29, v28 offset:16384
    s_waitcnt lgkmcnt(0)
    v_cmp_gt_u32 vcc, 2, v29
    s_cbranch_vccz attn_kernel_h6
    s_sleep 16
    s_branch attn_kernel_g6
attn_kernel_h6:
    s_mov_b32 m0, 99328
    s_nop 0
    buffer_load_dwordx4 v15, s[24:27], s42 offen lds
    s_add_u32 s42, s42, 16384
    s_mov_b32 m0, 100352
    s_nop 0
    buffer_load_dwordx4 v15, s[24:27], s42 offen lds
    s_add_u32 s42, s42, 16384
    s_mov_b32 m0, 101376
    s_nop 0
    buffer_load_dwordx4 v15, s[24:27], s42 offen lds
    s_add_u32 s42, s42, 16384
    s_mov_b32 m0, 102400
    s_nop 0
    buffer_load_dwordx4 v15, s[24:27], s42 offen lds
    s_add_u32 s42, s42, 16384
    s_waitcnt vmcnt(0)
    ds_read_b64_tr_b16 v[32:33], v16 offset:4096
    ds_read_b64_tr_b16 v[34:35], v16 offset:6144
    ds_read_b64_tr_b16 v[36:37], v17 offset:4096
    ds_read_b64_tr_b16 v[38:39], v17 offset:6144
    ds_read_b64_tr_b16 v[40:41], v18 offset:4096
    ds_read_b64_tr_b16 v[42:43], v18 offset:6144
    ds_read_b64_tr_b16 v[44:45], v19 offset:4096
    ds_read_b64_tr_b16 v[46:47], v19 offset:6144
    s_waitcnt lgkmcnt(0)
    buffer_store_dwordx4 v[32:35], v4, s[16:19], s43 offen offset:0 sc1
    buffer_store_dwordx4 v[36:39], v4, s[16:19], s43 offen offset:1024 sc1
    buffer_store_dwordx4 v[40:43], v4, s[16:19], s43 offen offset:2048 sc1
    buffer_store_dwordx4 v[44:47], v4, s[16:19], s43 offen offset:3072 sc1
    s_add_u32 s43, s43, 8192
    v_mov_b32 v28, 16640
attn_kernel_g7:
    ds_read_b32 v29, v28 offset:16384
    s_waitcnt lgkmcnt(0)
    v_cmp_gt_u32 vcc, 2, v29
    s_cbranch_vccz attn_kernel_h7
    s_sleep 16
    s_branch attn_kernel_g7
attn_kernel_h7:
    s_mov_b32 m0, 103424
    s_nop 0
    buffer_load_dwordx4 v15, s[24:27], s42 offen lds
    s_add_u32 s42, s42, 16384
    s_mov_b32 m0, 104448
    s_nop 0
    buffer_load_dwordx4 v15, s[24:27], s42 offen lds
    s_add_u32 s42, s42, 16384
    s_mov_b32 m0, 105472
    s_nop 0
    buffer_load_dwordx4 v15, s[24:27], s42 offen lds
    s_add_u32 s42, s42, 16384
    s_mov_b32 m0, 106496
    s_nop 0
    buffer_load_dwordx4 v15, s[24:27], s42 offen lds
    s_add_u32 s42, s42, 16384
    s_waitcnt vmcnt(0)
    ds_read_b64_tr_b16 v[32:33], v16 offset:8192
    ds_read_b64_tr_b16 v[34:35], v16 offset:10240
    ds_read_b64_tr_b16 v[36:37], v17 offset:8192
    ds_read_b64_tr_b16 v[38:39], v17 offset:10240
    ds_read_b64_tr_b16 v[40:41], v18 offset:8192
    ds_read_b64_tr_b16 v[42:43], v18 offset:10240
    ds_read_b64_tr_b16 v[44:45], v19 offset:8192
    ds_read_b64_tr_b16 v[46:47], v19 offset:10240
    s_waitcnt lgkmcnt(0)
    buffer_store_dwordx4 v[32:35], v4, s[16:19], s43 offen offset:0 sc1
    buffer_store_dwordx4 v[36:39], v4, s[16:19], s43 offen offset:1024 sc1
    buffer_store_dwordx4 v[40:43], v4, s[16:19], s43 offen offset:2048 sc1
    buffer_store_dwordx4 v[44:47], v4, s[16:19], s43 offen offset:3072 sc1
    s_add_u32 s43, s43, 8192
    v_mov_b32 v28, 33280
attn_kernel_g8:
    ds_read_b32 v29, v28 offset:16384
    s_waitcnt lgkmcnt(0)
    v_cmp_gt_u32 vcc, 2, v29
    s_cbranch_vccz attn_kernel_h8
    s_sleep 16
    s_branch attn_kernel_g8
attn_kernel_h8:
    s_mov_b32 m0, 107520
    s_nop 0
    buffer_load_dwordx4 v15, s[24:27], s42 offen lds
    s_add_u32 s42, s42, 16384
    s_mov_b32 m0, 108544
    s_nop 0
    buffer_load_dwordx4 v15, s[24:27], s42 offen lds
    s_add_u32 s42, s42, 16384
    s_mov_b32 m0, 109568
    s_nop 0
    buffer_load_dwordx4 v15, s[24:27], s42 offen lds
    s_add_u32 s42, s42, 16384
    s_mov_b32 m0, 110592
    s_nop 0
    buffer_load_dwordx4 v15, s[24:27], s42 offen lds
    s_add_u32 s42, s42, 16384
    s_waitcnt vmcnt(0)
    ds_read_b64_tr_b16 v[32:33], v16 offset:12288
    ds_read_b64_tr_b16 v[34:35], v16 offset:14336
    ds_read_b64_tr_b16 v[36:37], v17 offset:12288
    ds_read_b64_tr_b16 v[38:39], v17 offset:14336
    ds_read_b64_tr_b16 v[40:41], v18 offset:12288
    ds_read_b64_tr_b16 v[42:43], v18 offset:14336
    ds_read_b64_tr_b16 v[44:45], v19 offset:12288
    ds_read_b64_tr_b16 v[46:47], v19 offset:14336
    s_waitcnt lgkmcnt(0)
    buffer_store_dwordx4 v[32:35], v4, s[16:19], s43 offen offset:0 sc1
    buffer_store_dwordx4 v[36:39], v4, s[16:19], s43 offen offset:1024 sc1
    buffer_store_dwordx4 v[40:43], v4, s[16:19], s43 offen offset:2048 sc1
    buffer_store_dwordx4 v[44:47], v4, s[16:19], s43 offen offset:3072 sc1
    s_add_u32 s43, s43, 8192
    v_mov_b32 v28, 0
attn_kernel_g9:
    ds_read_b32 v29, v28 offset:16384
    s_waitcnt lgkmcnt(0)
    v_cmp_gt_u32 vcc, 3, v29
    s_cbranch_vccz attn_kernel_h9
    s_sleep 16
    s_branch attn_kernel_g9
attn_kernel_h9:
    s_mov_b32 m0, 111616
    s_nop 0
    buffer_load_dwordx4 v15, s[24:27], s42 offen lds
    s_add_u32 s42, s42, 16384
    s_mov_b32 m0, 112640
    s_nop 0
    buffer_load_dwordx4 v15, s[24:27], s42 offen lds
    s_add_u32 s42, s42, 16384
    s_mov_b32 m0, 113664
    s_nop 0
    buffer_load_dwordx4 v15, s[24:27], s42 offen lds
    s_add_u32 s42, s42, 16384
    s_mov_b32 m0, 114688
    s_nop 0
    buffer_load_dwordx4 v15, s[24:27], s42 offen lds
    s_add_u32 s42, s42, 16384
    s_waitcnt vmcnt(0)
    ds_read_b64_tr_b16 v[32:33], v16 offset:16384
    ds_read_b64_tr_b16 v[34:35], v16 offset:18432
    ds_read_b64_tr_b16 v[36:37], v17 offset:16384
    ds_read_b64_tr_b16 v[38:39], v17 offset:18432
    ds_read_b64_tr_b16 v[40:41], v18 offset:16384
    ds_read_b64_tr_b16 v[42:43], v18 offset:18432
    ds_read_b64_tr_b16 v[44:45], v19 offset:16384
    ds_read_b64_tr_b16 v[46:47], v19 offset:18432
    s_waitcnt lgkmcnt(0)
    buffer_store_dwordx4 v[32:35], v4, s[16:19], s43 offen offset:0 sc1
    buffer_store_dwordx4 v[36:39], v4, s[16:19], s43 offen offset:1024 sc1
    buffer_store_dwordx4 v[40:43], v4, s[16:19], s43 offen offset:2048 sc1
    buffer_store_dwordx4 v[44:47], v4, s[16:19], s43 offen offset:3072 sc1
    s_add_u32 s43, s43, 8192
    v_mov_b32 v28, 16640
attn_kernel_g10:
    ds_read_b32 v29, v28 offset:16384
    s_waitcnt lgkmcnt(0)
    v_cmp_gt_u32 vcc, 3, v29
    s_cbranch_vccz attn_kernel_h10
    s_sleep 16
    s_branch attn_kernel_g10
attn_kernel_h10:
    s_mov_b32 m0, 115712
    s_nop 0
    buffer_load_dwordx4 v15, s[24:27], s42 offen lds
    s_add_u32 s42, s42, 16384
    s_mov_b32 m0, 116736
    s_nop 0
    buffer_load_dwordx4 v15, s[24:27], s42 offen lds
    s_add_u32 s42, s42, 16384
    s_mov_b32 m0, 117760
    s_nop 0
    buffer_load_dwordx4 v15, s[24:27], s42 offen lds
    s_add_u32 s42, s42, 16384
    s_mov_b32 m0, 118784
    s_nop 0
    buffer_load_dwordx4 v15, s[24:27], s42 offen lds
    s_add_u32 s42, s42, 16384
    s_waitcnt vmcnt(0)
    ds_read_b64_tr_b16 v[32:33], v16 offset:20480
    ds_read_b64_tr_b16 v[34:35], v16 offset:22528
    ds_read_b64_tr_b16 v[36:37], v17 offset:20480
    ds_read_b64_tr_b16 v[38:39], v17 offset:22528
    ds_read_b64_tr_b16 v[40:41], v18 offset:20480
    ds_read_b64_tr_b16 v[42:43], v18 offset:22528
    ds_read_b64_tr_b16 v[44:45], v19 offset:20480
    ds_read_b64_tr_b16 v[46:47], v19 offset:22528
    s_waitcnt lgkmcnt(0)
    buffer_store_dwordx4 v[32:35], v4, s[16:19], s43 offen offset:0 sc1
    buffer_store_dwordx4 v[36:39], v4, s[16:19], s43 offen offset:1024 sc1
    buffer_store_dwordx4 v[40:43], v4, s[16:19], s43 offen offset:2048 sc1
    buffer_store_dwordx4 v[44:47], v4, s[16:19], s43 offen offset:3072 sc1
    s_add_u32 s43, s43, 8192
    v_mov_b32 v28, 49920
attn_kernel_g11:
    ds_read_b32 v29, v28 offset:16384
    s_waitcnt lgkmcnt(0)
    v_cmp_gt_u32 vcc, 4, v29
    s_cbranch_vccz attn_kernel_h11
    s_sleep 16
    s_branch attn_kernel_g11
attn_kernel_h11:
    s_mov_b32 m0, 119808
    s_nop 0
    buffer_load_dwordx4 v15, s[24:27], s42 offen lds
    s_add_u32 s42, s42, 16384
    s_mov_b32 m0, 120832
    s_nop 0
    buffer_load_dwordx4 v15, s[24:27], s42 offen lds
    s_add_u32 s42, s42, 16384
    s_mov_b32 m0, 121856
    s_nop 0
    buffer_load_dwordx4 v15, s[24:27], s42 offen lds
    s_add_u32 s42, s42, 16384
    s_mov_b32 m0, 122880
    s_nop 0
    buffer_load_dwordx4 v15, s[24:27], s42 offen lds
    s_add_u32 s42, s42, 16384
    s_waitcnt vmcnt(0)
    ds_read_b64_tr_b16 v[32:33], v16 offset:24576
    ds_read_b64_tr_b16 v[34:35], v16 offset:26624
    ds_read_b64_tr_b16 v[36:37], v17 offset:24576
    ds_read_b64_tr_b16 v[38:39], v17 offset:26624
    ds_read_b64_tr_b16 v[40:41], v18 offset:24576
    ds_read_b64_tr_b16 v[42:43], v18 offset:26624
    ds_read_b64_tr_b16 v[44:45], v19 offset:24576
    ds_read_b64_tr_b16 v[46:47], v19 offset:26624
    s_waitcnt lgkmcnt(0)
    buffer_store_dwordx4 v[32:35], v4, s[16:19], s43 offen offset:0 sc1
    buffer_store_dwordx4 v[36:39], v4, s[16:19], s43 offen offset:1024 sc1
    buffer_store_dwordx4 v[40:43], v4, s[16:19], s43 offen offset:2048 sc1
    buffer_store_dwordx4 v[44:47], v4, s[16:19], s43 offen offset:3072 sc1
    s_add_u32 s43, s43, 8192
    s_mov_b64 exec, 1
    v_mov_b32 v2, 156684
    v_mov_b32 v3, 1
    ds_add_u32 v2, v3
    s_and_b32 s42, s41, 14
    s_lshr_b32 s43, s40, 3
    s_add_u32 s42, s42, s43
    s_lshl_b32 s42, s42, 4
    s_and_b32 s43, s40, 7
    s_add_u32 s42, s42, s43
    s_lshl_b32 s42, s42, 1
    s_and_b32 s43, s41, 1
    s_add_u32 s42, s42, s43
    s_lshl_b32 s42, s42, 2
    s_add_u32 s42, s42, 39980032
    v_mov_b32 v5, 1
    s_waitcnt vmcnt(0)
    buffer_store_dword v5, off, s[16:19], s42 sc1
    s_mov_b64 exec, -1
    s_branch mlp_ld
attn_kernel_side7:
    v_mov_b32 v28, 0
attn_kernel_g12:
    ds_read_b32 v29, v28 offset:16384
    s_waitcnt lgkmcnt(0)
    v_cmp_gt_u32 vcc, 2, v29
    s_cbranch_vccz attn_kernel_h12
    s_sleep 16
    s_branch attn_kernel_g12
attn_kernel_h12:
    v_lshrrev_b32 v2, 3, v1
    v_and_b32 v3, 6, v2
    v_and_b32 v15, 7, v1
    v_xor_b32 v3, v3, v15
    v_lshlrev_b32 v2, 11, v2
    v_lshl_add_u32 v15, v3, 4, v2
    s_mul_i32 s42, s40, 131072
    s_lshl_b32 s44, s41, 7
    s_add_u32 s42, s42, s44
    s_mov_b32 m0, 123904
    s_nop 0
    buffer_load_dwordx4 v15, s[20:23], s42 offen lds
    s_add_u32 s42, s42, 16384
    s_mov_b32 m0, 124928
    s_nop 0
    buffer_load_dwordx4 v15, s[20:23], s42 offen lds
    s_add_u32 s42, s42, 16384
    s_mov_b32 m0, 125952
    s_nop 0
    buffer_load_dwordx4 v15, s[20:23], s42 offen lds
    s_add_u32 s42, s42, 16384
    s_mov_b32 m0, 126976
    s_nop 0
    buffer_load_dwordx4 v15, s[20:23], s42 offen lds
    s_add_u32 s42, s42, 16384
    s_waitcnt vmcnt(0)
    v_lshrrev_b32 v2, 4, v1
    v_lshrrev_b32 v3, 2, v1
    v_and_b32 v3, 3, v3
    v_lshl_add_u32 v16, v2, 2, v3
    v_lshrrev_b32 v17, 1, v2
    v_lshl_add_u32 v16, v17, 3, v16
    v_lshlrev_b32 v16, 7, v16
    v_and_b32 v17, 3, v1
    v_lshl_add_u32 v16, v17, 3, v16
    v_add_u32 v16, 123904, v16
    v_and_b32 v2, 1, v2
    v_lshrrev_b32 v3, 1, v3
    v_lshl_add_u32 v2, v2, 1, v3
    v_lshl_add_u32 v16, v2, 5, v16
    v_xor_b32 v17, 32, v16
    v_xor_b32 v18, 64, v16
    v_xor_b32 v19, 96, v16
    s_lshr_b32 s43, s41, 1
    s_mul_i32 s43, s43, 262144
    s_mul_i32 s44, s40, 16384
    s_add_u32 s43, s43, s44
    s_and_b32 s44, s41, 1
    s_lshl_b32 s44, s44, 12
    s_add_u32 s43, s43, s44
    s_add_u32 s43, s43, 46137344
    ds_read_b64_tr_b16 v[32:33], v16 offset:0
    ds_read_b64_tr_b16 v[34:35], v16 offset:1024
    ds_read_b64_tr_b16 v[36:37], v17 offset:0
    ds_read_b64_tr_b16 v[38:39], v17 offset:1024
    ds_read_b64_tr_b16 v[40:41], v18 offset:0
    ds_read_b64_tr_b16 v[42:43], v18 offset:1024
    ds_read_b64_tr_b16 v[44:45], v19 offset:0
    ds_read_b64_tr_b16 v[46:47], v19 offset:1024
    s_waitcnt lgkmcnt(0)
    buffer_store_dwordx4 v[32:35], v4, s[16:19], s43 offen offset:0 sc1
    buffer_store_dwordx4 v[36:39], v4, s[16:19], s43 offen offset:1024 sc1
    buffer_store_dwordx4 v[40:43], v4, s[16:19], s43 offen offset:2048 sc1
    buffer_store_dwordx4 v[44:47], v4, s[16:19], s43 offen offset:3072 sc1
    s_add_u32 s43, s43, 8192
    v_mov_b32 v28, 0
attn_kernel_g13:
    ds_read_b32 v29, v28 offset:16384
    s_waitcnt lgkmcnt(0)
    v_cmp_gt_u32 vcc, 3, v29
    s_cbranch_vccz attn_kernel_h13
    s_sleep 16
    s_branch attn_kernel_g13
attn_kernel_h13:
    s_mov_b32 m0, 128000
    s_nop 0
    buffer_load_dwordx4 v15, s[20:23], s42 offen lds
    s_add_u32 s42, s42, 16384
    s_mov_b32 m0, 129024
    s_nop 0
    buffer_load_dwordx4 v15, s[20:23], s42 offen lds
    s_add_u32 s42, s42, 16384
    s_mov_b32 m0, 130048
    s_nop 0
    buffer_load_dwordx4 v15, s[20:23], s42 offen lds
    s_add_u32 s42, s42, 16384
    s_mov_b32 m0, 131072
    s_nop 0
    buffer_load_dwordx4 v15, s[20:23], s42 offen lds
    s_add_u32 s42, s42, 16384
    s_waitcnt vmcnt(0)
    ds_read_b64_tr_b16 v[32:33], v16 offset:4096
    ds_read_b64_tr_b16 v[34:35], v16 offset:5120
    ds_read_b64_tr_b16 v[36:37], v17 offset:4096
    ds_read_b64_tr_b16 v[38:39], v17 offset:5120
    ds_read_b64_tr_b16 v[40:41], v18 offset:4096
    ds_read_b64_tr_b16 v[42:43], v18 offset:5120
    ds_read_b64_tr_b16 v[44:45], v19 offset:4096
    ds_read_b64_tr_b16 v[46:47], v19 offset:5120
    s_waitcnt lgkmcnt(0)
    buffer_store_dwordx4 v[32:35], v4, s[16:19], s43 offen offset:0 sc1
    buffer_store_dwordx4 v[36:39], v4, s[16:19], s43 offen offset:1024 sc1
    buffer_store_dwordx4 v[40:43], v4, s[16:19], s43 offen offset:2048 sc1
    buffer_store_dwordx4 v[44:47], v4, s[16:19], s43 offen offset:3072 sc1
    s_add_u32 s43, s43, 8192
    s_mov_b64 exec, 1
    v_mov_b32 v2, 156684
    v_mov_b32 v3, 1
    ds_add_u32 v2, v3
    s_lshr_b32 s42, s41, 1
    s_lshl_b32 s42, s42, 4
    s_add_u32 s42, s42, s40
    s_lshl_b32 s42, s42, 1
    s_and_b32 s43, s41, 1
    s_add_u32 s42, s42, s43
    s_lshl_b32 s42, s42, 2
    s_add_u32 s42, s42, 39976960
    v_mov_b32 v5, 1
    s_waitcnt vmcnt(0)
    buffer_store_dword v5, off, s[16:19], s42 sc1
    s_mov_b64 exec, -1
    s_branch mlp_ld
attn_kernel_end:
    s_endpgm
attn_kernel_comp:
    v_min_u32 v5, 3, v1
    v_mul_u32_u24 v5, 16640, v5
    v_mov_b32 v6, 0
    v_mov_b32 v7, 0
    ds_write_b64 v5, v[6:7] offset:16384
    v_mov_b32 v5, 156672
    ds_write_b64 v5, v[6:7]
    ds_write_b64 v5, v[6:7] offset:8
    ds_write_b64 v5, v[6:7] offset:16
    ds_write_b64 v5, v[6:7] offset:24
    s_lshl_b32 s34, s28, 6
    s_lshl_b32 s35, s29, 3
    s_add_u32 s34, s34, s35
    s_lshl_b32 s35, s3, 1
    s_add_u32 s34, s34, s35
    s_lshl_b32 s34, s34, 11
    s_add_u32 s34, s34, 0
    s_waitcnt lgkmcnt(0)
    s_barrier
    buffer_load_dwordx4 v[128:131], v4, s[16:19], s34 offen offset:0
    buffer_load_dwordx4 v[132:135], v4, s[16:19], s34 offen offset:1024
    buffer_load_dwordx4 v[136:139], v4, s[16:19], s34 offen offset:2048
    buffer_load_dwordx4 v[140:143], v4, s[16:19], s34 offen offset:3072
    v_and_b32 v5, 4, v1
    v_cmp_eq_u32 vcc, 0, v5
    v_mov_b32 v6, 0x3f803f80
    v_and_b32 v5, 1, v1
    v_cndmask_b32 v168, 0, v6, vcc
    v_xor_b32 v170, v168, v6
    v_mov_b32 v169, v168
    v_mov_b32 v171, v170
    v_cmp_eq_u32 vcc, 0, v5
    v_mov_b32 v6, 0x44444444
    v_mov_b32 v7, 0xeeeeeeee
    v_cndmask_b32 v172, v7, v6, vcc
    v_mov_b32 v80, 0
    v_mov_b32 v81, 0
    v_mov_b32 v82, 0
    v_mov_b32 v83, 0
    v_mov_b32 v84, 0
    v_mov_b32 v85, 0
    v_mov_b32 v86, 0
    v_mov_b32 v87, 0
    v_mov_b32 v88, 0
    v_mov_b32 v89, 0
    v_mov_b32 v90, 0
    v_mov_b32 v91, 0
    v_mov_b32 v92, 0
    v_mov_b32 v93, 0
    v_mov_b32 v94, 0
    v_mov_b32 v95, 0
    v_mov_b32 v96, 0
    v_mov_b32 v97, 0
    v_mov_b32 v98, 0
    v_mov_b32 v99, 0
    v_mov_b32 v100, 0
    v_mov_b32 v101, 0
    v_mov_b32 v102, 0
    v_mov_b32 v103, 0
    v_mov_b32 v104, 0
    v_mov_b32 v105, 0
    v_mov_b32 v106, 0
    v_mov_b32 v107, 0
    v_mov_b32 v108, 0
    v_mov_b32 v109, 0
    v_mov_b32 v110, 0
    v_mov_b32 v111, 0
    v_mov_b32 v144, 0
    v_mov_b32 v145, 0
    v_mov_b32 v146, 0
    v_mov_b32 v147, 0
    v_mov_b32 v148, 0
    v_mov_b32 v149, 0
    v_mov_b32 v150, 0
    v_mov_b32 v151, 0
    v_mov_b32 v120, 0
    v_mov_b32 v121, 0
    v_mov_b32 v122, 0
    v_mov_b32 v123, 0
    v_mov_b32 v124, 0
    v_mov_b32 v125, 0
    v_mov_b32 v126, 0
    v_mov_b32 v127, 0
    v_mov_b32 v184, 0
    v_mov_b32 v185, 0
    v_mov_b32 v186, 0
    v_mov_b32 v187, 0
    v_mov_b32 v188, 0
    v_mov_b32 v189, 0
    v_mov_b32 v190, 0
    v_mov_b32 v191, 0
    v_mov_b32 v2, v4
    v_add_u32 v3, 49920, v4
    s_mov_b32 s31, 16640
    s_mov_b32 s30, 16
    s_mov_b32 s52, 1
    v_mov_b32 v10, 1
attn_kernel_spin0:
    ds_read_b32 v9, v3 offset:16384
    s_waitcnt lgkmcnt(0)
    v_readfirstlane_b32 s53, v9
    s_nop 0
    s_cmp_lt_u32 s53, s52
    s_cbranch_scc1 attn_kernel_spin0
    v_mov_b32 v3, v4
    ds_read_b128 v[152:155], v2 offset:0
    ds_read_b128 v[156:159], v2 offset:1024
    ds_read_b128 v[176:179], v2 offset:4096
    ds_read_b128 v[180:183], v2 offset:5120
    ds_read_b128 v[160:163], v2 offset:2048
    ds_read_b128 v[164:167], v2 offset:3072
    s_waitcnt vmcnt(0) lgkmcnt(4)
    v_mfma_f32_32x32x16_bf16 v[16:31], v[152:155], v[128:131], 0
    v_mfma_f32_32x32x16_bf16 v[16:31], v[156:159], v[132:135], v[16:31]
    v_mfma_f32_32x32x16_bf16 v[32:47], v[152:155], v[136:139], 0
    v_mfma_f32_32x32x16_bf16 v[32:47], v[156:159], v[140:143], v[32:47]
    s_nop 7
    s_nop 3
    v_max3_f32 v5, v16, v17, v18
    v_max_f32 v5, v5, v31
    v_max3_f32 v5, v5, v19, v20
    v_max3_f32 v5, v5, v21, v22
    v_max3_f32 v5, v5, v23, v24
    v_max3_f32 v5, v5, v25, v26
    v_max3_f32 v5, v5, v27, v28
    v_max3_f32 v5, v5, v29, v30
    v_mov_b32 v7, v5
    s_nop 1
    v_permlane32_swap_b32 v5, v7
    v_max_f32 v5, v5, v7
    v_sub_f32 v48, 0, v5
    v_sub_f32 v49, 0, v5
    v_sub_f32 v50, 0, v5
    v_sub_f32 v51, 0, v5
    v_sub_f32 v52, 0, v5
    v_sub_f32 v53, 0, v5
    v_sub_f32 v54, 0, v5
    v_sub_f32 v55, 0, v5
    v_sub_f32 v56, 0, v5
    v_sub_f32 v57, 0, v5
    v_sub_f32 v58, 0, v5
    v_sub_f32 v59, 0, v5
    v_sub_f32 v60, 0, v5
    v_sub_f32 v61, 0, v5
    v_sub_f32 v62, 0, v5
    v_sub_f32 v63, 0, v5
    s_nop 1
    v_mfma_f32_32x32x16_bf16 v[16:31], v[152:155], v[128:131], v[48:63]
    v_mfma_f32_32x32x16_bf16 v[16:31], v[156:159], v[132:135], v[16:31]
    v_max3_f32 v6, v32, v33, v34
    v_max_f32 v6, v6, v47
    v_max3_f32 v6, v6, v35, v36
    v_max3_f32 v6, v6, v37, v38
    v_max3_f32 v6, v6, v39, v40
    v_max3_f32 v6, v6, v41, v42
    v_max3_f32 v6, v6, v43, v44
    v_max3_f32 v6, v6, v45, v46
    v_mov_b32 v7, v6
    s_nop 1
    v_permlane32_swap_b32 v6, v7
    v_max_f32 v6, v6, v7
    v_sub_f32 v64, 0, v6
    v_sub_f32 v65, 0, v6
    v_sub_f32 v66, 0, v6
    v_sub_f32 v67, 0, v6
    v_sub_f32 v68, 0, v6
    v_sub_f32 v69, 0, v6
    v_sub_f32 v70, 0, v6
    v_sub_f32 v71, 0, v6
    v_sub_f32 v72, 0, v6
    v_sub_f32 v73, 0, v6
    v_sub_f32 v74, 0, v6
    v_sub_f32 v75, 0, v6
    v_sub_f32 v76, 0, v6
    v_sub_f32 v77, 0, v6
    v_sub_f32 v78, 0, v6
    v_sub_f32 v79, 0, v6
    s_nop 1
.p2align 6
    s_nop 0
    s_nop 0
    s_nop 0
    s_nop 0
attn_kernel_loop:
    v_mfma_f32_32x32x16_bf16 v[32:47], v[152:155], v[136:139], v[64:79]
    v_exp_f32 v16, v16
    v_exp_f32 v17, v17
    v_exp_f32 v18, v18
    v_exp_f32 v19, v19
    v_mfma_f32_32x32x16_bf16 v[32:47], v[156:159], v[140:143], v[32:47]
    v_exp_f32 v20, v20
    v_exp_f32 v21, v21
    v_exp_f32 v22, v22
    v_exp_f32 v23, v23
    v_mfma_f32_32x32x16_bf16 v[96:111], v[184:187], v[120:123], v[96:111]
    v_cvt_pk_bf16_f32 v112, v16, v17
    v_cvt_pk_bf16_f32 v113, v18, v19
    v_cvt_pk_bf16_f32 v114, v20, v21
    v_cvt_pk_bf16_f32 v115, v22, v23
    v_exp_f32 v24, v24
    v_exp_f32 v25, v25
    v_mfma_f32_32x32x16_bf16 v[96:111], v[188:191], v[124:127], v[96:111]
    s_waitcnt lgkmcnt(0)
    v_exp_f32 v26, v26
    v_exp_f32 v27, v27
    v_exp_f32 v28, v28
    v_exp_f32 v29, v29
    v_smfmac_f32_16x16x64_bf16 v[148:151], v[168:171], v[120:127], v172
    v_exp_f32 v30, v30
    v_exp_f32 v31, v31
    v_cvt_pk_bf16_f32 v116, v24, v25
    v_cvt_pk_bf16_f32 v117, v26, v27
    v_cvt_pk_bf16_f32 v118, v28, v29
    v_cvt_pk_bf16_f32 v119, v30, v31
    v_mfma_f32_32x32x16_bf16 v[16:31], v[176:179], v[128:131], v[48:63]
    ds_read_b128 v[152:155], v2 offset:8192
    v_exp_f32 v32, v32
    v_exp_f32 v33, v33
    v_exp_f32 v34, v34
    v_exp_f32 v35, v35
    v_mfma_f32_32x32x16_bf16 v[16:31], v[180:183], v[132:135], v[16:31]
    ds_read_b128 v[156:159], v2 offset:9216
    v_exp_f32 v36, v36
    v_exp_f32 v37, v37
    v_exp_f32 v38, v38
    v_exp_f32 v39, v39
    v_mfma_f32_32x32x16_bf16 v[80:95], v[160:163], v[112:115], v[80:95]
    ds_read_b128 v[184:187], v3 offset:6144
    v_cvt_pk_bf16_f32 v120, v32, v33
    v_cvt_pk_bf16_f32 v121, v34, v35
    v_cvt_pk_bf16_f32 v122, v36, v37
    v_cvt_pk_bf16_f32 v123, v38, v39
    v_exp_f32 v40, v40
    v_exp_f32 v41, v41
    v_mfma_f32_32x32x16_bf16 v[80:95], v[164:167], v[116:119], v[80:95]
    ds_read_b128 v[188:191], v3 offset:7168
    v_exp_f32 v42, v42
    v_exp_f32 v43, v43
    v_exp_f32 v44, v44
    v_exp_f32 v45, v45
    v_smfmac_f32_16x16x64_bf16 v[144:147], v[168:171], v[112:119], v172
    v_exp_f32 v46, v46
    v_exp_f32 v47, v47
    v_cvt_pk_bf16_f32 v124, v40, v41
    v_cvt_pk_bf16_f32 v125, v42, v43
    v_cvt_pk_bf16_f32 v126, v44, v45
    v_cvt_pk_bf16_f32 v127, v46, v47
    v_mfma_f32_32x32x16_bf16 v[32:47], v[176:179], v[136:139], v[64:79]
    v_exp_f32 v16, v16
    v_exp_f32 v17, v17
    v_exp_f32 v18, v18
    v_exp_f32 v19, v19
    v_mfma_f32_32x32x16_bf16 v[32:47], v[180:183], v[140:143], v[32:47]
    v_exp_f32 v20, v20
    v_exp_f32 v21, v21
    v_exp_f32 v22, v22
    v_exp_f32 v23, v23
    v_mfma_f32_32x32x16_bf16 v[96:111], v[160:163], v[120:123], v[96:111]
    v_cvt_pk_bf16_f32 v112, v16, v17
    v_cvt_pk_bf16_f32 v113, v18, v19
    v_cvt_pk_bf16_f32 v114, v20, v21
    v_cvt_pk_bf16_f32 v115, v22, v23
    v_exp_f32 v24, v24
    v_exp_f32 v25, v25
    v_mfma_f32_32x32x16_bf16 v[96:111], v[164:167], v[124:127], v[96:111]
    s_waitcnt lgkmcnt(0)
    v_exp_f32 v26, v26
    v_exp_f32 v27, v27
    v_exp_f32 v28, v28
    v_exp_f32 v29, v29
    v_smfmac_f32_16x16x64_bf16 v[148:151], v[168:171], v[120:127], v172
    v_exp_f32 v30, v30
    v_exp_f32 v31, v31
    v_cvt_pk_bf16_f32 v116, v24, v25
    v_cvt_pk_bf16_f32 v117, v26, v27
    v_cvt_pk_bf16_f32 v118, v28, v29
    v_cvt_pk_bf16_f32 v119, v30, v31
    v_mfma_f32_32x32x16_bf16 v[16:31], v[152:155], v[128:131], v[48:63]
    ds_read_b128 v[176:179], v2 offset:12288
    v_exp_f32 v32, v32
    v_exp_f32 v33, v33
    v_exp_f32 v34, v34
    v_exp_f32 v35, v35
    v_mfma_f32_32x32x16_bf16 v[16:31], v[156:159], v[132:135], v[16:31]
    ds_read_b128 v[180:183], v2 offset:13312
    v_exp_f32 v36, v36
    v_exp_f32 v37, v37
    v_exp_f32 v38, v38
    v_exp_f32 v39, v39
    v_mfma_f32_32x32x16_bf16 v[80:95], v[184:187], v[112:115], v[80:95]
    ds_read_b128 v[160:163], v3 offset:10240
    v_cvt_pk_bf16_f32 v120, v32, v33
    v_cvt_pk_bf16_f32 v121, v34, v35
    v_cvt_pk_bf16_f32 v122, v36, v37
    v_cvt_pk_bf16_f32 v123, v38, v39
    v_exp_f32 v40, v40
    v_exp_f32 v41, v41
    v_mfma_f32_32x32x16_bf16 v[80:95], v[188:191], v[116:119], v[80:95]
    ds_read_b128 v[164:167], v3 offset:11264
    v_exp_f32 v42, v42
    v_exp_f32 v43, v43
    v_exp_f32 v44, v44
    v_exp_f32 v45, v45
    v_smfmac_f32_16x16x64_bf16 v[144:147], v[168:171], v[112:119], v172
    ds_read_b32 v9, v3 offset:16384
    v_exp_f32 v46, v46
    v_exp_f32 v47, v47
    v_cvt_pk_bf16_f32 v124, v40, v41
    v_cvt_pk_bf16_f32 v125, v42, v43
    v_cvt_pk_bf16_f32 v126, v44, v45
    v_cvt_pk_bf16_f32 v127, v46, v47
    v_mfma_f32_32x32x16_bf16 v[32:47], v[152:155], v[136:139], v[64:79]
    v_add_u32 v2, s31, v4
    v_exp_f32 v16, v16
    v_exp_f32 v17, v17
    v_exp_f32 v18, v18
    v_exp_f32 v19, v19
    v_mfma_f32_32x32x16_bf16 v[32:47], v[156:159], v[140:143], v[32:47]
    v_exp_f32 v20, v20
    v_exp_f32 v21, v21
    v_exp_f32 v22, v22
    v_exp_f32 v23, v23
    v_mfma_f32_32x32x16_bf16 v[96:111], v[184:187], v[120:123], v[96:111]
    v_cvt_pk_bf16_f32 v112, v16, v17
    v_cvt_pk_bf16_f32 v113, v18, v19
    v_cvt_pk_bf16_f32 v114, v20, v21
    v_cvt_pk_bf16_f32 v115, v22, v23
    v_exp_f32 v24, v24
    v_exp_f32 v25, v25
    v_mfma_f32_32x32x16_bf16 v[96:111], v[188:191], v[124:127], v[96:111]
    s_waitcnt lgkmcnt(0)
    v_exp_f32 v26, v26
    v_exp_f32 v27, v27
    v_exp_f32 v28, v28
    v_exp_f32 v29, v29
    v_smfmac_f32_16x16x64_bf16 v[148:151], v[168:171], v[120:127], v172
    v_readfirstlane_b32 s53, v9
    v_exp_f32 v30, v30
    v_exp_f32 v31, v31
    v_cvt_pk_bf16_f32 v116, v24, v25
    v_cvt_pk_bf16_f32 v117, v26, v27
    v_cvt_pk_bf16_f32 v118, v28, v29
    v_cvt_pk_bf16_f32 v119, v30, v31
    v_mfma_f32_32x32x16_bf16 v[16:31], v[176:179], v[128:131], v[48:63]
    s_cmp_lt_u32 s53, s52
    s_cbranch_scc1 attn_kernel_spin
attn_kernel_back:
    ds_read_b128 v[152:155], v2 offset:0
    v_exp_f32 v32, v32
    v_exp_f32 v33, v33
    v_exp_f32 v34, v34
    v_exp_f32 v35, v35
    v_mfma_f32_32x32x16_bf16 v[16:31], v[180:183], v[132:135], v[16:31]
    ds_read_b128 v[156:159], v2 offset:1024
    v_exp_f32 v36, v36
    v_exp_f32 v37, v37
    v_exp_f32 v38, v38
    v_exp_f32 v39, v39
    v_mfma_f32_32x32x16_bf16 v[80:95], v[160:163], v[112:115], v[80:95]
    ds_read_b128 v[184:187], v3 offset:14336
    v_cvt_pk_bf16_f32 v120, v32, v33
    v_cvt_pk_bf16_f32 v121, v34, v35
    v_cvt_pk_bf16_f32 v122, v36, v37
    v_cvt_pk_bf16_f32 v123, v38, v39
    v_exp_f32 v40, v40
    v_exp_f32 v41, v41
    v_mfma_f32_32x32x16_bf16 v[80:95], v[164:167], v[116:119], v[80:95]
    ds_read_b128 v[188:191], v3 offset:15360
    v_exp_f32 v42, v42
    v_exp_f32 v43, v43
    v_exp_f32 v44, v44
    v_exp_f32 v45, v45
    v_smfmac_f32_16x16x64_bf16 v[144:147], v[168:171], v[112:119], v172
    v_exp_f32 v46, v46
    v_exp_f32 v47, v47
    v_cvt_pk_bf16_f32 v124, v40, v41
    v_cvt_pk_bf16_f32 v125, v42, v43
    v_cvt_pk_bf16_f32 v126, v44, v45
    v_cvt_pk_bf16_f32 v127, v46, v47
    v_mfma_f32_32x32x16_bf16 v[32:47], v[176:179], v[136:139], v[64:79]
    s_add_u32 s31, s31, 16640
    s_cmp_eq_u32 s31, 66560
    v_exp_f32 v16, v16
    v_exp_f32 v17, v17
    v_exp_f32 v18, v18
    v_exp_f32 v19, v19
    v_mfma_f32_32x32x16_bf16 v[32:47], v[180:183], v[140:143], v[32:47]
    s_cselect_b32 s31, 0, s31
    s_addc_u32 s52, s52, 0
    v_exp_f32 v20, v20
    v_exp_f32 v21, v21
    v_exp_f32 v22, v22
    v_exp_f32 v23, v23
    v_mfma_f32_32x32x16_bf16 v[96:111], v[160:163], v[120:123], v[96:111]
    v_mov_b32 v3, v2
    v_cvt_pk_bf16_f32 v112, v16, v17
    v_cvt_pk_bf16_f32 v113, v18, v19
    v_cvt_pk_bf16_f32 v114, v20, v21
    v_cvt_pk_bf16_f32 v115, v22, v23
    v_exp_f32 v24, v24
    v_exp_f32 v25, v25
    v_mfma_f32_32x32x16_bf16 v[96:111], v[164:167], v[124:127], v[96:111]
    s_waitcnt lgkmcnt(0)
    v_exp_f32 v26, v26
    v_exp_f32 v27, v27
    v_exp_f32 v28, v28
    v_exp_f32 v29, v29
    v_smfmac_f32_16x16x64_bf16 v[148:151], v[168:171], v[120:127], v172
    s_mov_b64 exec, 1
    ds_add_u32 v2, v10 offset:16388
    s_mov_b64 exec, -1
    v_exp_f32 v30, v30
    v_exp_f32 v31, v31
    v_cvt_pk_bf16_f32 v116, v24, v25
    v_cvt_pk_bf16_f32 v117, v26, v27
    v_cvt_pk_bf16_f32 v118, v28, v29
    v_cvt_pk_bf16_f32 v119, v30, v31
    v_mfma_f32_32x32x16_bf16 v[16:31], v[152:155], v[128:131], v[48:63]
    ds_read_b128 v[176:179], v2 offset:4096
    v_exp_f32 v32, v32
    v_exp_f32 v33, v33
    v_exp_f32 v34, v34
    v_exp_f32 v35, v35
    v_mfma_f32_32x32x16_bf16 v[16:31], v[156:159], v[132:135], v[16:31]
    ds_read_b128 v[180:183], v2 offset:5120
    v_exp_f32 v36, v36
    v_exp_f32 v37, v37
    v_exp_f32 v38, v38
    v_exp_f32 v39, v39
    v_mfma_f32_32x32x16_bf16 v[80:95], v[184:187], v[112:115], v[80:95]
    ds_read_b128 v[160:163], v3 offset:2048
    v_cvt_pk_bf16_f32 v120, v32, v33
    v_cvt_pk_bf16_f32 v121, v34, v35
    v_cvt_pk_bf16_f32 v122, v36, v37
    v_cvt_pk_bf16_f32 v123, v38, v39
    v_exp_f32 v40, v40
    v_exp_f32 v41, v41
    v_mfma_f32_32x32x16_bf16 v[80:95], v[188:191], v[116:119], v[80:95]
    ds_read_b128 v[164:167], v3 offset:3072
    v_exp_f32 v42, v42
    v_exp_f32 v43, v43
    v_exp_f32 v44, v44
    v_exp_f32 v45, v45
    v_smfmac_f32_16x16x64_bf16 v[144:147], v[168:171], v[112:119], v172
    s_sub_u32 s30, s30, 1
    s_cmp_lg_u32 s30, 0
    v_exp_f32 v46, v46
    v_exp_f32 v47, v47
    v_cvt_pk_bf16_f32 v124, v40, v41
    v_cvt_pk_bf16_f32 v125, v42, v43
    v_cvt_pk_bf16_f32 v126, v44, v45
    v_cvt_pk_bf16_f32 v127, v46, v47
    s_cbranch_scc1 attn_kernel_loop
    s_nop 1
    v_mfma_f32_32x32x16_bf16 v[96:111], v[184:187], v[120:123], v[96:111]
    v_mfma_f32_32x32x16_bf16 v[96:111], v[188:191], v[124:127], v[96:111]
    v_smfmac_f32_16x16x64_bf16 v[148:151], v[168:171], v[120:127], v172
    s_waitcnt lgkmcnt(0)
    s_nop 7
    s_nop 3
    v_add_f32 v144, v144, v145
    v_add_f32 v148, v148, v149
    v_mov_b32 v8, 0
    v_mov_b32 v9, 0
    v_mov_b32 v10, 0
    v_mov_b32 v11, 0
    v_pk_fma_f32 v[8:9], v[80:81], v[10:11], v[8:9]
    v_pk_fma_f32 v[8:9], v[82:83], v[10:11], v[8:9]
    v_pk_fma_f32 v[8:9], v[84:85], v[10:11], v[8:9]
    v_pk_fma_f32 v[8:9], v[86:87], v[10:11], v[8:9]
    v_pk_fma_f32 v[8:9], v[88:89], v[10:11], v[8:9]
    v_pk_fma_f32 v[8:9], v[90:91], v[10:11], v[8:9]
    v_pk_fma_f32 v[8:9], v[92:93], v[10:11], v[8:9]
    v_pk_fma_f32 v[8:9], v[94:95], v[10:11], v[8:9]
    v_pk_fma_f32 v[8:9], v[96:97], v[10:11], v[8:9]
    v_pk_fma_f32 v[8:9], v[98:99], v[10:11], v[8:9]
    v_pk_fma_f32 v[8:9], v[100:101], v[10:11], v[8:9]
    v_pk_fma_f32 v[8:9], v[102:103], v[10:11], v[8:9]
    v_pk_fma_f32 v[8:9], v[104:105], v[10:11], v[8:9]
    v_pk_fma_f32 v[8:9], v[106:107], v[10:11], v[8:9]
    v_pk_fma_f32 v[8:9], v[108:109], v[10:11], v[8:9]
    v_pk_fma_f32 v[8:9], v[110:111], v[10:11], v[8:9]
    v_add_f32 v8, v8, v9
    v_add_f32 v9, v144, v148
    v_add_f32 v8, v8, v9
    v_mov_b32 v9, 0x53800000
    v_cmp_nlt_f32 vcc, v8, v9
    s_nop 1
    s_cbranch_vccnz attn_kernel_slow
attn_kernel_fin:
    v_rcp_f32 v8, v144
    v_rcp_f32 v10, v148
    s_lshl_b32 s34, s29, 3
    s_lshl_b32 s35, s3, 1
    s_add_u32 s34, s34, s35
    s_lshl_b32 s34, s34, 5
    s_add_u32 s34, s34, s28
    s_lshl_b32 s34, s34, 11
    s_add_u32 s34, s34, 12582912
    s_add_u32 s35, s34, 65536
    v_lshrrev_b32 v5, 4, v1
    v_and_b32 v5, 1, v5
    v_lshlrev_b32 v5, 10, v5
    v_lshrrev_b32 v6, 5, v1
    v_lshl_add_u32 v5, v6, 8, v5
    v_and_b32 v6, 15, v1
    v_lshl_add_u32 v5, v6, 4, v5
    v_pk_mul_f32 v[80:81], v[80:81], v[8:9] op_sel_hi:[1,0]
    v_pk_mul_f32 v[82:83], v[82:83], v[8:9] op_sel_hi:[1,0]
    v_pk_mul_f32 v[84:85], v[84:85], v[8:9] op_sel_hi:[1,0]
    v_pk_mul_f32 v[86:87], v[86:87], v[8:9] op_sel_hi:[1,0]
    v_pk_mul_f32 v[88:89], v[88:89], v[8:9] op_sel_hi:[1,0]
    v_pk_mul_f32 v[90:91], v[90:91], v[8:9] op_sel_hi:[1,0]
    v_pk_mul_f32 v[92:93], v[92:93], v[8:9] op_sel_hi:[1,0]
    v_pk_mul_f32 v[94:95], v[94:95], v[8:9] op_sel_hi:[1,0]
    v_cvt_pk_bf16_f32 v80, v80, v81
    v_cvt_pk_bf16_f32 v81, v82, v83
    v_cvt_pk_bf16_f32 v82, v84, v85
    v_cvt_pk_bf16_f32 v83, v86, v87
    v_cvt_pk_bf16_f32 v84, v88, v89
    v_cvt_pk_bf16_f32 v85, v90, v91
    v_cvt_pk_bf16_f32 v86, v92, v93
    v_cvt_pk_bf16_f32 v87, v94, v95
    buffer_store_dwordx4 v[80:83], v5, s[16:19], s34 offen offset:0 sc1
    buffer_store_dwordx4 v[84:87], v5, s[16:19], s34 offen offset:512 sc1
    v_pk_mul_f32 v[96:97], v[96:97], v[10:11] op_sel_hi:[1,0]
    v_pk_mul_f32 v[98:99], v[98:99], v[10:11] op_sel_hi:[1,0]
    v_pk_mul_f32 v[100:101], v[100:101], v[10:11] op_sel_hi:[1,0]
    v_pk_mul_f32 v[102:103], v[102:103], v[10:11] op_sel_hi:[1,0]
    v_pk_mul_f32 v[104:105], v[104:105], v[10:11] op_sel_hi:[1,0]
    v_pk_mul_f32 v[106:107], v[106:107], v[10:11] op_sel_hi:[1,0]
    v_pk_mul_f32 v[108:109], v[108:109], v[10:11] op_sel_hi:[1,0]
    v_pk_mul_f32 v[110:111], v[110:111], v[10:11] op_sel_hi:[1,0]
    v_cvt_pk_bf16_f32 v96, v96, v97
    v_cvt_pk_bf16_f32 v97, v98, v99
    v_cvt_pk_bf16_f32 v98, v100, v101
    v_cvt_pk_bf16_f32 v99, v102, v103
    v_cvt_pk_bf16_f32 v100, v104, v105
    v_cvt_pk_bf16_f32 v101, v106, v107
    v_cvt_pk_bf16_f32 v102, v108, v109
    v_cvt_pk_bf16_f32 v103, v110, v111
    buffer_store_dwordx4 v[96:99], v5, s[16:19], s35 offen offset:0 sc1
    buffer_store_dwordx4 v[100:103], v5, s[16:19], s35 offen offset:512 sc1
    s_lshl_b32 s34, s29, 2
    s_add_u32 s34, s34, s3
    s_lshl_b32 s34, s34, 5
    s_add_u32 s34, s34, s28
    s_lshl_b32 s34, s34, 5
    s_add_u32 s34, s34, 39944192
    v_mov_b32 v12, 1
    v_mov_b32 v13, 156700
    v_mov_b32 v11, 1
    s_waitcnt vmcnt(0)
    s_mov_b64 exec, 1
    buffer_store_dword v12, off, s[16:19], s34 sc1
    ds_add_u32 v13, v11
    s_mov_b64 exec, -1
    s_branch mlp_cons
attn_kernel_spin:
    ds_read_b32 v9, v3 offset:16384
    s_waitcnt lgkmcnt(0)
    v_readfirstlane_b32 s53, v9
    s_nop 0
    s_cmp_lt_u32 s53, s52
    s_cbranch_scc1 attn_kernel_spin
    s_branch attn_kernel_back
attn_kernel_slow:
    v_mov_b32 v5, 0xff800000
    v_mov_b32 v6, 0xff800000
    s_mov_b32 s34, s37
    s_mov_b32 s30, 64
attn_kernel_s1:
    buffer_load_dwordx4 v[152:155], v4, s[16:19], s34 offen offset:0
    buffer_load_dwordx4 v[156:159], v4, s[16:19], s34 offen offset:1024
    s_waitcnt vmcnt(0)
    v_mfma_f32_32x32x16_bf16 v[16:31], v[152:155], v[128:131], 0
    v_mfma_f32_32x32x16_bf16 v[16:31], v[156:159], v[132:135], v[16:31]
    v_mfma_f32_32x32x16_bf16 v[32:47], v[152:155], v[136:139], 0
    v_mfma_f32_32x32x16_bf16 v[32:47], v[156:159], v[140:143], v[32:47]
    s_nop 7
    s_nop 3
    v_max3_f32 v5, v5, v16, v17
    v_max3_f32 v5, v5, v18, v19
    v_max3_f32 v5, v5, v20, v21
    v_max3_f32 v5, v5, v22, v23
    v_max3_f32 v5, v5, v24, v25
    v_max3_f32 v5, v5, v26, v27
    v_max3_f32 v5, v5, v28, v29
    v_max3_f32 v5, v5, v30, v31
    v_max3_f32 v6, v6, v32, v33
    v_max3_f32 v6, v6, v34, v35
    v_max3_f32 v6, v6, v36, v37
    v_max3_f32 v6, v6, v38, v39
    v_max3_f32 v6, v6, v40, v41
    v_max3_f32 v6, v6, v42, v43
    v_max3_f32 v6, v6, v44, v45
    v_max3_f32 v6, v6, v46, v47
    s_add_u32 s34, s34, 4096
    s_sub_u32 s30, s30, 1
    s_cmp_lg_u32 s30, 0
    s_cbranch_scc1 attn_kernel_s1
    v_mov_b32 v7, v5
    s_nop 1
    v_permlane32_swap_b32 v5, v7
    v_max_f32 v5, v5, v7
    v_sub_f32 v48, 0, v5
    v_sub_f32 v49, 0, v5
    v_sub_f32 v50, 0, v5
    v_sub_f32 v51, 0, v5
    v_sub_f32 v52, 0, v5
    v_sub_f32 v53, 0, v5
    v_sub_f32 v54, 0, v5
    v_sub_f32 v55, 0, v5
    v_sub_f32 v56, 0, v5
    v_sub_f32 v57, 0, v5
    v_sub_f32 v58, 0, v5
    v_sub_f32 v59, 0, v5
    v_sub_f32 v60, 0, v5
    v_sub_f32 v61, 0, v5
    v_sub_f32 v62, 0, v5
    v_sub_f32 v63, 0, v5
    v_mov_b32 v7, v6
    s_nop 1
    v_permlane32_swap_b32 v6, v7
    v_max_f32 v6, v6, v7
    v_sub_f32 v64, 0, v6
    v_sub_f32 v65, 0, v6
    v_sub_f32 v66, 0, v6
    v_sub_f32 v67, 0, v6
    v_sub_f32 v68, 0, v6
    v_sub_f32 v69, 0, v6
    v_sub_f32 v70, 0, v6
    v_sub_f32 v71, 0, v6
    v_sub_f32 v72, 0, v6
    v_sub_f32 v73, 0, v6
    v_sub_f32 v74, 0, v6
    v_sub_f32 v75, 0, v6
    v_sub_f32 v76, 0, v6
    v_sub_f32 v77, 0, v6
    v_sub_f32 v78, 0, v6
    v_sub_f32 v79, 0, v6
    v_mov_b32 v80, 0
    v_mov_b32 v81, 0
    v_mov_b32 v82, 0
    v_mov_b32 v83, 0
    v_mov_b32 v84, 0
    v_mov_b32 v85, 0
    v_mov_b32 v86, 0
    v_mov_b32 v87, 0
    v_mov_b32 v88, 0
    v_mov_b32 v89, 0
    v_mov_b32 v90, 0
    v_mov_b32 v91, 0
    v_mov_b32 v92, 0
    v_mov_b32 v93, 0
    v_mov_b32 v94, 0
    v_mov_b32 v95, 0
    v_mov_b32 v96, 0
    v_mov_b32 v97, 0
    v_mov_b32 v98, 0
    v_mov_b32 v99, 0
    v_mov_b32 v100, 0
    v_mov_b32 v101, 0
    v_mov_b32 v102, 0
    v_mov_b32 v103, 0
    v_mov_b32 v104, 0
    v_mov_b32 v105, 0
    v_mov_b32 v106, 0
    v_mov_b32 v107, 0
    v_mov_b32 v108, 0
    v_mov_b32 v109, 0
    v_mov_b32 v110, 0
    v_mov_b32 v111, 0
    v_mov_b32 v144, 0
    v_mov_b32 v145, 0
    v_mov_b32 v146, 0
    v_mov_b32 v147, 0
    v_mov_b32 v148, 0
    v_mov_b32 v149, 0
    v_mov_b32 v150, 0
    v_mov_b32 v151, 0
    v_mov_b32 v120, 0
    v_mov_b32 v121, 0
    v_mov_b32 v122, 0
    v_mov_b32 v123, 0
    v_mov_b32 v124, 0
    v_mov_b32 v125, 0
    v_mov_b32 v126, 0
    v_mov_b32 v127, 0
    v_mov_b32 v184, 0
    v_mov_b32 v185, 0
    v_mov_b32 v186, 0
    v_mov_b32 v187, 0
    v_mov_b32 v188, 0
    v_mov_b32 v189, 0
    v_mov_b32 v190, 0
    v_mov_b32 v191, 0
    s_mov_b32 s34, s37
    s_mov_b32 s30, 64
attn_kernel_s2:
    buffer_load_dwordx4 v[152:155], v4, s[16:19], s34 offen offset:0
    buffer_load_dwordx4 v[156:159], v4, s[16:19], s34 offen offset:1024
    buffer_load_dwordx4 v[160:163], v4, s[16:19], s34 offen offset:2048
    buffer_load_dwordx4 v[164:167], v4, s[16:19], s34 offen offset:3072
    s_waitcnt vmcnt(0)
    v_mfma_f32_32x32x16_bf16 v[16:31], v[152:155], v[128:131], v[48:63]
    v_mfma_f32_32x32x16_bf16 v[16:31], v[156:159], v[132:135], v[16:31]
    v_mfma_f32_32x32x16_bf16 v[32:47], v[152:155], v[136:139], v[64:79]
    v_mfma_f32_32x32x16_bf16 v[32:47], v[156:159], v[140:143], v[32:47]
    s_nop 7
    s_nop 3
    v_exp_f32 v16, v16
    v_exp_f32 v17, v17
    v_exp_f32 v18, v18
    v_exp_f32 v19, v19
    v_exp_f32 v20, v20
    v_exp_f32 v21, v21
    v_exp_f32 v22, v22
    v_exp_f32 v23, v23
    v_exp_f32 v24, v24
    v_exp_f32 v25, v25
    v_exp_f32 v26, v26
    v_exp_f32 v27, v27
    v_exp_f32 v28, v28
    v_exp_f32 v29, v29
    v_exp_f32 v30, v30
    v_exp_f32 v31, v31
    s_nop 0
    v_cvt_pk_bf16_f32 v112, v16, v17
    v_cvt_pk_bf16_f32 v113, v18, v19
    v_cvt_pk_bf16_f32 v114, v20, v21
    v_cvt_pk_bf16_f32 v115, v22, v23
    v_cvt_pk_bf16_f32 v116, v24, v25
    v_cvt_pk_bf16_f32 v117, v26, v27
    v_cvt_pk_bf16_f32 v118, v28, v29
    v_cvt_pk_bf16_f32 v119, v30, v31
    v_exp_f32 v32, v32
    v_exp_f32 v33, v33
    v_exp_f32 v34, v34
    v_exp_f32 v35, v35
    v_exp_f32 v36, v36
    v_exp_f32 v37, v37
    v_exp_f32 v38, v38
    v_exp_f32 v39, v39
    v_exp_f32 v40, v40
    v_exp_f32 v41, v41
    v_exp_f32 v42, v42
    v_exp_f32 v43, v43
    v_exp_f32 v44, v44
    v_exp_f32 v45, v45
    v_exp_f32 v46, v46
    v_exp_f32 v47, v47
    s_nop 0
    v_cvt_pk_bf16_f32 v120, v32, v33
    v_cvt_pk_bf16_f32 v121, v34, v35
    v_cvt_pk_bf16_f32 v122, v36, v37
    v_cvt_pk_bf16_f32 v123, v38, v39
    v_cvt_pk_bf16_f32 v124, v40, v41
    v_cvt_pk_bf16_f32 v125, v42, v43
    v_cvt_pk_bf16_f32 v126, v44, v45
    v_cvt_pk_bf16_f32 v127, v46, v47
    s_nop 1
    v_mfma_f32_32x32x16_bf16 v[80:95], v[160:163], v[112:115], v[80:95]
    v_mfma_f32_32x32x16_bf16 v[80:95], v[164:167], v[116:119], v[80:95]
    v_smfmac_f32_16x16x64_bf16 v[144:147], v[168:171], v[112:119], v172
    v_mfma_f32_32x32x16_bf16 v[96:111], v[160:163], v[120:123], v[96:111]
    v_mfma_f32_32x32x16_bf16 v[96:111], v[164:167], v[124:127], v[96:111]
    v_smfmac_f32_16x16x64_bf16 v[148:151], v[168:171], v[120:127], v172
    s_add_u32 s34, s34, 4096
    s_sub_u32 s30, s30, 1
    s_cmp_lg_u32 s30, 0
    s_cbranch_scc1 attn_kernel_s2
    s_nop 7
    s_nop 7
    v_add_f32 v144, v144, v145
    v_add_f32 v148, v148, v149
    s_branch attn_kernel_fin
mlp_ld:
    s_load_dwordx2 s[12:13], s[0:1], 0
    s_load_dwordx2 s[24:25], s[0:1], 40
    s_load_dwordx2 s[20:21], s[0:1], 64
    s_load_dwordx2 s[44:45], s[0:1], 56
    s_and_b32 s34, s2, 7
    s_lshr_b32 s35, s2, 3
    s_and_b32 s28, s34, 3
    s_lshl_b32 s28, s28, 3
    s_and_b32 s36, s35, 7
    s_add_u32 s28, s28, s36
    s_lshr_b32 s29, s34, 2
    s_mul_i32 s29, s29, 4
    s_lshr_b32 s36, s35, 3
    s_add_u32 s29, s29, s36
    s_mov_b32 s14, 4194304
    s_mov_b32 s15, 0x20000
    s_mov_b32 s26, 7168
    s_mov_b32 s27, 0x20000
    s_mov_b32 s22, 4194304
    s_mov_b32 s23, 0x20000
    s_mov_b32 s46, 2048
    s_mov_b32 s47, 0x20000
    s_sub_u32 s37, s3, 4
    s_lshr_b32 s36, s37, 1
    s_lshl_b32 s35, s28, 1
    s_add_u32 s35, s35, s36
    s_mul_i32 s35, s35, 65536
    s_and_b32 s36, s37, 1
    s_lshl_b32 s36, s36, 11
    s_add_u32 s35, s35, s36
    s_add_u32 s32, s35, 12582912
    v_lshlrev_b32 v4, 4, v1
    s_mul_i32 s38, s37, 2048
    s_mul_i32 s39, s37, 4096
    s_add_u32 s39, s39, 0
    s_mul_i32 s33, s29, 262144
    s_add_u32 s33, s33, 46137344
    s_add_u32 s33, s33, s39
    s_mov_b32 s31, 66560
    s_add_u32 s39, s39, 8192
    s_mov_b32 s52, 0
    s_waitcnt lgkmcnt(0)
    s_or_b32 s9, s9, 0x100000
    s_mov_b32 s10, -1
    s_mov_b32 s11, 0x800000
    v_mov_b32 v5, 156684
mlp0_sd:
    ds_read_b32 v3, v5
    s_waitcnt lgkmcnt(0)
    v_cmp_ne_u32 vcc, 3, v3
    s_nop 1
    s_cbranch_vccz mlp0_sd1
    s_sleep 8
    s_branch mlp0_sd
mlp0_sd1:
    s_lshl_b32 s34, s29, 7
    s_add_u32 s34, s34, 39976960
    v_and_b32 v2, 31, v1
    v_lshlrev_b32 v2, 2, v2
    s_branch mlp0_wp1
mlp0_wp:
    s_sleep 8
mlp0_wp1:
    buffer_load_dword v3, v2, s[16:19], s34 offen sc1
    s_waitcnt vmcnt(0)
    v_cmp_ne_u32 vcc, 1, v3
    s_nop 1
    s_cbranch_vccnz mlp0_wp
    s_add_u32 s40, 66560, s38
    s_add_u32 s41, 66560, s39
    s_add_u32 m0, s41, 0
    s_nop 0
    buffer_load_dwordx4 off, s[8:11], s33  lds
    buffer_load_dwordx4 off, s[8:11], s33 offset:1024  lds
    buffer_load_dwordx4 off, s[8:11], s33 offset:2048  lds
    buffer_load_dwordx4 off, s[8:11], s33 offset:3072  lds
    s_add_u32 s33, s33, 16384
    s_add_u32 s40, 91136, s38
    s_add_u32 s41, 91136, s39
    s_add_u32 m0, s41, 0
    s_nop 0
    buffer_load_dwordx4 off, s[8:11], s33  lds
    buffer_load_dwordx4 off, s[8:11], s33 offset:1024  lds
    buffer_load_dwordx4 off, s[8:11], s33 offset:2048  lds
    buffer_load_dwordx4 off, s[8:11], s33 offset:3072  lds
    s_add_u32 s33, s33, 16384
    s_add_u32 s40, 115712, s38
    s_add_u32 s41, 115712, s39
    s_add_u32 m0, s41, 0
    s_nop 0
    buffer_load_dwordx4 off, s[8:11], s33  lds
    buffer_load_dwordx4 off, s[8:11], s33 offset:1024  lds
    buffer_load_dwordx4 off, s[8:11], s33 offset:2048  lds
    buffer_load_dwordx4 off, s[8:11], s33 offset:3072  lds
    s_add_u32 s33, s33, 16384
    s_and_b32 s34, s28, 31
    s_lshl_b32 s34, s34, 10
    s_add_u32 s34, s34, 39944192
    v_and_b32 v2, 31, v1
    v_lshlrev_b32 v2, 5, v2
    v_mov_b32 v5, 156680
    s_cmp_lg_u32 s3, 4
    s_cbranch_scc1 mlp0_pl
    v_mov_b32 v16, 156700
mlp0_lp:
    ds_read_b32 v17, v16
    s_waitcnt lgkmcnt(0)
    v_cmp_gt_u32 vcc, 4, v17
    s_nop 1
    s_cbranch_vccz mlp0_lq
    s_sleep 2
    s_branch mlp0_lp
mlp0_lq:
    s_branch mlp0_poll1
mlp0_poll:
    s_sleep 2
mlp0_poll1:
    buffer_load_dword v3, v2, s[16:19], s34 offen sc1
    s_waitcnt vmcnt(0)
    v_cmp_ne_u32 vcc, 1, v3
    s_nop 1
    s_cbranch_vccnz mlp0_poll
    ds_write_b32 v5, v3
    s_branch mlp0_pd
mlp0_pl:
    ds_read_b32 v3, v5
    s_waitcnt lgkmcnt(0)
    v_cmp_ne_u32 vcc, 1, v3
    s_nop 1
    s_cbranch_vccz mlp0_pd
    s_sleep 1
    s_branch mlp0_pl
mlp0_pd:
    s_add_u32 s40, s31, s38
    s_add_u32 s41, s31, s39
    s_add_u32 m0, s40, 0
    s_nop 0
    buffer_load_dwordx4 off, s[8:11], s32 sc1 lds
    buffer_load_dwordx4 off, s[8:11], s32 offset:1024 sc1 lds
    s_add_u32 s31, s31, 24576
    s_cmp_eq_u32 s31, 140288
    s_cselect_b32 s31, 17408, s31
    s_add_u32 s32, s32, 4096
    s_add_u32 s40, s31, s38
    s_add_u32 s41, s31, s39
    s_add_u32 m0, s40, 0
    s_nop 0
    buffer_load_dwordx4 off, s[8:11], s32 sc1 lds
    buffer_load_dwordx4 off, s[8:11], s32 offset:1024 sc1 lds
    s_add_u32 s31, s31, 24576
    s_cmp_eq_u32 s31, 140288
    s_cselect_b32 s31, 17408, s31
    s_add_u32 s32, s32, 4096
    s_add_u32 s40, s31, s38
    s_add_u32 s41, s31, s39
    s_add_u32 m0, s40, 0
    s_nop 0
    buffer_load_dwordx4 off, s[8:11], s32 sc1 lds
    buffer_load_dwordx4 off, s[8:11], s32 offset:1024 sc1 lds
    s_add_u32 s31, s31, 24576
    s_cmp_eq_u32 s31, 140288
    s_cselect_b32 s31, 17408, s31
    s_add_u32 s32, s32, 4096
    s_waitcnt vmcnt(4)
    s_barrier
    s_call_b64 s[82:83], mlp0_issue
    s_call_b64 s[82:83], mlp0_issue
    s_waitcnt vmcnt(14)
    s_barrier
    s_call_b64 s[82:83], mlp0_issue
    s_waitcnt vmcnt(18)
    s_barrier
    s_call_b64 s[82:83], mlp0_issue
    s_waitcnt vmcnt(18)
    s_barrier
    s_call_b64 s[82:83], mlp0_issue
    s_waitcnt vmcnt(18)
    s_barrier
    s_call_b64 s[82:83], mlp0_issue
    s_waitcnt vmcnt(18)
    s_barrier
    s_call_b64 s[82:83], mlp0_issue
    s_waitcnt vmcnt(18)
    s_barrier
    s_call_b64 s[82:83], mlp0_issue
    s_waitcnt vmcnt(18)
    s_barrier
    s_call_b64 s[82:83], mlp0_issue
    s_waitcnt vmcnt(18)
    s_barrier
    s_call_b64 s[82:83], mlp0_issue
    s_waitcnt vmcnt(18)
    s_barrier
    s_call_b64 s[82:83], mlp0_issue
    s_waitcnt vmcnt(18)
    s_barrier
    s_call_b64 s[82:83], mlp0_issue
    s_waitcnt vmcnt(18)
    s_barrier
    s_call_b64 s[82:83], mlp0_issue
    s_waitcnt vmcnt(18)
    s_barrier
    s_lshl_b32 s34, s28, 6
    s_lshl_b32 s35, s37, 4
    s_add_u32 s34, s34, s35
    s_lshl_b32 s34, s34, 11
    s_lshl_b32 s35, s29, 8
    s_add_u32 s34, s34, s35
    v_lshrrev_b32 v2, 4, v1
    v_and_b32 v3, 15, v1
    v_xor_b32 v3, v3, v2
    v_lshlrev_b32 v2, 11, v2
    v_lshl_add_u32 v2, v3, 4, v2
    s_lshl_b32 s35, s37, 12
    s_add_u32 s35, s35, 140288
    v_xor_b32 v3, 0, v2
    s_add_u32 m0, s35, 0
    s_nop 0
    buffer_load_dwordx4 v3, s[12:15], s34 offen lds
    s_add_u32 s34, s34, 8192
    v_xor_b32 v3, 64, v2
    s_add_u32 m0, s35, 1024
    s_nop 0
    buffer_load_dwordx4 v3, s[12:15], s34 offen lds
    s_add_u32 s34, s34, 8192
    v_xor_b32 v3, 128, v2
    s_add_u32 m0, s35, 2048
    s_nop 0
    buffer_load_dwordx4 v3, s[12:15], s34 offen lds
    s_add_u32 s34, s34, 8192
    v_xor_b32 v3, 192, v2
    s_add_u32 m0, s35, 3072
    s_nop 0
    buffer_load_dwordx4 v3, s[12:15], s34 offen lds
    s_add_u32 s34, s34, 8192
    s_waitcnt vmcnt(16)
    s_barrier
    s_waitcnt vmcnt(10)
    s_barrier
    s_waitcnt vmcnt(4)
    s_barrier
    s_waitcnt vmcnt(0)
    s_barrier
    s_and_b32 s34, s2, 7
    s_lshr_b32 s35, s2, 3
    s_and_b32 s28, s34, 1
    s_lshl_b32 s28, s28, 3
    s_and_b32 s36, s35, 7
    s_add_u32 s28, s28, s36
    s_lshr_b32 s29, s34, 1
    s_mul_i32 s29, s29, 4
    s_lshr_b32 s36, s35, 3
    s_add_u32 s29, s29, s36
    s_lshr_b32 s55, s29, 3
    s_and_b32 s54, s29, 7
    s_sub_u32 s37, s3, 4
    s_lshl_b32 s35, s28, 2
    s_add_u32 s35, s35, s37
    s_mul_i32 s35, s35, 65536
    s_add_u32 s32, s35, 16777216
    v_lshlrev_b32 v4, 4, v1
    s_mul_i32 s38, s37, 4096
    s_mul_i32 s39, s37, 7168
    s_add_u32 s39, s39, 0
    s_mul_i32 s33, s29, 458752
    s_add_u32 s33, s33, 50331648
    s_add_u32 s33, s33, s39
    s_mov_b32 s31, 0
    s_add_u32 s39, s39, 16384
    s_mov_b32 s52, 0
    s_waitcnt lgkmcnt(0)
    s_or_b32 s9, s9, 0x100000
    s_mov_b32 s10, -1
    s_mov_b32 s11, 0x800000
    s_lshl_b32 s34, s29, 7
    s_add_u32 s34, s34, 39977984
    v_and_b32 v2, 15, v1
    v_lshlrev_b32 v2, 2, v2
    s_branch mlp1_wp1
mlp1_wp:
    s_sleep 8
mlp1_wp1:
    buffer_load_dword v3, v2, s[16:19], s34 offen sc1
    s_waitcnt vmcnt(0)
    v_cmp_ne_u32 vcc, 1, v3
    s_nop 1
    s_cbranch_vccnz mlp1_wp
    s_add_u32 s40, s31, s38
    s_add_u32 s41, s31, s39
    s_add_u32 m0, s41, 0
    s_nop 0
    buffer_load_dwordx4 off, s[8:11], s33  lds
    buffer_load_dwordx4 off, s[8:11], s33 offset:1024  lds
    buffer_load_dwordx4 off, s[8:11], s33 offset:2048  lds
    buffer_load_dwordx4 off, s[8:11], s33 offset:3072  lds
    s_add_u32 m0, s41, 4096
    s_add_u32 s80, s33, 4096
    buffer_load_dwordx4 off, s[8:11], s80  lds
    buffer_load_dwordx4 off, s[8:11], s80 offset:1024  lds
    buffer_load_dwordx4 off, s[8:11], s80 offset:2048  lds
    s_add_u32 s33, s33, 28672
    s_add_u32 s40, 45056, s38
    s_add_u32 s41, 45056, s39
    s_add_u32 m0, s41, 0
    s_nop 0
    buffer_load_dwordx4 off, s[8:11], s33  lds
    buffer_load_dwordx4 off, s[8:11], s33 offset:1024  lds
    buffer_load_dwordx4 off, s[8:11], s33 offset:2048  lds
    buffer_load_dwordx4 off, s[8:11], s33 offset:3072  lds
    s_add_u32 m0, s41, 4096
    s_add_u32 s80, s33, 4096
    buffer_load_dwordx4 off, s[8:11], s80  lds
    buffer_load_dwordx4 off, s[8:11], s80 offset:1024  lds
    buffer_load_dwordx4 off, s[8:11], s80 offset:2048  lds
    s_add_u32 s33, s33, 28672
    s_lshl_b32 s34, s28, 11
    s_add_u32 s34, s34, 39878656
    v_and_b32 v2, 15, v1
    v_lshlrev_b32 v2, 7, v2
    v_mov_b32 v5, 156672
    s_cmp_lg_u32 s3, 4
    s_cbranch_scc1 mlp1_pl
    v_mov_b32 v16, 156688
mlp1_lp:
    ds_read_b32 v17, v16
    s_waitcnt lgkmcnt(0)
    v_cmp_gt_u32 vcc, 4, v17
    s_nop 1
    s_cbranch_vccz mlp1_lq
    s_sleep 2
    s_branch mlp1_lp
mlp1_lq:
    s_branch mlp1_poll1
mlp1_poll:
    s_sleep 2
mlp1_poll1:
    buffer_load_dword v3, v2, s[16:19], s34 offen sc1
    s_waitcnt vmcnt(0)
    v_cmp_ne_u32 vcc, 1, v3
    s_nop 1
    s_cbranch_vccnz mlp1_poll
    ds_write_b32 v5, v3
    s_branch mlp1_pd
mlp1_pl:
    ds_read_b32 v3, v5
    s_waitcnt lgkmcnt(0)
    v_cmp_ne_u32 vcc, 1, v3
    s_nop 1
    s_cbranch_vccz mlp1_pd
    s_sleep 1
    s_branch mlp1_pl
mlp1_pd:
    s_add_u32 s40, s31, s38
    s_add_u32 s41, s31, s39
    s_add_u32 m0, s40, 0
    s_nop 0
    buffer_load_dwordx4 off, s[8:11], s32 sc1 lds
    buffer_load_dwordx4 off, s[8:11], s32 offset:1024 sc1 lds
    buffer_load_dwordx4 off, s[8:11], s32 offset:2048 sc1 lds
    buffer_load_dwordx4 off, s[8:11], s32 offset:3072 sc1 lds
    s_add_u32 s31, s31, 45056
    s_cmp_eq_u32 s31, 135168
    s_cselect_b32 s31, 0, s31
    s_add_u32 s32, s32, 4096
    s_add_u32 s40, s31, s38
    s_add_u32 s41, s31, s39
    s_add_u32 m0, s40, 0
    s_nop 0
    buffer_load_dwordx4 off, s[8:11], s32 sc1 lds
    buffer_load_dwordx4 off, s[8:11], s32 offset:1024 sc1 lds
    buffer_load_dwordx4 off, s[8:11], s32 offset:2048 sc1 lds
    buffer_load_dwordx4 off, s[8:11], s32 offset:3072 sc1 lds
    s_add_u32 s31, s31, 45056
    s_cmp_eq_u32 s31, 135168
    s_cselect_b32 s31, 0, s31
    s_add_u32 s32, s32, 4096
    s_waitcnt vmcnt(4)
    s_barrier
    s_call_b64 s[82:83], mlp1_issue
    s_waitcnt vmcnt(11)
    s_barrier
    s_call_b64 s[82:83], mlp1_issue
    s_mul_i32 s43, s29, 896
    s_mul_i32 s42, s37, 224
    s_add_u32 s43, s43, s42
    s_lshl_b32 s81, s28, 7
    s_lshl_b32 s35, s37, 5
    s_add_u32 s81, s81, s35
    v_and_b32 v2, 31, v1
    v_add_u32 v2, s81, v2
    v_lshlrev_b32 v2, 3, v2
    v_lshrrev_b32 v3, 5, v1
    v_lshl_add_u32 v2, v3, 17, v2
    s_mov_b32 s81, 38797312
    buffer_load_dwordx2 v[32:33], v2, s[16:19], s81 offen sc1
    s_add_u32 s81, s81, 16384
    buffer_load_dwordx2 v[34:35], v2, s[16:19], s81 offen sc1
    s_add_u32 s81, s81, 16384
    s_waitcnt vmcnt(13)
    s_barrier
    s_call_b64 s[82:83], mlp1_issue
    buffer_load_dwordx2 v[36:37], v2, s[16:19], s81 offen sc1
    s_add_u32 s81, s81, 16384
    buffer_load_dwordx2 v[38:39], v2, s[16:19], s81 offen sc1
    s_add_u32 s81, s81, 16384
    s_waitcnt vmcnt(15)
    s_barrier
    s_call_b64 s[82:83], mlp1_issue
    buffer_load_dwordx2 v[40:41], v2, s[16:19], s81 offen sc1
    s_add_u32 s81, s81, 16384
    buffer_load_dwordx2 v[42:43], v2, s[16:19], s81 offen sc1
    s_add_u32 s81, s81, 16384
    s_waitcnt vmcnt(15)
    s_barrier
    s_call_b64 s[82:83], mlp1_issue
    buffer_load_dwordx2 v[44:45], v2, s[16:19], s81 offen sc1
    s_add_u32 s81, s81, 16384
    buffer_load_dwordx2 v[46:47], v2, s[16:19], s81 offen sc1
    s_add_u32 s81, s81, 16384
    s_add_u32 s81, s43, 38273024
    s_waitcnt vmcnt(15)
    s_barrier
    s_call_b64 s[82:83], mlp1_issue
    v_lshlrev_b32 v3, 2, v1
    buffer_load_dword v48, v3, s[16:19], s81 offen sc1
    s_add_u32 s81, s81, 14336
    buffer_load_dword v49, v3, s[16:19], s81 offen sc1
    s_add_u32 s81, s81, 14336
    s_waitcnt vmcnt(15)
    s_barrier
    s_call_b64 s[82:83], mlp1_issue
    buffer_load_dword v50, v3, s[16:19], s81 offen sc1
    s_add_u32 s81, s81, 14336
    buffer_load_dword v51, v3, s[16:19], s81 offen sc1
    s_add_u32 s81, s81, 14336
    s_waitcnt vmcnt(15)
    s_barrier
    s_call_b64 s[82:83], mlp1_issue
    buffer_load_dword v52, v3, s[16:19], s81 offen sc1
    s_add_u32 s81, s81, 14336
    buffer_load_dword v53, v3, s[16:19], s81 offen sc1
    s_add_u32 s81, s81, 14336
    s_waitcnt vmcnt(15)
    s_barrier
    s_call_b64 s[82:83], mlp1_issue
    buffer_load_dword v54, v3, s[16:19], s81 offen sc1
    s_add_u32 s81, s81, 14336
    buffer_load_dword v55, v3, s[16:19], s81 offen sc1
    s_add_u32 s81, s81, 14336
    s_waitcnt vmcnt(15)
    s_barrier
    s_call_b64 s[82:83], mlp1_issue
    buffer_load_dword v56, v3, s[16:19], s81 offen sc1
    s_add_u32 s81, s81, 14336
    buffer_load_dword v57, v3, s[16:19], s81 offen sc1
    s_add_u32 s81, s81, 14336
    s_waitcnt vmcnt(15)
    s_barrier
    s_call_b64 s[82:83], mlp1_issue
    buffer_load_dword v58, v3, s[16:19], s81 offen sc1
    s_add_u32 s81, s81, 14336
    buffer_load_dword v59, v3, s[16:19], s81 offen sc1
    s_add_u32 s81, s81, 14336
    s_waitcnt vmcnt(15)
    s_barrier
    s_call_b64 s[82:83], mlp1_issue
    buffer_load_dword v60, v3, s[16:19], s81 offen sc1
    s_add_u32 s81, s81, 14336
    buffer_load_dword v61, v3, s[16:19], s81 offen sc1
    s_add_u32 s81, s81, 14336
    s_waitcnt vmcnt(15)
    s_barrier
    s_call_b64 s[82:83], mlp1_issue
    buffer_load_dword v62, v3, s[16:19], s81 offen sc1
    s_add_u32 s81, s81, 14336
    buffer_load_dword v63, v3, s[16:19], s81 offen sc1
    s_add_u32 s81, s81, 14336
    s_waitcnt vmcnt(15)
    s_barrier
    s_call_b64 s[82:83], mlp1_issue
    s_lshr_b32 s81, s43, 1
    v_lshlrev_b32 v3, 1, v1
    buffer_load_ushort v64, v3, s[24:27], s81 offen
    s_waitcnt vmcnt(14)
    s_barrier
    s_waitcnt vmcnt(1)
    s_waitcnt vmcnt(0)
    v_pk_add_f32 v[32:33], v[32:33], v[34:35]
    v_pk_add_f32 v[32:33], v[32:33], v[36:37]
    v_pk_add_f32 v[32:33], v[32:33], v[38:39]
    v_pk_add_f32 v[32:33], v[32:33], v[40:41]
    v_pk_add_f32 v[32:33], v[32:33], v[42:43]
    v_pk_add_f32 v[32:33], v[32:33], v[44:45]
    v_pk_add_f32 v[32:33], v[32:33], v[46:47]
    v_add_f32 v48, v48, v49
    v_add_f32 v48, v48, v50
    v_add_f32 v48, v48, v51
    v_add_f32 v48, v48, v52
    v_add_f32 v48, v48, v53
    v_add_f32 v48, v48, v54
    v_add_f32 v48, v48, v55
    v_add_f32 v48, v48, v56
    v_add_f32 v48, v48, v57
    v_add_f32 v48, v48, v58
    v_add_f32 v48, v48, v59
    v_add_f32 v48, v48, v60
    v_add_f32 v48, v48, v61
    v_add_f32 v48, v48, v62
    v_add_f32 v48, v48, v63
    v_mov_b32 v34, v32
    v_mov_b32 v35, v33
    s_nop 1
    v_permlane32_swap_b32 v32, v34
    v_permlane32_swap_b32 v33, v35
    v_add_f32 v32, v32, v34
    v_add_f32 v33, v33, v35
    v_mul_f32 v34, 0x3a800000, v32
    v_mul_f32 v33, 0x3a800000, v33
    v_fma_f32 v33, -v34, v34, v33
    v_max_f32 v33, 0, v33
    v_mov_b32 v35, 0x2edbe6ff
    v_fmac_f32 v35, 0x3f800054, v33
    v_rsq_f32 v32, v35
    s_nop 0
    v_mul_f32 v33, v32, v34
    v_and_b32 v2, 31, v1
    s_lshl_b32 s34, s37, 7
    s_add_u32 s34, s34, 135168
    v_lshl_add_u32 v2, v2, 2, s34
    ds_write_b32 v2, v32
    ds_write_b32 v2, v33 offset:512
    s_add_u32 s34, s42, 136192
    v_lshl_add_u32 v2, v1, 2, s34
    v_lshlrev_b32 v64, 16, v64
    s_mov_b32 exec_hi, 0x00ffffff
    ds_write_b32 v2, v48
    ds_write_b32 v2, v64 offset:1024
    s_mov_b64 exec, -1
    s_waitcnt lgkmcnt(0)
    s_barrier
    s_waitcnt vmcnt(0)
    s_barrier
    s_mov_b32 s29, s54
    s_sub_u32 s37, s3, 4
    s_lshl_b32 s35, s28, 2
    s_add_u32 s35, s35, s37
    s_mul_i32 s35, s35, 229376
    s_add_u32 s32, s35, 20971520
    v_lshlrev_b32 v4, 4, v1
    s_mul_i32 s35, s55, 114688
    s_add_u32 s32, s32, s35
    s_mul_i32 s38, s37, 4096
    s_mul_i32 s39, s37, 4096
    s_add_u32 s39, s39, 0
    s_mul_i32 s33, s29, 917504
    s_add_u32 s33, s33, 58720256
    s_add_u32 s33, s33, s39
    s_mov_b32 s31, 0
    s_mul_i32 s35, s55, 458752
    s_add_u32 s33, s33, s35
    s_add_u32 s39, s39, 16384
    s_mov_b32 s52, 0
    s_waitcnt lgkmcnt(0)
    s_or_b32 s9, s9, 0x100000
    s_mov_b32 s10, -1
    s_mov_b32 s11, 0x800000
    s_lshr_b32 s85, s37, 1
    s_lshl_b32 s86, s85, 13
    s_sub_u32 s33, s33, s86
    s_mul_i32 s86, s54, 7
    s_lshl_b32 s90, s54, 1
    s_lshl_b32 s34, s29, 8
    s_add_u32 s34, s34, 39980032
    v_and_b32 v2, 47, v1
    v_lshlrev_b32 v2, 2, v2
    s_branch mlp2_wp1
mlp2_wp:
    s_sleep 8
mlp2_wp1:
    buffer_load_dword v3, v2, s[16:19], s34 offen sc1
    s_waitcnt vmcnt(0)
    v_cmp_ne_u32 vcc, 1, v3
    s_nop 1
    s_cbranch_vccnz mlp2_wp
    s_add_u32 s88, s86, 0
    s_mov_b32 s89, 1
    s_mul_i32 s87, s85, s89
    s_add_u32 s87, s87, s88
    s_lshl_b32 s87, s87, 13
    s_add_u32 m0, s31, s39
    s_add_u32 s87, s87, s33
    buffer_load_dwordx4 off, s[8:11], s87 offset:0 lds
    buffer_load_dwordx4 off, s[8:11], s87 offset:1024 lds
    buffer_load_dwordx4 off, s[8:11], s87 offset:2048 lds
    buffer_load_dwordx4 off, s[8:11], s87 offset:3072 lds
    s_add_u32 s31, s31, 32768
    s_cmp_eq_u32 s31, 98304
    s_cselect_b32 s31, 0, s31
    s_add_u32 s88, s86, 4
    s_mov_b32 s89, 1
    s_mul_i32 s87, s85, s89
    s_add_u32 s87, s87, s88
    s_lshl_b32 s87, s87, 13
    s_add_u32 m0, s31, s39
    s_add_u32 s87, s87, s33
    buffer_load_dwordx4 off, s[8:11], s87 offset:0 lds
    buffer_load_dwordx4 off, s[8:11], s87 offset:1024 lds
    buffer_load_dwordx4 off, s[8:11], s87 offset:2048 lds
    buffer_load_dwordx4 off, s[8:11], s87 offset:3072 lds
    s_add_u32 s31, s31, 32768
    s_cmp_eq_u32 s31, 98304
    s_cselect_b32 s31, 0, s31
    s_add_u32 s88, s86, 2
    s_mov_b32 s89, 4
    s_mul_i32 s87, s85, s89
    s_add_u32 s87, s87, s88
    s_lshl_b32 s87, s87, 13
    s_add_u32 m0, s31, s39
    s_add_u32 s87, s87, s33
    buffer_load_dwordx4 off, s[8:11], s87 offset:0 lds
    buffer_load_dwordx4 off, s[8:11], s87 offset:1024 lds
    buffer_load_dwordx4 off, s[8:11], s87 offset:2048 lds
    buffer_load_dwordx4 off, s[8:11], s87 offset:3072 lds
    s_add_u32 s31, s31, 32768
    s_cmp_eq_u32 s31, 98304
    s_cselect_b32 s31, 0, s31
    s_waitcnt vmcnt(8)
    s_barrier
    v_lshl_add_u32 v7, v1, 4, s38
    v_add_u32 v7, 65536, v7
    ds_read_b128 v[32:35], v7 offset:0
    ds_read_b128 v[36:39], v7 offset:1024
    ds_read_b128 v[40:43], v7 offset:2048
    ds_read_b128 v[44:47], v7 offset:3072
    ds_read_b128 v[48:51], v7 offset:32768
    ds_read_b128 v[52:55], v7 offset:33792
    v_lshlrev_b32 v8, 4, v1
    s_lshl_b32 s91, s86, 11
    s_add_u32 s91, s91, s32
    s_waitcnt lgkmcnt(0)
    s_waitcnt vmcnt(4)
    s_barrier
    s_cmp_le_u32 s90, 0
    s_cselect_b32 s88, 7, 0
    s_mov_b32 s89, 1
    s_mul_i32 s87, s85, s89
    s_add_u32 s87, s87, s88
    s_lshl_b32 s87, s87, 13
    s_add_u32 m0, 0, s39
    s_add_u32 s87, s87, s33
    buffer_load_dwordx4 off, s[8:11], s87 offset:0 lds
    buffer_load_dwordx4 off, s[8:11], s87 offset:1024 lds
    buffer_load_dwordx4 off, s[8:11], s87 offset:2048 lds
    buffer_load_dwordx4 off, s[8:11], s87 offset:3072 lds
    s_lshl_b32 s34, s28, 1
    s_add_u32 s34, s34, s55
    s_lshl_b32 s34, s34, 10
    s_add_u32 s34, s34, 39845888
    v_and_b32 v2, 7, v1
    v_lshlrev_b32 v2, 7, v2
    v_mov_b32 v5, 156676
    s_cmp_lg_u32 s3, 4
    s_cbranch_scc1 mlp2_pl
    s_branch mlp2_poll1
mlp2_poll:
    s_sleep 2
mlp2_poll1:
    buffer_load_dword v3, v2, s[16:19], s34 offen sc1
    s_waitcnt vmcnt(0)
    v_cmp_ne_u32 vcc, 1, v3
    s_nop 1
    s_cbranch_vccnz mlp2_poll
    ds_write_b32 v5, v3
    s_branch mlp2_pd
mlp2_pl:
    ds_read_b32 v3, v5
    s_waitcnt lgkmcnt(0)
    v_cmp_ne_u32 vcc, 1, v3
    s_nop 1
    s_cbranch_vccz mlp2_pd
    s_sleep 1
    s_branch mlp2_pl
mlp2_pd:
    s_cmp_le_u32 s90, 0
    s_cselect_b32 s88, 7, 0
    s_mov_b32 s89, 1
    s_lshl_b32 s80, s88, 11
    s_add_u32 s80, s80, s32
    s_add_u32 m0, s31, s38
    s_sub_u32 s87, s89, 1
    buffer_load_dwordx4 off, s[8:11], s80 offset:0 sc1 lds
    buffer_load_dwordx4 off, s[8:11], s80 offset:1024 sc1 lds
    s_lshl_b32 s87, s87, 11
    s_add_u32 s80, s80, s87
    buffer_load_dwordx4 off, s[8:11], s80 offset:2048 sc1 lds
    buffer_load_dwordx4 off, s[8:11], s80 offset:3072 sc1 lds
    s_add_u32 s31, s31, 32768
    s_cmp_eq_u32 s31, 98304
    s_cselect_b32 s31, 0, s31
    s_waitcnt vmcnt(8)
    s_barrier
    s_cmp_le_u32 s90, 1
    s_cselect_b32 s88, 11, 4
    s_call_b64 s[82:83], mlp2_issue
    s_add_u32 s80, s91, 4096
    buffer_store_dwordx4 v[32:35], v8, s[16:19], s80 offen offset:0 sc1
    s_add_u32 s80, s91, 4096
    buffer_store_dwordx4 v[36:39], v8, s[16:19], s80 offen offset:1024 sc1
    s_add_u32 s80, s91, 12288
    buffer_store_dwordx4 v[40:43], v8, s[16:19], s80 offen offset:0 sc1
    s_add_u32 s80, s91, 12288
    buffer_store_dwordx4 v[44:47], v8, s[16:19], s80 offen offset:1024 sc1
    s_add_u32 s80, s91, 6144
    buffer_store_dwordx4 v[48:51], v8, s[16:19], s80 offen offset:0 sc1
    s_add_u32 s80, s91, 6144
    buffer_store_dwordx4 v[52:55], v8, s[16:19], s80 offen offset:1024 sc1
    s_waitcnt vmcnt(14)
    s_barrier
    s_cmp_le_u32 s90, 2
    s_cselect_b32 s88, 14, 7
    s_call_b64 s[82:83], mlp2_issue
    s_waitcnt vmcnt(14)
    s_barrier
    s_cmp_le_u32 s90, 3
    s_cselect_b32 s88, 18, 11
    s_call_b64 s[82:83], mlp2_issue
    s_waitcnt vmcnt(8)
    s_barrier
    s_cmp_le_u32 s90, 4
    s_cselect_b32 s88, 21, 14
    s_call_b64 s[82:83], mlp2_issue
    s_waitcnt vmcnt(8)
    s_barrier
    s_cmp_le_u32 s90, 5
    s_cselect_b32 s88, 25, 18
    s_call_b64 s[82:83], mlp2_issue
    s_waitcnt vmcnt(8)
    s_lshl_b32 s80, s28, 1
    s_add_u32 s80, s80, s55
    s_lshl_b32 s80, s80, 3
    s_add_u32 s80, s80, s29
    s_lshl_b32 s80, s80, 7
    s_add_u32 s80, s80, 39911424
    v_mov_b32 v12, 1
    v_mov_b32 v13, 156696
    v_mov_b32 v11, 1
    s_waitcnt vmcnt(63)
    s_mov_b64 exec, 1
    ds_add_rtn_u32 v11, v13, v11
    s_waitcnt lgkmcnt(0)
    v_cmp_eq_u32 vcc, 3, v11
    s_nop 1
    s_cbranch_vccnz mlp2_l2
    s_add_u32 s80, s80, 64
mlp2_l2:
    buffer_store_dword v12, off, s[16:19], s80 sc1
    s_mov_b64 exec, -1
    s_barrier
    s_cmp_le_u32 s90, 6
    s_cselect_b32 s88, 28, 21
    s_call_b64 s[82:83], mlp2_issue
    s_waitcnt vmcnt(9)
    s_barrier
    s_cmp_le_u32 s90, 7
    s_cselect_b32 s88, 32, 25
    s_call_b64 s[82:83], mlp2_issue
    s_waitcnt vmcnt(8)
    s_barrier
    s_cmp_le_u32 s90, 8
    s_cselect_b32 s88, 35, 28
    s_call_b64 s[82:83], mlp2_issue
    s_waitcnt vmcnt(8)
    s_barrier
    s_cmp_le_u32 s90, 9
    s_cselect_b32 s88, 39, 32
    s_call_b64 s[82:83], mlp2_issue
    s_waitcnt vmcnt(8)
    s_barrier
    s_cmp_le_u32 s90, 10
    s_cselect_b32 s88, 42, 35
    s_call_b64 s[82:83], mlp2_issue
    s_waitcnt vmcnt(8)
    s_barrier
    s_cmp_le_u32 s90, 11
    s_cselect_b32 s88, 46, 39
    s_call_b64 s[82:83], mlp2_issue
    s_lshl_b32 s34, s28, 1
    s_add_u32 s34, s34, s55
    s_lshl_b32 s34, s34, 10
    s_add_u32 s34, s34, 39911424
    v_and_b32 v2, 7, v1
    v_lshlrev_b32 v2, 7, v2
    s_mov_b32 s81, s34
    buffer_load_dword v6, v2, s[16:19], s81 offen sc1
    s_waitcnt vmcnt(9)
    s_barrier
    s_cmp_le_u32 s90, 12
    s_cselect_b32 s88, 49, 42
    s_call_b64 s[82:83], mlp2_issue
    s_waitcnt vmcnt(9)
    s_barrier
    s_cmp_le_u32 s90, 13
    s_cselect_b32 s88, 53, 46
    s_call_b64 s[82:83], mlp2_issue
    s_waitcnt vmcnt(8)
    s_barrier
mlp2_c12:
    v_cmp_ne_u32 vcc, 1, v6
    s_nop 1
    s_cbranch_vccz mlp2_d12
    s_sleep 2
    buffer_load_dword v6, v2, s[16:19], s81 offen sc1
    s_waitcnt vmcnt(0)
    s_branch mlp2_c12
mlp2_d12:
    s_cmp_le_u32 s54, 0
    s_cselect_b32 s88, 9, 2
    s_mov_b32 s89, 4
    s_call_b64 s[82:83], mlp2_issue
    s_waitcnt vmcnt(8)
    s_barrier
    s_cmp_le_u32 s54, 1
    s_cselect_b32 s88, 16, 9
    s_call_b64 s[82:83], mlp2_issue
    s_waitcnt vmcnt(8)
    s_barrier
    s_cmp_le_u32 s54, 2
    s_cselect_b32 s88, 23, 16
    s_call_b64 s[82:83], mlp2_issue
    s_waitcnt vmcnt(8)
    s_barrier
    s_cmp_le_u32 s54, 3
    s_cselect_b32 s88, 30, 23
    s_call_b64 s[82:83], mlp2_issue
    s_waitcnt vmcnt(8)
    s_barrier
    s_cmp_le_u32 s54, 4
    s_cselect_b32 s88, 37, 30
    s_call_b64 s[82:83], mlp2_issue
    s_waitcnt vmcnt(8)
    s_barrier
    s_cmp_le_u32 s54, 5
    s_cselect_b32 s88, 44, 37
    s_call_b64 s[82:83], mlp2_issue
    s_waitcnt vmcnt(8)
    s_barrier
    s_cmp_le_u32 s54, 6
    s_cselect_b32 s88, 51, 44
    s_call_b64 s[82:83], mlp2_issue
    s_waitcnt vmcnt(8)
    s_barrier
    s_mov_b32 s88, 3
    s_mov_b32 s89, 7
    s_call_b64 s[82:83], mlp2_issue
    s_waitcnt vmcnt(8)
    s_barrier
    s_mov_b32 s88, 17
    s_call_b64 s[82:83], mlp2_issue
    s_waitcnt vmcnt(8)
    s_barrier
    s_mov_b32 s88, 31
    s_call_b64 s[82:83], mlp2_issue
    s_waitcnt vmcnt(8)
    s_barrier
    s_mov_b32 s88, 45
    s_call_b64 s[82:83], mlp2_issue
    s_waitcnt vmcnt(8)
    s_barrier
    s_lshr_b32 s35, s37, 1
    s_lshl_b32 s34, s28, 1
    s_add_u32 s34, s34, s35
    s_lshl_b32 s34, s34, 1
    s_add_u32 s34, s34, s55
    s_lshl_b32 s34, s34, 4
    s_lshl_b32 s35, s29, 1
    s_add_u32 s34, s34, s35
    s_and_b32 s35, s37, 1
    s_add_u32 s34, s34, s35
    s_lshl_b32 s34, s34, 12
    s_add_u32 s34, s34, 16777216
    s_lshl_b32 s35, s37, 12
    s_add_u32 m0, s35, 114688
    v_lshlrev_b32 v2, 2, v1
    buffer_load_dwordx4 off, s[8:11], s34 offset:0 sc1 lds
    buffer_load_dwordx4 off, s[8:11], s34 offset:1024 sc1 lds
    buffer_load_dwordx4 off, s[8:11], s34 offset:2048 sc1 lds
    buffer_load_dwordx4 off, s[8:11], s34 offset:3072 sc1 lds
    s_mov_b32 m0, 131072
    s_lshl_b32 s34, s29, 8
    buffer_load_dword v2, s[44:47], s34 offen lds
    s_waitcnt vmcnt(5)
    s_barrier
    s_waitcnt vmcnt(0)
    s_barrier
    s_endpgm
mlp2_issue:
    s_mul_i32 s87, s85, s89
    s_add_u32 s87, s87, s88
    s_lshl_b32 s87, s87, 13
    s_add_u32 m0, s31, s39
    s_add_u32 s87, s87, s33
    buffer_load_dwordx4 off, s[8:11], s87 offset:0 lds
    buffer_load_dwordx4 off, s[8:11], s87 offset:1024 lds
    buffer_load_dwordx4 off, s[8:11], s87 offset:2048 lds
    buffer_load_dwordx4 off, s[8:11], s87 offset:3072 lds
    s_lshl_b32 s80, s88, 11
    s_add_u32 s80, s80, s32
    s_add_u32 m0, s31, s38
    s_sub_u32 s87, s89, 1
    buffer_load_dwordx4 off, s[8:11], s80 offset:0 sc1 lds
    buffer_load_dwordx4 off, s[8:11], s80 offset:1024 sc1 lds
    s_lshl_b32 s87, s87, 11
    s_add_u32 s80, s80, s87
    buffer_load_dwordx4 off, s[8:11], s80 offset:2048 sc1 lds
    buffer_load_dwordx4 off, s[8:11], s80 offset:3072 sc1 lds
    s_add_u32 s31, s31, 32768
    s_cmp_eq_u32 s31, 98304
    s_cselect_b32 s31, 0, s31
    s_setpc_b64 s[82:83]
mlp0_issue:
    s_add_u32 s40, s31, s38
    s_add_u32 s41, s31, s39
    s_add_u32 m0, s40, 0
    s_nop 0
    buffer_load_dwordx4 off, s[8:11], s32 sc1 lds
    buffer_load_dwordx4 off, s[8:11], s32 offset:1024 sc1 lds
    s_add_u32 m0, s41, 0
    s_nop 0
    buffer_load_dwordx4 off, s[8:11], s33  lds
    buffer_load_dwordx4 off, s[8:11], s33 offset:1024  lds
    buffer_load_dwordx4 off, s[8:11], s33 offset:2048  lds
    buffer_load_dwordx4 off, s[8:11], s33 offset:3072  lds
    s_add_u32 s32, s32, 4096
    s_add_u32 s33, s33, 16384
    s_add_u32 s31, s31, 24576
    s_cmp_eq_u32 s31, 140288
    s_cselect_b32 s31, 17408, s31
    s_setpc_b64 s[82:83]
mlp1_issue:
    s_add_u32 s40, s31, s38
    s_add_u32 s41, s31, s39
    s_add_u32 m0, s40, 0
    s_nop 0
    buffer_load_dwordx4 off, s[8:11], s32 sc1 lds
    buffer_load_dwordx4 off, s[8:11], s32 offset:1024 sc1 lds
    buffer_load_dwordx4 off, s[8:11], s32 offset:2048 sc1 lds
    buffer_load_dwordx4 off, s[8:11], s32 offset:3072 sc1 lds
    s_add_u32 m0, s41, 0
    s_nop 0
    buffer_load_dwordx4 off, s[8:11], s33  lds
    buffer_load_dwordx4 off, s[8:11], s33 offset:1024  lds
    buffer_load_dwordx4 off, s[8:11], s33 offset:2048  lds
    buffer_load_dwordx4 off, s[8:11], s33 offset:3072  lds
    s_add_u32 m0, s41, 4096
    s_add_u32 s80, s33, 4096
    buffer_load_dwordx4 off, s[8:11], s80  lds
    buffer_load_dwordx4 off, s[8:11], s80 offset:1024  lds
    buffer_load_dwordx4 off, s[8:11], s80 offset:2048  lds
    s_add_u32 s32, s32, 4096
    s_add_u32 s33, s33, 28672
    s_add_u32 s31, s31, 45056
    s_cmp_eq_u32 s31, 135168
    s_cselect_b32 s31, 0, s31
    s_setpc_b64 s[82:83]
mlp_cons:
    s_load_dwordx2 s[12:13], s[0:1], 0
    s_load_dwordx2 s[24:25], s[0:1], 40
    s_load_dwordx2 s[20:21], s[0:1], 64
    s_load_dwordx2 s[44:45], s[0:1], 56
    s_and_b32 s34, s2, 7
    s_lshr_b32 s35, s2, 3
    s_and_b32 s28, s34, 3
    s_lshl_b32 s28, s28, 3
    s_and_b32 s36, s35, 7
    s_add_u32 s28, s28, s36
    s_lshr_b32 s29, s34, 2
    s_mul_i32 s29, s29, 4
    s_lshr_b32 s36, s35, 3
    s_add_u32 s29, s29, s36
    s_mov_b32 s14, 4194304
    s_mov_b32 s15, 0x20000
    s_mov_b32 s26, 7168
    s_mov_b32 s27, 0x20000
    s_mov_b32 s22, 4194304
    s_mov_b32 s23, 0x20000
    s_mov_b32 s46, 2048
    s_mov_b32 s47, 0x20000
    s_lshr_b32 s38, s3, 1
    s_and_b32 s39, s3, 1
    v_lshrrev_b32 v14, 4, v1
    v_and_b32 v15, 15, v1
    s_mul_i32 s34, s38, 4096
    v_lshl_add_u32 v2, v1, 4, s34
    s_mul_i32 s34, s39, 4096
    s_add_u32 s34, s34, 8192
    v_lshl_add_u32 v6, v1, 4, s34
    s_waitcnt lgkmcnt(0)
    v_mov_b32 v16, 0
    v_mov_b32 v17, 0
    v_mov_b32 v18, 0
    v_mov_b32 v19, 0
    v_mov_b32 v20, 0
    v_mov_b32 v21, 0
    v_mov_b32 v22, 0
    v_mov_b32 v23, 0
    v_mov_b32 v24, 0
    v_mov_b32 v25, 0
    v_mov_b32 v26, 0
    v_mov_b32 v27, 0
    v_mov_b32 v28, 0
    v_mov_b32 v29, 0
    v_mov_b32 v30, 0
    v_mov_b32 v31, 0
    v_mov_b32 v32, 0
    v_mov_b32 v33, 0
    v_mov_b32 v34, 0
    v_mov_b32 v35, 0
    v_mov_b32 v36, 0
    v_mov_b32 v37, 0
    v_mov_b32 v38, 0
    v_mov_b32 v39, 0
    v_mov_b32 v40, 0
    v_mov_b32 v41, 0
    v_mov_b32 v42, 0
    v_mov_b32 v43, 0
    v_mov_b32 v44, 0
    v_mov_b32 v45, 0
    v_mov_b32 v46, 0
    v_mov_b32 v47, 0
    s_mov_b32 s31, 66560
    v_add_u32 v4, s31, v2
    v_add_u32 v10, s31, v6
    s_add_u32 s31, s31, 24576
    s_cmp_eq_u32 s31, 140288
    s_cselect_b32 s31, 17408, s31
    s_barrier
    ds_read_b128 v[64:67], v10 offset:0
    ds_read_b128 v[48:51], v4 offset:0
    ds_read_b128 v[56:59], v4 offset:1024
    ds_read_b128 v[72:75], v10 offset:1024
    ds_read_b128 v[80:83], v10 offset:2048
    ds_read_b128 v[88:91], v10 offset:3072
    s_mov_b32 s30, 0
    s_mov_b32 s53, 16
.p2align 6
mlp0_cloop:
    s_waitcnt lgkmcnt(4)
    v_mfma_f32_16x16x32_bf16 v[16:19], v[64:67], v[48:51], v[16:19]
    ds_read_b128 v[68:71], v10 offset:8192
    ds_read_b128 v[52:55], v4 offset:2048
    s_waitcnt lgkmcnt(5)
    v_mfma_f32_16x16x32_bf16 v[32:35], v[64:67], v[56:59], v[32:35]
    ds_read_b128 v[60:63], v4 offset:3072
    s_waitcnt lgkmcnt(5)
    v_mfma_f32_16x16x32_bf16 v[20:23], v[72:75], v[48:51], v[20:23]
    ds_read_b128 v[76:79], v10 offset:9216
    v_mfma_f32_16x16x32_bf16 v[36:39], v[72:75], v[56:59], v[36:39]
    ds_read_b128 v[84:87], v10 offset:10240
    s_waitcnt lgkmcnt(6)
    v_mfma_f32_16x16x32_bf16 v[24:27], v[80:83], v[48:51], v[24:27]
    ds_read_b128 v[92:95], v10 offset:11264
    v_mfma_f32_16x16x32_bf16 v[40:43], v[80:83], v[56:59], v[40:43]
    s_waitcnt lgkmcnt(6)
    v_mfma_f32_16x16x32_bf16 v[28:31], v[88:91], v[48:51], v[28:31]
    v_mfma_f32_16x16x32_bf16 v[44:47], v[88:91], v[56:59], v[44:47]
    s_waitcnt lgkmcnt(0)
    v_mfma_f32_16x16x32_bf16 v[16:19], v[68:71], v[52:55], v[16:19]
    v_add_u32 v4, s31, v2
    v_mfma_f32_16x16x32_bf16 v[32:35], v[68:71], v[60:63], v[32:35]
    v_add_u32 v10, s31, v6
    s_barrier
    v_mfma_f32_16x16x32_bf16 v[20:23], v[76:79], v[52:55], v[20:23]
    ds_read_b128 v[64:67], v10 offset:0
    ds_read_b128 v[48:51], v4 offset:0
    v_mfma_f32_16x16x32_bf16 v[36:39], v[76:79], v[60:63], v[36:39]
    ds_read_b128 v[56:59], v4 offset:1024
    ds_read_b128 v[72:75], v10 offset:1024
    v_mfma_f32_16x16x32_bf16 v[24:27], v[84:87], v[52:55], v[24:27]
    ds_read_b128 v[80:83], v10 offset:2048
    ds_read_b128 v[88:91], v10 offset:3072
    s_add_u32 s31, s31, 24576
    s_cmp_eq_u32 s31, 140288
    v_mfma_f32_16x16x32_bf16 v[40:43], v[84:87], v[60:63], v[40:43]
    s_cselect_b32 s31, 17408, s31
    v_mfma_f32_16x16x32_bf16 v[28:31], v[92:95], v[52:55], v[28:31]
    s_add_u32 s30, s30, 1
    s_cmp_lt_u32 s30, s53
    v_mfma_f32_16x16x32_bf16 v[44:47], v[92:95], v[60:63], v[44:47]
    s_cbranch_scc1 mlp0_cloop
    s_waitcnt lgkmcnt(0)
    s_nop 7
    s_lshl_b32 s34, s39, 3
    v_lshrrev_b32 v8, 1, v14
    v_add_u32 v8, s34, v8
    v_xor_b32 v8, v8, v15
    v_lshlrev_b32 v8, 4, v8
    v_lshl_add_u32 v8, v15, 8, v8
    v_and_b32 v9, 1, v14
    v_lshl_add_u32 v8, v9, 3, v8
    s_lshl_b32 s34, s38, 13
    s_add_u32 s34, s34, 140288
    v_xor_b32 v9, 0, v8
    v_add_u32 v9, s34, v9
    ds_read_b64 v[224:225], v9 offset:0
    ds_read_b64 v[232:233], v9 offset:4096
    v_xor_b32 v9, 32, v8
    v_add_u32 v9, s34, v9
    ds_read_b64 v[226:227], v9 offset:0
    ds_read_b64 v[234:235], v9 offset:4096
    v_xor_b32 v9, 64, v8
    v_add_u32 v9, s34, v9
    ds_read_b64 v[228:229], v9 offset:0
    ds_read_b64 v[236:237], v9 offset:4096
    v_xor_b32 v9, 96, v8
    v_add_u32 v9, s34, v9
    ds_read_b64 v[230:231], v9 offset:0
    ds_read_b64 v[238:239], v9 offset:4096
    s_lshl_b32 s34, s28, 1
    s_add_u32 s34, s34, s38
    s_lshl_b32 s35, s29, 1
    s_add_u32 s35, s35, s39
    s_lshl_b32 s40, s34, 4
    s_add_u32 s40, s40, s35
    s_lshl_b32 s40, s40, 12
    s_add_u32 s40, s40, 16777216
    s_lshl_b32 s42, s35, 14
    s_lshl_b32 s43, s34, 8
    s_add_u32 s42, s42, s43
    s_add_u32 s42, s42, 38797312
    v_lshlrev_b32 v6, 4, v1
    v_and_b32 v7, 31, v1
    v_lshlrev_b32 v7, 3, v7
    s_waitcnt lgkmcnt(0)
    v_lshlrev_b32 v48, 16, v224
    v_and_b32 v49, 0xffff0000, v224
    v_lshlrev_b32 v50, 16, v225
    v_and_b32 v51, 0xffff0000, v225
    v_lshlrev_b32 v52, 16, v226
    v_and_b32 v53, 0xffff0000, v226
    v_lshlrev_b32 v54, 16, v227
    v_and_b32 v55, 0xffff0000, v227
    v_lshlrev_b32 v56, 16, v228
    v_and_b32 v57, 0xffff0000, v228
    v_lshlrev_b32 v58, 16, v229
    v_and_b32 v59, 0xffff0000, v229
    v_lshlrev_b32 v60, 16, v230
    v_and_b32 v61, 0xffff0000, v230
    v_lshlrev_b32 v62, 16, v231
    v_and_b32 v63, 0xffff0000, v231
    v_pk_add_f32 v[16:17], v[16:17], v[48:49]
    v_pk_add_f32 v[18:19], v[18:19], v[50:51]
    v_pk_add_f32 v[20:21], v[20:21], v[52:53]
    v_pk_add_f32 v[22:23], v[22:23], v[54:55]
    v_pk_add_f32 v[24:25], v[24:25], v[56:57]
    v_pk_add_f32 v[26:27], v[26:27], v[58:59]
    v_pk_add_f32 v[28:29], v[28:29], v[60:61]
    v_pk_add_f32 v[30:31], v[30:31], v[62:63]
    v_pk_add_f32 v[64:65], v[16:17], v[18:19]
    v_pk_mul_f32 v[66:67], v[16:17], v[16:17]
    v_pk_fma_f32 v[66:67], v[18:19], v[18:19], v[66:67]
    v_pk_add_f32 v[64:65], v[64:65], v[20:21]
    v_pk_fma_f32 v[66:67], v[20:21], v[20:21], v[66:67]
    v_pk_add_f32 v[64:65], v[64:65], v[22:23]
    v_pk_fma_f32 v[66:67], v[22:23], v[22:23], v[66:67]
    v_pk_add_f32 v[64:65], v[64:65], v[24:25]
    v_pk_fma_f32 v[66:67], v[24:25], v[24:25], v[66:67]
    v_pk_add_f32 v[64:65], v[64:65], v[26:27]
    v_pk_fma_f32 v[66:67], v[26:27], v[26:27], v[66:67]
    v_pk_add_f32 v[64:65], v[64:65], v[28:29]
    v_pk_fma_f32 v[66:67], v[28:29], v[28:29], v[66:67]
    v_pk_add_f32 v[64:65], v[64:65], v[30:31]
    v_pk_fma_f32 v[66:67], v[30:31], v[30:31], v[66:67]
    v_add_f32 v64, v64, v65
    v_add_f32 v65, v66, v67
    v_cvt_pk_bf16_f32 v16, v16, v17
    v_cvt_pk_bf16_f32 v17, v18, v19
    v_cvt_pk_bf16_f32 v18, v20, v21
    v_cvt_pk_bf16_f32 v19, v22, v23
    v_cvt_pk_bf16_f32 v20, v24, v25
    v_cvt_pk_bf16_f32 v21, v26, v27
    v_cvt_pk_bf16_f32 v22, v28, v29
    v_cvt_pk_bf16_f32 v23, v30, v31
    buffer_store_dwordx4 v[16:19], v6, s[16:19], s40 offen offset:0 sc1
    buffer_store_dwordx4 v[20:23], v6, s[16:19], s40 offen offset:2048 sc1
    v_lshlrev_b32 v48, 16, v232
    v_and_b32 v49, 0xffff0000, v232
    v_lshlrev_b32 v50, 16, v233
    v_and_b32 v51, 0xffff0000, v233
    v_lshlrev_b32 v52, 16, v234
    v_and_b32 v53, 0xffff0000, v234
    v_lshlrev_b32 v54, 16, v235
    v_and_b32 v55, 0xffff0000, v235
    v_lshlrev_b32 v56, 16, v236
    v_and_b32 v57, 0xffff0000, v236
    v_lshlrev_b32 v58, 16, v237
    v_and_b32 v59, 0xffff0000, v237
    v_lshlrev_b32 v60, 16, v238
    v_and_b32 v61, 0xffff0000, v238
    v_lshlrev_b32 v62, 16, v239
    v_and_b32 v63, 0xffff0000, v239
    v_pk_add_f32 v[32:33], v[32:33], v[48:49]
    v_pk_add_f32 v[34:35], v[34:35], v[50:51]
    v_pk_add_f32 v[36:37], v[36:37], v[52:53]
    v_pk_add_f32 v[38:39], v[38:39], v[54:55]
    v_pk_add_f32 v[40:41], v[40:41], v[56:57]
    v_pk_add_f32 v[42:43], v[42:43], v[58:59]
    v_pk_add_f32 v[44:45], v[44:45], v[60:61]
    v_pk_add_f32 v[46:47], v[46:47], v[62:63]
    v_pk_add_f32 v[68:69], v[32:33], v[34:35]
    v_pk_mul_f32 v[70:71], v[32:33], v[32:33]
    v_pk_fma_f32 v[70:71], v[34:35], v[34:35], v[70:71]
    v_pk_add_f32 v[68:69], v[68:69], v[36:37]
    v_pk_fma_f32 v[70:71], v[36:37], v[36:37], v[70:71]
    v_pk_add_f32 v[68:69], v[68:69], v[38:39]
    v_pk_fma_f32 v[70:71], v[38:39], v[38:39], v[70:71]
    v_pk_add_f32 v[68:69], v[68:69], v[40:41]
    v_pk_fma_f32 v[70:71], v[40:41], v[40:41], v[70:71]
    v_pk_add_f32 v[68:69], v[68:69], v[42:43]
    v_pk_fma_f32 v[70:71], v[42:43], v[42:43], v[70:71]
    v_pk_add_f32 v[68:69], v[68:69], v[44:45]
    v_pk_fma_f32 v[70:71], v[44:45], v[44:45], v[70:71]
    v_pk_add_f32 v[68:69], v[68:69], v[46:47]
    v_pk_fma_f32 v[70:71], v[46:47], v[46:47], v[70:71]
    v_add_f32 v68, v68, v69
    v_add_f32 v69, v70, v71
    v_cvt_pk_bf16_f32 v32, v32, v33
    v_cvt_pk_bf16_f32 v33, v34, v35
    v_cvt_pk_bf16_f32 v34, v36, v37
    v_cvt_pk_bf16_f32 v35, v38, v39
    v_cvt_pk_bf16_f32 v36, v40, v41
    v_cvt_pk_bf16_f32 v37, v42, v43
    v_cvt_pk_bf16_f32 v38, v44, v45
    v_cvt_pk_bf16_f32 v39, v46, v47
    buffer_store_dwordx4 v[32:35], v6, s[16:19], s40 offen offset:1024 sc1
    buffer_store_dwordx4 v[36:39], v6, s[16:19], s40 offen offset:3072 sc1
    v_permlane16_swap_b32 v64, v68
    v_permlane16_swap_b32 v65, v69
    v_pk_add_f32 v[64:65], v[64:65], v[68:69]
    v_mov_b32 v68, v64
    v_mov_b32 v69, v65
    s_nop 1
    v_permlane32_swap_b32 v64, v68
    v_permlane32_swap_b32 v65, v69
    v_pk_add_f32 v[64:65], v[64:65], v[68:69]
    buffer_store_dwordx2 v[64:65], v7, s[16:19], s42 offen sc1
    s_lshl_b32 s34, s28, 3
    s_add_u32 s34, s34, s29
    s_lshl_b32 s34, s34, 2
    s_add_u32 s34, s34, 0
    s_lshl_b32 s34, s34, 5
    s_add_u32 s34, s34, 39878656
    v_mov_b32 v12, 1
    v_mov_b32 v13, 156688
    v_mov_b32 v11, 1
    s_waitcnt vmcnt(0)
    s_mov_b64 exec, 1
    ds_add_rtn_u32 v11, v13, v11
    s_waitcnt lgkmcnt(0)
    v_cmp_eq_u32 vcc, 3, v11
    s_nop 1
    s_cbranch_vccz mlp_fh
    buffer_store_dword v12, off, s[16:19], s34 sc1
mlp_fh:
    s_mov_b64 exec, -1
    s_and_b32 s34, s2, 7
    s_lshr_b32 s35, s2, 3
    s_and_b32 s28, s34, 1
    s_lshl_b32 s28, s28, 3
    s_and_b32 s36, s35, 7
    s_add_u32 s28, s28, s36
    s_lshr_b32 s29, s34, 1
    s_mul_i32 s29, s29, 4
    s_lshr_b32 s36, s35, 3
    s_add_u32 s29, s29, s36
    s_lshr_b32 s55, s29, 3
    s_and_b32 s54, s29, 7
    s_lshr_b32 s38, s3, 1
    s_and_b32 s39, s3, 1
    v_lshrrev_b32 v14, 4, v1
    v_and_b32 v15, 15, v1
    s_mul_i32 s34, s38, 8192
    v_lshl_add_u32 v2, v1, 4, s34
    s_mul_i32 s34, s39, 7168
    s_add_u32 s34, s34, 16384
    v_lshl_add_u32 v6, v1, 4, s34
    s_waitcnt lgkmcnt(0)
    v_mov_b32 v16, 0
    v_mov_b32 v17, 0
    v_mov_b32 v18, 0
    v_mov_b32 v19, 0
    v_mov_b32 v20, 0
    v_mov_b32 v21, 0
    v_mov_b32 v22, 0
    v_mov_b32 v23, 0
    v_mov_b32 v24, 0
    v_mov_b32 v25, 0
    v_mov_b32 v26, 0
    v_mov_b32 v27, 0
    v_mov_b32 v28, 0
    v_mov_b32 v29, 0
    v_mov_b32 v30, 0
    v_mov_b32 v31, 0
    v_mov_b32 v32, 0
    v_mov_b32 v33, 0
    v_mov_b32 v34, 0
    v_mov_b32 v35, 0
    v_mov_b32 v36, 0
    v_mov_b32 v37, 0
    v_mov_b32 v38, 0
    v_mov_b32 v39, 0
    v_mov_b32 v40, 0
    v_mov_b32 v41, 0
    v_mov_b32 v42, 0
    v_mov_b32 v43, 0
    v_mov_b32 v44, 0
    v_mov_b32 v45, 0
    v_mov_b32 v46, 0
    v_mov_b32 v47, 0
    v_mov_b32 v48, 0
    v_mov_b32 v49, 0
    v_mov_b32 v50, 0
    v_mov_b32 v51, 0
    v_mov_b32 v52, 0
    v_mov_b32 v53, 0
    v_mov_b32 v54, 0
    v_mov_b32 v55, 0
    v_mov_b32 v56, 0
    v_mov_b32 v57, 0
    v_mov_b32 v58, 0
    v_mov_b32 v59, 0
    v_mov_b32 v60, 0
    v_mov_b32 v61, 0
    v_mov_b32 v62, 0
    v_mov_b32 v63, 0
    v_mov_b32 v64, 0
    v_mov_b32 v65, 0
    v_mov_b32 v66, 0
    v_mov_b32 v67, 0
    v_mov_b32 v68, 0
    v_mov_b32 v69, 0
    v_mov_b32 v70, 0
    v_mov_b32 v71, 0
    v_mov_b32 v72, 0
    v_mov_b32 v73, 0
    v_mov_b32 v74, 0
    v_mov_b32 v75, 0
    v_mov_b32 v76, 0
    v_mov_b32 v77, 0
    v_mov_b32 v78, 0
    v_mov_b32 v79, 0
    v_mov_b32 v80, 0
    v_mov_b32 v81, 0
    v_mov_b32 v82, 0
    v_mov_b32 v83, 0
    v_mov_b32 v84, 0
    v_mov_b32 v85, 0
    v_mov_b32 v86, 0
    v_mov_b32 v87, 0
    v_mov_b32 v88, 0
    v_mov_b32 v89, 0
    v_mov_b32 v90, 0
    v_mov_b32 v91, 0
    v_mov_b32 v92, 0
    v_mov_b32 v93, 0
    v_mov_b32 v94, 0
    v_mov_b32 v95, 0
    v_mov_b32 v96, 0
    v_mov_b32 v97, 0
    v_mov_b32 v98, 0
    v_mov_b32 v99, 0
    v_mov_b32 v100, 0
    v_mov_b32 v101, 0
    v_mov_b32 v102, 0
    v_mov_b32 v103, 0
    v_mov_b32 v104, 0
    v_mov_b32 v105, 0
    v_mov_b32 v106, 0
    v_mov_b32 v107, 0
    v_mov_b32 v108, 0
    v_mov_b32 v109, 0
    v_mov_b32 v110, 0
    v_mov_b32 v111, 0
    v_mov_b32 v112, 0
    v_mov_b32 v113, 0
    v_mov_b32 v114, 0
    v_mov_b32 v115, 0
    v_mov_b32 v116, 0
    v_mov_b32 v117, 0
    v_mov_b32 v118, 0
    v_mov_b32 v119, 0
    v_mov_b32 v120, 0
    v_mov_b32 v121, 0
    v_mov_b32 v122, 0
    v_mov_b32 v123, 0
    v_mov_b32 v124, 0
    v_mov_b32 v125, 0
    v_mov_b32 v126, 0
    v_mov_b32 v127, 0
    s_mov_b32 s31, 0
    v_add_u32 v4, s31, v2
    v_add_u32 v10, s31, v6
    s_add_u32 s31, s31, 45056
    s_cmp_eq_u32 s31, 135168
    s_cselect_b32 s31, 0, s31
    s_barrier
    ds_read_b128 v[160:163], v10 offset:0
    ds_read_b128 v[128:131], v4 offset:0
    ds_read_b128 v[136:139], v4 offset:1024
    ds_read_b128 v[144:147], v4 offset:4096
    ds_read_b128 v[152:155], v4 offset:5120
    ds_read_b128 v[168:171], v10 offset:1024
    ds_read_b128 v[176:179], v10 offset:2048
    ds_read_b128 v[184:187], v10 offset:3072
    ds_read_b128 v[192:195], v10 offset:4096
    ds_read_b128 v[200:203], v10 offset:5120
    ds_read_b128 v[208:211], v10 offset:6144
    s_mov_b32 s30, 0
    s_mov_b32 s53, 16
.p2align 6
mlp1_cloop:
    s_waitcnt lgkmcnt(9)
    v_mfma_f32_16x16x32_bf16 v[16:19], v[160:163], v[128:131], v[16:19]
    ds_read_b128 v[164:167], v10 offset:14336
    s_waitcnt lgkmcnt(9)
    v_mfma_f32_16x16x32_bf16 v[44:47], v[160:163], v[136:139], v[44:47]
    ds_read_b128 v[132:135], v4 offset:2048
    s_waitcnt lgkmcnt(9)
    v_mfma_f32_16x16x32_bf16 v[72:75], v[160:163], v[144:147], v[72:75]
    ds_read_b128 v[140:143], v4 offset:3072
    s_waitcnt lgkmcnt(9)
    v_mfma_f32_16x16x32_bf16 v[100:103], v[160:163], v[152:155], v[100:103]
    ds_read_b128 v[148:151], v4 offset:6144
    s_waitcnt lgkmcnt(9)
    v_mfma_f32_16x16x32_bf16 v[20:23], v[168:171], v[128:131], v[20:23]
    ds_read_b128 v[156:159], v4 offset:7168
    v_mfma_f32_16x16x32_bf16 v[48:51], v[168:171], v[136:139], v[48:51]
    ds_read_b128 v[172:175], v10 offset:15360
    v_mfma_f32_16x16x32_bf16 v[76:79], v[168:171], v[144:147], v[76:79]
    ds_read_b128 v[180:183], v10 offset:16384
    v_mfma_f32_16x16x32_bf16 v[104:107], v[168:171], v[152:155], v[104:107]
    ds_read_b128 v[188:191], v10 offset:17408
    s_waitcnt lgkmcnt(12)
    v_mfma_f32_16x16x32_bf16 v[24:27], v[176:179], v[128:131], v[24:27]
    ds_read_b128 v[196:199], v10 offset:18432
    v_mfma_f32_16x16x32_bf16 v[52:55], v[176:179], v[136:139], v[52:55]
    ds_read_b128 v[204:207], v10 offset:19456
    v_mfma_f32_16x16x32_bf16 v[80:83], v[176:179], v[144:147], v[80:83]
    ds_read_b128 v[212:215], v10 offset:20480
    v_mfma_f32_16x16x32_bf16 v[108:111], v[176:179], v[152:155], v[108:111]
    s_waitcnt lgkmcnt(14)
    v_mfma_f32_16x16x32_bf16 v[28:31], v[184:187], v[128:131], v[28:31]
    v_mfma_f32_16x16x32_bf16 v[56:59], v[184:187], v[136:139], v[56:59]
    v_mfma_f32_16x16x32_bf16 v[84:87], v[184:187], v[144:147], v[84:87]
    v_mfma_f32_16x16x32_bf16 v[112:115], v[184:187], v[152:155], v[112:115]
    s_waitcnt lgkmcnt(13)
    v_mfma_f32_16x16x32_bf16 v[32:35], v[192:195], v[128:131], v[32:35]
    v_mfma_f32_16x16x32_bf16 v[60:63], v[192:195], v[136:139], v[60:63]
    v_mfma_f32_16x16x32_bf16 v[88:91], v[192:195], v[144:147], v[88:91]
    v_mfma_f32_16x16x32_bf16 v[116:119], v[192:195], v[152:155], v[116:119]
    s_waitcnt lgkmcnt(12)
    v_mfma_f32_16x16x32_bf16 v[36:39], v[200:203], v[128:131], v[36:39]
    v_mfma_f32_16x16x32_bf16 v[64:67], v[200:203], v[136:139], v[64:67]
    v_mfma_f32_16x16x32_bf16 v[92:95], v[200:203], v[144:147], v[92:95]
    v_mfma_f32_16x16x32_bf16 v[120:123], v[200:203], v[152:155], v[120:123]
    s_waitcnt lgkmcnt(11)
    v_mfma_f32_16x16x32_bf16 v[40:43], v[208:211], v[128:131], v[40:43]
    v_mfma_f32_16x16x32_bf16 v[68:71], v[208:211], v[136:139], v[68:71]
    v_mfma_f32_16x16x32_bf16 v[96:99], v[208:211], v[144:147], v[96:99]
    v_mfma_f32_16x16x32_bf16 v[124:127], v[208:211], v[152:155], v[124:127]
    s_waitcnt lgkmcnt(0)
    v_mfma_f32_16x16x32_bf16 v[16:19], v[164:167], v[132:135], v[16:19]
    v_add_u32 v4, s31, v2
    v_mfma_f32_16x16x32_bf16 v[44:47], v[164:167], v[140:143], v[44:47]
    v_add_u32 v10, s31, v6
    s_barrier
    v_mfma_f32_16x16x32_bf16 v[72:75], v[164:167], v[148:151], v[72:75]
    ds_read_b128 v[160:163], v10 offset:0
    v_mfma_f32_16x16x32_bf16 v[100:103], v[164:167], v[156:159], v[100:103]
    ds_read_b128 v[128:131], v4 offset:0
    v_mfma_f32_16x16x32_bf16 v[20:23], v[172:175], v[132:135], v[20:23]
    ds_read_b128 v[136:139], v4 offset:1024
    v_mfma_f32_16x16x32_bf16 v[48:51], v[172:175], v[140:143], v[48:51]
    ds_read_b128 v[144:147], v4 offset:4096
    v_mfma_f32_16x16x32_bf16 v[76:79], v[172:175], v[148:151], v[76:79]
    ds_read_b128 v[152:155], v4 offset:5120
    v_mfma_f32_16x16x32_bf16 v[104:107], v[172:175], v[156:159], v[104:107]
    ds_read_b128 v[168:171], v10 offset:1024
    v_mfma_f32_16x16x32_bf16 v[24:27], v[180:183], v[132:135], v[24:27]
    ds_read_b128 v[176:179], v10 offset:2048
    v_mfma_f32_16x16x32_bf16 v[52:55], v[180:183], v[140:143], v[52:55]
    ds_read_b128 v[184:187], v10 offset:3072
    v_mfma_f32_16x16x32_bf16 v[80:83], v[180:183], v[148:151], v[80:83]
    ds_read_b128 v[192:195], v10 offset:4096
    v_mfma_f32_16x16x32_bf16 v[108:111], v[180:183], v[156:159], v[108:111]
    ds_read_b128 v[200:203], v10 offset:5120
    v_mfma_f32_16x16x32_bf16 v[28:31], v[188:191], v[132:135], v[28:31]
    ds_read_b128 v[208:211], v10 offset:6144
    v_mfma_f32_16x16x32_bf16 v[56:59], v[188:191], v[140:143], v[56:59]
    s_add_u32 s31, s31, 45056
    s_cmp_eq_u32 s31, 135168
    v_mfma_f32_16x16x32_bf16 v[84:87], v[188:191], v[148:151], v[84:87]
    s_cselect_b32 s31, 0, s31
    v_mfma_f32_16x16x32_bf16 v[112:115], v[188:191], v[156:159], v[112:115]
    v_mfma_f32_16x16x32_bf16 v[32:35], v[196:199], v[132:135], v[32:35]
    v_mfma_f32_16x16x32_bf16 v[60:63], v[196:199], v[140:143], v[60:63]
    v_mfma_f32_16x16x32_bf16 v[88:91], v[196:199], v[148:151], v[88:91]
    v_mfma_f32_16x16x32_bf16 v[116:119], v[196:199], v[156:159], v[116:119]
    v_mfma_f32_16x16x32_bf16 v[36:39], v[204:207], v[132:135], v[36:39]
    v_mfma_f32_16x16x32_bf16 v[64:67], v[204:207], v[140:143], v[64:67]
    v_mfma_f32_16x16x32_bf16 v[92:95], v[204:207], v[148:151], v[92:95]
    v_mfma_f32_16x16x32_bf16 v[120:123], v[204:207], v[156:159], v[120:123]
    v_mfma_f32_16x16x32_bf16 v[40:43], v[212:215], v[132:135], v[40:43]
    v_mfma_f32_16x16x32_bf16 v[68:71], v[212:215], v[140:143], v[68:71]
    v_mfma_f32_16x16x32_bf16 v[96:99], v[212:215], v[148:151], v[96:99]
    s_add_u32 s30, s30, 1
    s_cmp_lt_u32 s30, s53
    v_mfma_f32_16x16x32_bf16 v[124:127], v[212:215], v[156:159], v[124:127]
    s_cbranch_scc1 mlp1_cloop
    s_waitcnt lgkmcnt(0)
    s_nop 7
    v_mov_b32 v250, 0xc0135761
    v_mov_b32 v251, 0xbdd2d3e8
    v_mov_b32 v248, 1.0
    v_mov_b32 v249, 1.0
    s_lshl_b32 s34, s38, 8
    s_add_u32 s34, s34, 135168
    v_lshl_add_u32 v2, v15, 2, s34
    s_mul_i32 s35, s39, 448
    s_add_u32 s35, s35, 136192
    v_lshl_add_u32 v3, v14, 4, s35
    ds_read_b32 v128, v2 offset:0
    ds_read_b32 v129, v2 offset:512
    ds_read_b32 v130, v2 offset:64
    ds_read_b32 v131, v2 offset:576
    ds_read_b32 v132, v2 offset:128
    ds_read_b32 v133, v2 offset:640
    ds_read_b32 v134, v2 offset:192
    ds_read_b32 v135, v2 offset:704
    ds_read_b128 v[136:139], v3 offset:0
    ds_read_b128 v[140:143], v3 offset:1024
    s_lshl_b32 s34, s28, 2
    s_lshl_b32 s35, s38, 1
    s_add_u32 s34, s34, s35
    s_mul_i32 s34, s34, 112
    s_mul_i32 s35, s29, 7
    s_add_u32 s34, s34, s35
    s_mul_i32 s35, s39, 3
    s_add_u32 s40, s34, s35
    s_lshl_b32 s40, s40, 11
    s_add_u32 s40, s40, 20971520
    s_add_u32 s41, s40, 229376
    v_lshlrev_b32 v6, 4, v1
    s_lshl_b32 s34, s38, 13
    v_add_u32 v7, s34, v6
    v_add_u32 v8, 65536, v7
    s_lshl_b32 s92, s28, 4
    s_add_u32 s92, s92, s29
    s_lshl_b32 s92, s92, 2
    s_add_u32 s92, s92, 0
    s_lshl_b32 s92, s92, 5
    s_add_u32 s92, s92, 39845888
    v_mov_b32 v12, 1
    s_cmp_eq_u32 s39, 0
    s_cbranch_scc0 mlp1_e1
    ds_read_b128 v[144:147], v3 offset:64
    ds_read_b128 v[148:151], v3 offset:1088
    s_waitcnt lgkmcnt(2)
    v_pk_fma_f32 v[152:153], v[136:137], v[128:129], v[140:141] op_sel:[0,1,0] op_sel_hi:[1,1,1] neg_lo:[1,0,0] neg_hi:[1,0,0]
    v_pk_fma_f32 v[154:155], v[138:139], v[128:129], v[142:143] op_sel:[0,1,0] op_sel_hi:[1,1,1] neg_lo:[1,0,0] neg_hi:[1,0,0]
    v_pk_fma_f32 v[156:157], v[136:137], v[130:131], v[140:141] op_sel:[0,1,0] op_sel_hi:[1,1,1] neg_lo:[1,0,0] neg_hi:[1,0,0]
    v_pk_fma_f32 v[158:159], v[138:139], v[130:131], v[142:143] op_sel:[0,1,0] op_sel_hi:[1,1,1] neg_lo:[1,0,0] neg_hi:[1,0,0]
    v_pk_fma_f32 v[160:161], v[136:137], v[132:133], v[140:141] op_sel:[0,1,0] op_sel_hi:[1,1,1] neg_lo:[1,0,0] neg_hi:[1,0,0]
    v_pk_fma_f32 v[162:163], v[138:139], v[132:133], v[142:143] op_sel:[0,1,0] op_sel_hi:[1,1,1] neg_lo:[1,0,0] neg_hi:[1,0,0]
    v_pk_fma_f32 v[164:165], v[136:137], v[134:135], v[140:141] op_sel:[0,1,0] op_sel_hi:[1,1,1] neg_lo:[1,0,0] neg_hi:[1,0,0]
    v_pk_fma_f32 v[166:167], v[138:139], v[134:135], v[142:143] op_sel:[0,1,0] op_sel_hi:[1,1,1] neg_lo:[1,0,0] neg_hi:[1,0,0]
    v_pk_fma_f32 v[16:17], v[16:17], v[128:129], v[152:153] op_sel_hi:[1,0,1]
    v_pk_fma_f32 v[18:19], v[18:19], v[128:129], v[154:155] op_sel_hi:[1,0,1]
    v_pk_fma_f32 v[44:45], v[44:45], v[130:131], v[156:157] op_sel_hi:[1,0,1]
    v_pk_fma_f32 v[46:47], v[46:47], v[130:131], v[158:159] op_sel_hi:[1,0,1]
    v_pk_fma_f32 v[72:73], v[72:73], v[132:133], v[160:161] op_sel_hi:[1,0,1]
    v_pk_fma_f32 v[74:75], v[74:75], v[132:133], v[162:163] op_sel_hi:[1,0,1]
    v_pk_fma_f32 v[100:101], v[100:101], v[134:135], v[164:165] op_sel_hi:[1,0,1]
    v_pk_fma_f32 v[102:103], v[102:103], v[134:135], v[166:167] op_sel_hi:[1,0,1]
    v_pk_mul_f32 v[152:153], v[16:17], v[16:17]
    v_pk_mul_f32 v[154:155], v[18:19], v[18:19]
    v_pk_mul_f32 v[156:157], v[44:45], v[44:45]
    v_pk_mul_f32 v[158:159], v[46:47], v[46:47]
    v_pk_mul_f32 v[160:161], v[72:73], v[72:73]
    v_pk_mul_f32 v[162:163], v[74:75], v[74:75]
    v_pk_mul_f32 v[164:165], v[100:101], v[100:101]
    v_pk_mul_f32 v[166:167], v[102:103], v[102:103]
    v_pk_fma_f32 v[152:153], v[152:153], v[250:251], v[250:251] op_sel:[0,1,0] op_sel_hi:[1,1,0]
    v_pk_fma_f32 v[154:155], v[154:155], v[250:251], v[250:251] op_sel:[0,1,0] op_sel_hi:[1,1,0]
    v_pk_fma_f32 v[156:157], v[156:157], v[250:251], v[250:251] op_sel:[0,1,0] op_sel_hi:[1,1,0]
    v_pk_fma_f32 v[158:159], v[158:159], v[250:251], v[250:251] op_sel:[0,1,0] op_sel_hi:[1,1,0]
    v_pk_fma_f32 v[160:161], v[160:161], v[250:251], v[250:251] op_sel:[0,1,0] op_sel_hi:[1,1,0]
    v_pk_fma_f32 v[162:163], v[162:163], v[250:251], v[250:251] op_sel:[0,1,0] op_sel_hi:[1,1,0]
    v_pk_fma_f32 v[164:165], v[164:165], v[250:251], v[250:251] op_sel:[0,1,0] op_sel_hi:[1,1,0]
    v_pk_fma_f32 v[166:167], v[166:167], v[250:251], v[250:251] op_sel:[0,1,0] op_sel_hi:[1,1,0]
    v_pk_mul_f32 v[152:153], v[152:153], v[16:17]
    v_pk_mul_f32 v[154:155], v[154:155], v[18:19]
    v_pk_mul_f32 v[156:157], v[156:157], v[44:45]
    v_pk_mul_f32 v[158:159], v[158:159], v[46:47]
    v_pk_mul_f32 v[160:161], v[160:161], v[72:73]
    v_pk_mul_f32 v[162:163], v[162:163], v[74:75]
    v_pk_mul_f32 v[164:165], v[164:165], v[100:101]
    v_pk_mul_f32 v[166:167], v[166:167], v[102:103]
    v_exp_f32 v152, v152
    v_exp_f32 v153, v153
    v_exp_f32 v154, v154
    v_exp_f32 v155, v155
    v_exp_f32 v156, v156
    v_exp_f32 v157, v157
    v_exp_f32 v158, v158
    v_exp_f32 v159, v159
    v_exp_f32 v160, v160
    v_exp_f32 v161, v161
    v_exp_f32 v162, v162
    v_exp_f32 v163, v163
    v_exp_f32 v164, v164
    v_exp_f32 v165, v165
    v_exp_f32 v166, v166
    v_exp_f32 v167, v167
    v_pk_add_f32 v[152:153], v[152:153], v[248:249]
    v_pk_add_f32 v[154:155], v[154:155], v[248:249]
    v_pk_add_f32 v[156:157], v[156:157], v[248:249]
    v_pk_add_f32 v[158:159], v[158:159], v[248:249]
    v_pk_add_f32 v[160:161], v[160:161], v[248:249]
    v_pk_add_f32 v[162:163], v[162:163], v[248:249]
    v_pk_add_f32 v[164:165], v[164:165], v[248:249]
    v_pk_add_f32 v[166:167], v[166:167], v[248:249]
    v_rcp_f32 v152, v152
    v_rcp_f32 v153, v153
    v_rcp_f32 v154, v154
    v_rcp_f32 v155, v155
    v_rcp_f32 v156, v156
    v_rcp_f32 v157, v157
    v_rcp_f32 v158, v158
    v_rcp_f32 v159, v159
    v_rcp_f32 v160, v160
    v_rcp_f32 v161, v161
    v_rcp_f32 v162, v162
    v_rcp_f32 v163, v163
    v_rcp_f32 v164, v164
    v_rcp_f32 v165, v165
    v_rcp_f32 v166, v166
    v_rcp_f32 v167, v167
    v_pk_mul_f32 v[16:17], v[16:17], v[152:153]
    v_pk_mul_f32 v[18:19], v[18:19], v[154:155]
    v_pk_mul_f32 v[44:45], v[44:45], v[156:157]
    v_pk_mul_f32 v[46:47], v[46:47], v[158:159]
    v_pk_mul_f32 v[72:73], v[72:73], v[160:161]
    v_pk_mul_f32 v[74:75], v[74:75], v[162:163]
    v_pk_mul_f32 v[100:101], v[100:101], v[164:165]
    v_pk_mul_f32 v[102:103], v[102:103], v[166:167]
    v_cvt_pk_bf16_f32 v168, v16, v17
    v_cvt_pk_bf16_f32 v169, v18, v19
    v_cvt_pk_bf16_f32 v172, v44, v45
    v_cvt_pk_bf16_f32 v173, v46, v47
    v_cvt_pk_bf16_f32 v176, v72, v73
    v_cvt_pk_bf16_f32 v177, v74, v75
    v_cvt_pk_bf16_f32 v180, v100, v101
    v_cvt_pk_bf16_f32 v181, v102, v103
    ds_read_b128 v[136:139], v3 offset:128
    ds_read_b128 v[140:143], v3 offset:1152
    s_waitcnt lgkmcnt(2)
    v_pk_fma_f32 v[152:153], v[144:145], v[128:129], v[148:149] op_sel:[0,1,0] op_sel_hi:[1,1,1] neg_lo:[1,0,0] neg_hi:[1,0,0]
    v_pk_fma_f32 v[154:155], v[146:147], v[128:129], v[150:151] op_sel:[0,1,0] op_sel_hi:[1,1,1] neg_lo:[1,0,0] neg_hi:[1,0,0]
    v_pk_fma_f32 v[156:157], v[144:145], v[130:131], v[148:149] op_sel:[0,1,0] op_sel_hi:[1,1,1] neg_lo:[1,0,0] neg_hi:[1,0,0]
    v_pk_fma_f32 v[158:159], v[146:147], v[130:131], v[150:151] op_sel:[0,1,0] op_sel_hi:[1,1,1] neg_lo:[1,0,0] neg_hi:[1,0,0]
    v_pk_fma_f32 v[160:161], v[144:145], v[132:133], v[148:149] op_sel:[0,1,0] op_sel_hi:[1,1,1] neg_lo:[1,0,0] neg_hi:[1,0,0]
    v_pk_fma_f32 v[162:163], v[146:147], v[132:133], v[150:151] op_sel:[0,1,0] op_sel_hi:[1,1,1] neg_lo:[1,0,0] neg_hi:[1,0,0]
    v_pk_fma_f32 v[164:165], v[144:145], v[134:135], v[148:149] op_sel:[0,1,0] op_sel_hi:[1,1,1] neg_lo:[1,0,0] neg_hi:[1,0,0]
    v_pk_fma_f32 v[166:167], v[146:147], v[134:135], v[150:151] op_sel:[0,1,0] op_sel_hi:[1,1,1] neg_lo:[1,0,0] neg_hi:[1,0,0]
    v_pk_fma_f32 v[20:21], v[20:21], v[128:129], v[152:153] op_sel_hi:[1,0,1]
    v_pk_fma_f32 v[22:23], v[22:23], v[128:129], v[154:155] op_sel_hi:[1,0,1]
    v_pk_fma_f32 v[48:49], v[48:49], v[130:131], v[156:157] op_sel_hi:[1,0,1]
    v_pk_fma_f32 v[50:51], v[50:51], v[130:131], v[158:159] op_sel_hi:[1,0,1]
    v_pk_fma_f32 v[76:77], v[76:77], v[132:133], v[160:161] op_sel_hi:[1,0,1]
    v_pk_fma_f32 v[78:79], v[78:79], v[132:133], v[162:163] op_sel_hi:[1,0,1]
    v_pk_fma_f32 v[104:105], v[104:105], v[134:135], v[164:165] op_sel_hi:[1,0,1]
    v_pk_fma_f32 v[106:107], v[106:107], v[134:135], v[166:167] op_sel_hi:[1,0,1]
    v_pk_mul_f32 v[152:153], v[20:21], v[20:21]
    v_pk_mul_f32 v[154:155], v[22:23], v[22:23]
    v_pk_mul_f32 v[156:157], v[48:49], v[48:49]
    v_pk_mul_f32 v[158:159], v[50:51], v[50:51]
    v_pk_mul_f32 v[160:161], v[76:77], v[76:77]
    v_pk_mul_f32 v[162:163], v[78:79], v[78:79]
    v_pk_mul_f32 v[164:165], v[104:105], v[104:105]
    v_pk_mul_f32 v[166:167], v[106:107], v[106:107]
    v_pk_fma_f32 v[152:153], v[152:153], v[250:251], v[250:251] op_sel:[0,1,0] op_sel_hi:[1,1,0]
    v_pk_fma_f32 v[154:155], v[154:155], v[250:251], v[250:251] op_sel:[0,1,0] op_sel_hi:[1,1,0]
    v_pk_fma_f32 v[156:157], v[156:157], v[250:251], v[250:251] op_sel:[0,1,0] op_sel_hi:[1,1,0]
    v_pk_fma_f32 v[158:159], v[158:159], v[250:251], v[250:251] op_sel:[0,1,0] op_sel_hi:[1,1,0]
    v_pk_fma_f32 v[160:161], v[160:161], v[250:251], v[250:251] op_sel:[0,1,0] op_sel_hi:[1,1,0]
    v_pk_fma_f32 v[162:163], v[162:163], v[250:251], v[250:251] op_sel:[0,1,0] op_sel_hi:[1,1,0]
    v_pk_fma_f32 v[164:165], v[164:165], v[250:251], v[250:251] op_sel:[0,1,0] op_sel_hi:[1,1,0]
    v_pk_fma_f32 v[166:167], v[166:167], v[250:251], v[250:251] op_sel:[0,1,0] op_sel_hi:[1,1,0]
    v_pk_mul_f32 v[152:153], v[152:153], v[20:21]
    v_pk_mul_f32 v[154:155], v[154:155], v[22:23]
    v_pk_mul_f32 v[156:157], v[156:157], v[48:49]
    v_pk_mul_f32 v[158:159], v[158:159], v[50:51]
    v_pk_mul_f32 v[160:161], v[160:161], v[76:77]
    v_pk_mul_f32 v[162:163], v[162:163], v[78:79]
    v_pk_mul_f32 v[164:165], v[164:165], v[104:105]
    v_pk_mul_f32 v[166:167], v[166:167], v[106:107]
    v_exp_f32 v152, v152
    v_exp_f32 v153, v153
    v_exp_f32 v154, v154
    v_exp_f32 v155, v155
    v_exp_f32 v156, v156
    v_exp_f32 v157, v157
    v_exp_f32 v158, v158
    v_exp_f32 v159, v159
    v_exp_f32 v160, v160
    v_exp_f32 v161, v161
    v_exp_f32 v162, v162
    v_exp_f32 v163, v163
    v_exp_f32 v164, v164
    v_exp_f32 v165, v165
    v_exp_f32 v166, v166
    v_exp_f32 v167, v167
    v_pk_add_f32 v[152:153], v[152:153], v[248:249]
    v_pk_add_f32 v[154:155], v[154:155], v[248:249]
    v_pk_add_f32 v[156:157], v[156:157], v[248:249]
    v_pk_add_f32 v[158:159], v[158:159], v[248:249]
    v_pk_add_f32 v[160:161], v[160:161], v[248:249]
    v_pk_add_f32 v[162:163], v[162:163], v[248:249]
    v_pk_add_f32 v[164:165], v[164:165], v[248:249]
    v_pk_add_f32 v[166:167], v[166:167], v[248:249]
    v_rcp_f32 v152, v152
    v_rcp_f32 v153, v153
    v_rcp_f32 v154, v154
    v_rcp_f32 v155, v155
    v_rcp_f32 v156, v156
    v_rcp_f32 v157, v157
    v_rcp_f32 v158, v158
    v_rcp_f32 v159, v159
    v_rcp_f32 v160, v160
    v_rcp_f32 v161, v161
    v_rcp_f32 v162, v162
    v_rcp_f32 v163, v163
    v_rcp_f32 v164, v164
    v_rcp_f32 v165, v165
    v_rcp_f32 v166, v166
    v_rcp_f32 v167, v167
    v_pk_mul_f32 v[20:21], v[20:21], v[152:153]
    v_pk_mul_f32 v[22:23], v[22:23], v[154:155]
    v_pk_mul_f32 v[48:49], v[48:49], v[156:157]
    v_pk_mul_f32 v[50:51], v[50:51], v[158:159]
    v_pk_mul_f32 v[76:77], v[76:77], v[160:161]
    v_pk_mul_f32 v[78:79], v[78:79], v[162:163]
    v_pk_mul_f32 v[104:105], v[104:105], v[164:165]
    v_pk_mul_f32 v[106:107], v[106:107], v[166:167]
    v_cvt_pk_bf16_f32 v170, v20, v21
    v_cvt_pk_bf16_f32 v171, v22, v23
    v_cvt_pk_bf16_f32 v174, v48, v49
    v_cvt_pk_bf16_f32 v175, v50, v51
    v_cvt_pk_bf16_f32 v178, v76, v77
    v_cvt_pk_bf16_f32 v179, v78, v79
    v_cvt_pk_bf16_f32 v182, v104, v105
    v_cvt_pk_bf16_f32 v183, v106, v107
    ds_write_b128 v7, v[168:171] offset:0
    ds_write_b128 v7, v[172:175] offset:1024
    ds_write_b128 v7, v[176:179] offset:4096
    ds_write_b128 v7, v[180:183] offset:5120
    buffer_store_dwordx4 v[168:171], v6, s[16:19], s40 offen offset:0 sc1
    buffer_store_dwordx4 v[172:175], v6, s[16:19], s40 offen offset:1024 sc1
    buffer_store_dwordx4 v[176:179], v6, s[16:19], s41 offen offset:0 sc1
    buffer_store_dwordx4 v[180:183], v6, s[16:19], s41 offen offset:1024 sc1
    s_add_u32 s40, s40, 2048
    s_add_u32 s41, s41, 2048
    ds_read_b128 v[144:147], v3 offset:192
    ds_read_b128 v[148:151], v3 offset:1216
    s_waitcnt lgkmcnt(2)
    v_pk_fma_f32 v[152:153], v[136:137], v[128:129], v[140:141] op_sel:[0,1,0] op_sel_hi:[1,1,1] neg_lo:[1,0,0] neg_hi:[1,0,0]
    v_pk_fma_f32 v[154:155], v[138:139], v[128:129], v[142:143] op_sel:[0,1,0] op_sel_hi:[1,1,1] neg_lo:[1,0,0] neg_hi:[1,0,0]
    v_pk_fma_f32 v[156:157], v[136:137], v[130:131], v[140:141] op_sel:[0,1,0] op_sel_hi:[1,1,1] neg_lo:[1,0,0] neg_hi:[1,0,0]
    v_pk_fma_f32 v[158:159], v[138:139], v[130:131], v[142:143] op_sel:[0,1,0] op_sel_hi:[1,1,1] neg_lo:[1,0,0] neg_hi:[1,0,0]
    v_pk_fma_f32 v[160:161], v[136:137], v[132:133], v[140:141] op_sel:[0,1,0] op_sel_hi:[1,1,1] neg_lo:[1,0,0] neg_hi:[1,0,0]
    v_pk_fma_f32 v[162:163], v[138:139], v[132:133], v[142:143] op_sel:[0,1,0] op_sel_hi:[1,1,1] neg_lo:[1,0,0] neg_hi:[1,0,0]
    v_pk_fma_f32 v[164:165], v[136:137], v[134:135], v[140:141] op_sel:[0,1,0] op_sel_hi:[1,1,1] neg_lo:[1,0,0] neg_hi:[1,0,0]
    v_pk_fma_f32 v[166:167], v[138:139], v[134:135], v[142:143] op_sel:[0,1,0] op_sel_hi:[1,1,1] neg_lo:[1,0,0] neg_hi:[1,0,0]
    v_pk_fma_f32 v[24:25], v[24:25], v[128:129], v[152:153] op_sel_hi:[1,0,1]
    v_pk_fma_f32 v[26:27], v[26:27], v[128:129], v[154:155] op_sel_hi:[1,0,1]
    v_pk_fma_f32 v[52:53], v[52:53], v[130:131], v[156:157] op_sel_hi:[1,0,1]
    v_pk_fma_f32 v[54:55], v[54:55], v[130:131], v[158:159] op_sel_hi:[1,0,1]
    v_pk_fma_f32 v[80:81], v[80:81], v[132:133], v[160:161] op_sel_hi:[1,0,1]
    v_pk_fma_f32 v[82:83], v[82:83], v[132:133], v[162:163] op_sel_hi:[1,0,1]
    v_pk_fma_f32 v[108:109], v[108:109], v[134:135], v[164:165] op_sel_hi:[1,0,1]
    v_pk_fma_f32 v[110:111], v[110:111], v[134:135], v[166:167] op_sel_hi:[1,0,1]
    v_pk_mul_f32 v[152:153], v[24:25], v[24:25]
    v_pk_mul_f32 v[154:155], v[26:27], v[26:27]
    v_pk_mul_f32 v[156:157], v[52:53], v[52:53]
    v_pk_mul_f32 v[158:159], v[54:55], v[54:55]
    v_pk_mul_f32 v[160:161], v[80:81], v[80:81]
    v_pk_mul_f32 v[162:163], v[82:83], v[82:83]
    v_pk_mul_f32 v[164:165], v[108:109], v[108:109]
    v_pk_mul_f32 v[166:167], v[110:111], v[110:111]
    v_pk_fma_f32 v[152:153], v[152:153], v[250:251], v[250:251] op_sel:[0,1,0] op_sel_hi:[1,1,0]
    v_pk_fma_f32 v[154:155], v[154:155], v[250:251], v[250:251] op_sel:[0,1,0] op_sel_hi:[1,1,0]
    v_pk_fma_f32 v[156:157], v[156:157], v[250:251], v[250:251] op_sel:[0,1,0] op_sel_hi:[1,1,0]
    v_pk_fma_f32 v[158:159], v[158:159], v[250:251], v[250:251] op_sel:[0,1,0] op_sel_hi:[1,1,0]
    v_pk_fma_f32 v[160:161], v[160:161], v[250:251], v[250:251] op_sel:[0,1,0] op_sel_hi:[1,1,0]
    v_pk_fma_f32 v[162:163], v[162:163], v[250:251], v[250:251] op_sel:[0,1,0] op_sel_hi:[1,1,0]
    v_pk_fma_f32 v[164:165], v[164:165], v[250:251], v[250:251] op_sel:[0,1,0] op_sel_hi:[1,1,0]
    v_pk_fma_f32 v[166:167], v[166:167], v[250:251], v[250:251] op_sel:[0,1,0] op_sel_hi:[1,1,0]
    v_pk_mul_f32 v[152:153], v[152:153], v[24:25]
    v_pk_mul_f32 v[154:155], v[154:155], v[26:27]
    v_pk_mul_f32 v[156:157], v[156:157], v[52:53]
    v_pk_mul_f32 v[158:159], v[158:159], v[54:55]
    v_pk_mul_f32 v[160:161], v[160:161], v[80:81]
    v_pk_mul_f32 v[162:163], v[162:163], v[82:83]
    v_pk_mul_f32 v[164:165], v[164:165], v[108:109]
    v_pk_mul_f32 v[166:167], v[166:167], v[110:111]
    v_exp_f32 v152, v152
    v_exp_f32 v153, v153
    v_exp_f32 v154, v154
    v_exp_f32 v155, v155
    v_exp_f32 v156, v156
    v_exp_f32 v157, v157
    v_exp_f32 v158, v158
    v_exp_f32 v159, v159
    v_exp_f32 v160, v160
    v_exp_f32 v161, v161
    v_exp_f32 v162, v162
    v_exp_f32 v163, v163
    v_exp_f32 v164, v164
    v_exp_f32 v165, v165
    v_exp_f32 v166, v166
    v_exp_f32 v167, v167
    v_pk_add_f32 v[152:153], v[152:153], v[248:249]
    v_pk_add_f32 v[154:155], v[154:155], v[248:249]
    v_pk_add_f32 v[156:157], v[156:157], v[248:249]
    v_pk_add_f32 v[158:159], v[158:159], v[248:249]
    v_pk_add_f32 v[160:161], v[160:161], v[248:249]
    v_pk_add_f32 v[162:163], v[162:163], v[248:249]
    v_pk_add_f32 v[164:165], v[164:165], v[248:249]
    v_pk_add_f32 v[166:167], v[166:167], v[248:249]
    v_rcp_f32 v152, v152
    v_rcp_f32 v153, v153
    v_rcp_f32 v154, v154
    v_rcp_f32 v155, v155
    v_rcp_f32 v156, v156
    v_rcp_f32 v157, v157
    v_rcp_f32 v158, v158
    v_rcp_f32 v159, v159
    v_rcp_f32 v160, v160
    v_rcp_f32 v161, v161
    v_rcp_f32 v162, v162
    v_rcp_f32 v163, v163
    v_rcp_f32 v164, v164
    v_rcp_f32 v165, v165
    v_rcp_f32 v166, v166
    v_rcp_f32 v167, v167
    v_pk_mul_f32 v[24:25], v[24:25], v[152:153]
    v_pk_mul_f32 v[26:27], v[26:27], v[154:155]
    v_pk_mul_f32 v[52:53], v[52:53], v[156:157]
    v_pk_mul_f32 v[54:55], v[54:55], v[158:159]
    v_pk_mul_f32 v[80:81], v[80:81], v[160:161]
    v_pk_mul_f32 v[82:83], v[82:83], v[162:163]
    v_pk_mul_f32 v[108:109], v[108:109], v[164:165]
    v_pk_mul_f32 v[110:111], v[110:111], v[166:167]
    v_cvt_pk_bf16_f32 v168, v24, v25
    v_cvt_pk_bf16_f32 v169, v26, v27
    v_cvt_pk_bf16_f32 v172, v52, v53
    v_cvt_pk_bf16_f32 v173, v54, v55
    v_cvt_pk_bf16_f32 v176, v80, v81
    v_cvt_pk_bf16_f32 v177, v82, v83
    v_cvt_pk_bf16_f32 v180, v108, v109
    v_cvt_pk_bf16_f32 v181, v110, v111
    ds_read_b128 v[136:139], v3 offset:256
    ds_read_b128 v[140:143], v3 offset:1280
    s_waitcnt lgkmcnt(2)
    v_pk_fma_f32 v[152:153], v[144:145], v[128:129], v[148:149] op_sel:[0,1,0] op_sel_hi:[1,1,1] neg_lo:[1,0,0] neg_hi:[1,0,0]
    v_pk_fma_f32 v[154:155], v[146:147], v[128:129], v[150:151] op_sel:[0,1,0] op_sel_hi:[1,1,1] neg_lo:[1,0,0] neg_hi:[1,0,0]
    v_pk_fma_f32 v[156:157], v[144:145], v[130:131], v[148:149] op_sel:[0,1,0] op_sel_hi:[1,1,1] neg_lo:[1,0,0] neg_hi:[1,0,0]
    v_pk_fma_f32 v[158:159], v[146:147], v[130:131], v[150:151] op_sel:[0,1,0] op_sel_hi:[1,1,1] neg_lo:[1,0,0] neg_hi:[1,0,0]
    v_pk_fma_f32 v[160:161], v[144:145], v[132:133], v[148:149] op_sel:[0,1,0] op_sel_hi:[1,1,1] neg_lo:[1,0,0] neg_hi:[1,0,0]
    v_pk_fma_f32 v[162:163], v[146:147], v[132:133], v[150:151] op_sel:[0,1,0] op_sel_hi:[1,1,1] neg_lo:[1,0,0] neg_hi:[1,0,0]
    v_pk_fma_f32 v[164:165], v[144:145], v[134:135], v[148:149] op_sel:[0,1,0] op_sel_hi:[1,1,1] neg_lo:[1,0,0] neg_hi:[1,0,0]
    v_pk_fma_f32 v[166:167], v[146:147], v[134:135], v[150:151] op_sel:[0,1,0] op_sel_hi:[1,1,1] neg_lo:[1,0,0] neg_hi:[1,0,0]
    v_pk_fma_f32 v[28:29], v[28:29], v[128:129], v[152:153] op_sel_hi:[1,0,1]
    v_pk_fma_f32 v[30:31], v[30:31], v[128:129], v[154:155] op_sel_hi:[1,0,1]
    v_pk_fma_f32 v[56:57], v[56:57], v[130:131], v[156:157] op_sel_hi:[1,0,1]
    v_pk_fma_f32 v[58:59], v[58:59], v[130:131], v[158:159] op_sel_hi:[1,0,1]
    v_pk_fma_f32 v[84:85], v[84:85], v[132:133], v[160:161] op_sel_hi:[1,0,1]
    v_pk_fma_f32 v[86:87], v[86:87], v[132:133], v[162:163] op_sel_hi:[1,0,1]
    v_pk_fma_f32 v[112:113], v[112:113], v[134:135], v[164:165] op_sel_hi:[1,0,1]
    v_pk_fma_f32 v[114:115], v[114:115], v[134:135], v[166:167] op_sel_hi:[1,0,1]
    v_pk_mul_f32 v[152:153], v[28:29], v[28:29]
    v_pk_mul_f32 v[154:155], v[30:31], v[30:31]
    v_pk_mul_f32 v[156:157], v[56:57], v[56:57]
    v_pk_mul_f32 v[158:159], v[58:59], v[58:59]
    v_pk_mul_f32 v[160:161], v[84:85], v[84:85]
    v_pk_mul_f32 v[162:163], v[86:87], v[86:87]
    v_pk_mul_f32 v[164:165], v[112:113], v[112:113]
    v_pk_mul_f32 v[166:167], v[114:115], v[114:115]
    v_pk_fma_f32 v[152:153], v[152:153], v[250:251], v[250:251] op_sel:[0,1,0] op_sel_hi:[1,1,0]
    v_pk_fma_f32 v[154:155], v[154:155], v[250:251], v[250:251] op_sel:[0,1,0] op_sel_hi:[1,1,0]
    v_pk_fma_f32 v[156:157], v[156:157], v[250:251], v[250:251] op_sel:[0,1,0] op_sel_hi:[1,1,0]
    v_pk_fma_f32 v[158:159], v[158:159], v[250:251], v[250:251] op_sel:[0,1,0] op_sel_hi:[1,1,0]
    v_pk_fma_f32 v[160:161], v[160:161], v[250:251], v[250:251] op_sel:[0,1,0] op_sel_hi:[1,1,0]
    v_pk_fma_f32 v[162:163], v[162:163], v[250:251], v[250:251] op_sel:[0,1,0] op_sel_hi:[1,1,0]
    v_pk_fma_f32 v[164:165], v[164:165], v[250:251], v[250:251] op_sel:[0,1,0] op_sel_hi:[1,1,0]
    v_pk_fma_f32 v[166:167], v[166:167], v[250:251], v[250:251] op_sel:[0,1,0] op_sel_hi:[1,1,0]
    v_pk_mul_f32 v[152:153], v[152:153], v[28:29]
    v_pk_mul_f32 v[154:155], v[154:155], v[30:31]
    v_pk_mul_f32 v[156:157], v[156:157], v[56:57]
    v_pk_mul_f32 v[158:159], v[158:159], v[58:59]
    v_pk_mul_f32 v[160:161], v[160:161], v[84:85]
    v_pk_mul_f32 v[162:163], v[162:163], v[86:87]
    v_pk_mul_f32 v[164:165], v[164:165], v[112:113]
    v_pk_mul_f32 v[166:167], v[166:167], v[114:115]
    v_exp_f32 v152, v152
    v_exp_f32 v153, v153
    v_exp_f32 v154, v154
    v_exp_f32 v155, v155
    v_exp_f32 v156, v156
    v_exp_f32 v157, v157
    v_exp_f32 v158, v158
    v_exp_f32 v159, v159
    v_exp_f32 v160, v160
    v_exp_f32 v161, v161
    v_exp_f32 v162, v162
    v_exp_f32 v163, v163
    v_exp_f32 v164, v164
    v_exp_f32 v165, v165
    v_exp_f32 v166, v166
    v_exp_f32 v167, v167
    v_pk_add_f32 v[152:153], v[152:153], v[248:249]
    v_pk_add_f32 v[154:155], v[154:155], v[248:249]
    v_pk_add_f32 v[156:157], v[156:157], v[248:249]
    v_pk_add_f32 v[158:159], v[158:159], v[248:249]
    v_pk_add_f32 v[160:161], v[160:161], v[248:249]
    v_pk_add_f32 v[162:163], v[162:163], v[248:249]
    v_pk_add_f32 v[164:165], v[164:165], v[248:249]
    v_pk_add_f32 v[166:167], v[166:167], v[248:249]
    v_rcp_f32 v152, v152
    v_rcp_f32 v153, v153
    v_rcp_f32 v154, v154
    v_rcp_f32 v155, v155
    v_rcp_f32 v156, v156
    v_rcp_f32 v157, v157
    v_rcp_f32 v158, v158
    v_rcp_f32 v159, v159
    v_rcp_f32 v160, v160
    v_rcp_f32 v161, v161
    v_rcp_f32 v162, v162
    v_rcp_f32 v163, v163
    v_rcp_f32 v164, v164
    v_rcp_f32 v165, v165
    v_rcp_f32 v166, v166
    v_rcp_f32 v167, v167
    v_pk_mul_f32 v[28:29], v[28:29], v[152:153]
    v_pk_mul_f32 v[30:31], v[30:31], v[154:155]
    v_pk_mul_f32 v[56:57], v[56:57], v[156:157]
    v_pk_mul_f32 v[58:59], v[58:59], v[158:159]
    v_pk_mul_f32 v[84:85], v[84:85], v[160:161]
    v_pk_mul_f32 v[86:87], v[86:87], v[162:163]
    v_pk_mul_f32 v[112:113], v[112:113], v[164:165]
    v_pk_mul_f32 v[114:115], v[114:115], v[166:167]
    v_cvt_pk_bf16_f32 v170, v28, v29
    v_cvt_pk_bf16_f32 v171, v30, v31
    v_cvt_pk_bf16_f32 v174, v56, v57
    v_cvt_pk_bf16_f32 v175, v58, v59
    v_cvt_pk_bf16_f32 v178, v84, v85
    v_cvt_pk_bf16_f32 v179, v86, v87
    v_cvt_pk_bf16_f32 v182, v112, v113
    v_cvt_pk_bf16_f32 v183, v114, v115
    ds_write_b128 v7, v[168:171] offset:2048
    ds_write_b128 v7, v[172:175] offset:3072
    ds_write_b128 v7, v[176:179] offset:6144
    ds_write_b128 v7, v[180:183] offset:7168
    buffer_store_dwordx4 v[168:171], v6, s[16:19], s40 offen offset:0 sc1
    buffer_store_dwordx4 v[172:175], v6, s[16:19], s40 offen offset:1024 sc1
    buffer_store_dwordx4 v[176:179], v6, s[16:19], s41 offen offset:0 sc1
    buffer_store_dwordx4 v[180:183], v6, s[16:19], s41 offen offset:1024 sc1
    s_add_u32 s40, s40, 2048
    s_add_u32 s41, s41, 2048
    ds_read_b128 v[144:147], v3 offset:320
    ds_read_b128 v[148:151], v3 offset:1344
    s_waitcnt lgkmcnt(2)
    v_pk_fma_f32 v[152:153], v[136:137], v[128:129], v[140:141] op_sel:[0,1,0] op_sel_hi:[1,1,1] neg_lo:[1,0,0] neg_hi:[1,0,0]
    v_pk_fma_f32 v[154:155], v[138:139], v[128:129], v[142:143] op_sel:[0,1,0] op_sel_hi:[1,1,1] neg_lo:[1,0,0] neg_hi:[1,0,0]
    v_pk_fma_f32 v[156:157], v[136:137], v[130:131], v[140:141] op_sel:[0,1,0] op_sel_hi:[1,1,1] neg_lo:[1,0,0] neg_hi:[1,0,0]
    v_pk_fma_f32 v[158:159], v[138:139], v[130:131], v[142:143] op_sel:[0,1,0] op_sel_hi:[1,1,1] neg_lo:[1,0,0] neg_hi:[1,0,0]
    v_pk_fma_f32 v[160:161], v[136:137], v[132:133], v[140:141] op_sel:[0,1,0] op_sel_hi:[1,1,1] neg_lo:[1,0,0] neg_hi:[1,0,0]
    v_pk_fma_f32 v[162:163], v[138:139], v[132:133], v[142:143] op_sel:[0,1,0] op_sel_hi:[1,1,1] neg_lo:[1,0,0] neg_hi:[1,0,0]
    v_pk_fma_f32 v[164:165], v[136:137], v[134:135], v[140:141] op_sel:[0,1,0] op_sel_hi:[1,1,1] neg_lo:[1,0,0] neg_hi:[1,0,0]
    v_pk_fma_f32 v[166:167], v[138:139], v[134:135], v[142:143] op_sel:[0,1,0] op_sel_hi:[1,1,1] neg_lo:[1,0,0] neg_hi:[1,0,0]
    v_pk_fma_f32 v[32:33], v[32:33], v[128:129], v[152:153] op_sel_hi:[1,0,1]
    v_pk_fma_f32 v[34:35], v[34:35], v[128:129], v[154:155] op_sel_hi:[1,0,1]
    v_pk_fma_f32 v[60:61], v[60:61], v[130:131], v[156:157] op_sel_hi:[1,0,1]
    v_pk_fma_f32 v[62:63], v[62:63], v[130:131], v[158:159] op_sel_hi:[1,0,1]
    v_pk_fma_f32 v[88:89], v[88:89], v[132:133], v[160:161] op_sel_hi:[1,0,1]
    v_pk_fma_f32 v[90:91], v[90:91], v[132:133], v[162:163] op_sel_hi:[1,0,1]
    v_pk_fma_f32 v[116:117], v[116:117], v[134:135], v[164:165] op_sel_hi:[1,0,1]
    v_pk_fma_f32 v[118:119], v[118:119], v[134:135], v[166:167] op_sel_hi:[1,0,1]
    v_pk_mul_f32 v[152:153], v[32:33], v[32:33]
    v_pk_mul_f32 v[154:155], v[34:35], v[34:35]
    v_pk_mul_f32 v[156:157], v[60:61], v[60:61]
    v_pk_mul_f32 v[158:159], v[62:63], v[62:63]
    v_pk_mul_f32 v[160:161], v[88:89], v[88:89]
    v_pk_mul_f32 v[162:163], v[90:91], v[90:91]
    v_pk_mul_f32 v[164:165], v[116:117], v[116:117]
    v_pk_mul_f32 v[166:167], v[118:119], v[118:119]
    v_pk_fma_f32 v[152:153], v[152:153], v[250:251], v[250:251] op_sel:[0,1,0] op_sel_hi:[1,1,0]
    v_pk_fma_f32 v[154:155], v[154:155], v[250:251], v[250:251] op_sel:[0,1,0] op_sel_hi:[1,1,0]
    v_pk_fma_f32 v[156:157], v[156:157], v[250:251], v[250:251] op_sel:[0,1,0] op_sel_hi:[1,1,0]
    v_pk_fma_f32 v[158:159], v[158:159], v[250:251], v[250:251] op_sel:[0,1,0] op_sel_hi:[1,1,0]
    v_pk_fma_f32 v[160:161], v[160:161], v[250:251], v[250:251] op_sel:[0,1,0] op_sel_hi:[1,1,0]
    v_pk_fma_f32 v[162:163], v[162:163], v[250:251], v[250:251] op_sel:[0,1,0] op_sel_hi:[1,1,0]
    v_pk_fma_f32 v[164:165], v[164:165], v[250:251], v[250:251] op_sel:[0,1,0] op_sel_hi:[1,1,0]
    v_pk_fma_f32 v[166:167], v[166:167], v[250:251], v[250:251] op_sel:[0,1,0] op_sel_hi:[1,1,0]
    v_pk_mul_f32 v[152:153], v[152:153], v[32:33]
    v_pk_mul_f32 v[154:155], v[154:155], v[34:35]
    v_pk_mul_f32 v[156:157], v[156:157], v[60:61]
    v_pk_mul_f32 v[158:159], v[158:159], v[62:63]
    v_pk_mul_f32 v[160:161], v[160:161], v[88:89]
    v_pk_mul_f32 v[162:163], v[162:163], v[90:91]
    v_pk_mul_f32 v[164:165], v[164:165], v[116:117]
    v_pk_mul_f32 v[166:167], v[166:167], v[118:119]
    v_exp_f32 v152, v152
    v_exp_f32 v153, v153
    v_exp_f32 v154, v154
    v_exp_f32 v155, v155
    v_exp_f32 v156, v156
    v_exp_f32 v157, v157
    v_exp_f32 v158, v158
    v_exp_f32 v159, v159
    v_exp_f32 v160, v160
    v_exp_f32 v161, v161
    v_exp_f32 v162, v162
    v_exp_f32 v163, v163
    v_exp_f32 v164, v164
    v_exp_f32 v165, v165
    v_exp_f32 v166, v166
    v_exp_f32 v167, v167
    v_pk_add_f32 v[152:153], v[152:153], v[248:249]
    v_pk_add_f32 v[154:155], v[154:155], v[248:249]
    v_pk_add_f32 v[156:157], v[156:157], v[248:249]
    v_pk_add_f32 v[158:159], v[158:159], v[248:249]
    v_pk_add_f32 v[160:161], v[160:161], v[248:249]
    v_pk_add_f32 v[162:163], v[162:163], v[248:249]
    v_pk_add_f32 v[164:165], v[164:165], v[248:249]
    v_pk_add_f32 v[166:167], v[166:167], v[248:249]
    v_rcp_f32 v152, v152
    v_rcp_f32 v153, v153
    v_rcp_f32 v154, v154
    v_rcp_f32 v155, v155
    v_rcp_f32 v156, v156
    v_rcp_f32 v157, v157
    v_rcp_f32 v158, v158
    v_rcp_f32 v159, v159
    v_rcp_f32 v160, v160
    v_rcp_f32 v161, v161
    v_rcp_f32 v162, v162
    v_rcp_f32 v163, v163
    v_rcp_f32 v164, v164
    v_rcp_f32 v165, v165
    v_rcp_f32 v166, v166
    v_rcp_f32 v167, v167
    v_pk_mul_f32 v[32:33], v[32:33], v[152:153]
    v_pk_mul_f32 v[34:35], v[34:35], v[154:155]
    v_pk_mul_f32 v[60:61], v[60:61], v[156:157]
    v_pk_mul_f32 v[62:63], v[62:63], v[158:159]
    v_pk_mul_f32 v[88:89], v[88:89], v[160:161]
    v_pk_mul_f32 v[90:91], v[90:91], v[162:163]
    v_pk_mul_f32 v[116:117], v[116:117], v[164:165]
    v_pk_mul_f32 v[118:119], v[118:119], v[166:167]
    v_cvt_pk_bf16_f32 v168, v32, v33
    v_cvt_pk_bf16_f32 v169, v34, v35
    v_cvt_pk_bf16_f32 v172, v60, v61
    v_cvt_pk_bf16_f32 v173, v62, v63
    v_cvt_pk_bf16_f32 v176, v88, v89
    v_cvt_pk_bf16_f32 v177, v90, v91
    v_cvt_pk_bf16_f32 v180, v116, v117
    v_cvt_pk_bf16_f32 v181, v118, v119
    ds_read_b128 v[136:139], v3 offset:384
    ds_read_b128 v[140:143], v3 offset:1408
    s_waitcnt lgkmcnt(2)
    v_pk_fma_f32 v[152:153], v[144:145], v[128:129], v[148:149] op_sel:[0,1,0] op_sel_hi:[1,1,1] neg_lo:[1,0,0] neg_hi:[1,0,0]
    v_pk_fma_f32 v[154:155], v[146:147], v[128:129], v[150:151] op_sel:[0,1,0] op_sel_hi:[1,1,1] neg_lo:[1,0,0] neg_hi:[1,0,0]
    v_pk_fma_f32 v[156:157], v[144:145], v[130:131], v[148:149] op_sel:[0,1,0] op_sel_hi:[1,1,1] neg_lo:[1,0,0] neg_hi:[1,0,0]
    v_pk_fma_f32 v[158:159], v[146:147], v[130:131], v[150:151] op_sel:[0,1,0] op_sel_hi:[1,1,1] neg_lo:[1,0,0] neg_hi:[1,0,0]
    v_pk_fma_f32 v[160:161], v[144:145], v[132:133], v[148:149] op_sel:[0,1,0] op_sel_hi:[1,1,1] neg_lo:[1,0,0] neg_hi:[1,0,0]
    v_pk_fma_f32 v[162:163], v[146:147], v[132:133], v[150:151] op_sel:[0,1,0] op_sel_hi:[1,1,1] neg_lo:[1,0,0] neg_hi:[1,0,0]
    v_pk_fma_f32 v[164:165], v[144:145], v[134:135], v[148:149] op_sel:[0,1,0] op_sel_hi:[1,1,1] neg_lo:[1,0,0] neg_hi:[1,0,0]
    v_pk_fma_f32 v[166:167], v[146:147], v[134:135], v[150:151] op_sel:[0,1,0] op_sel_hi:[1,1,1] neg_lo:[1,0,0] neg_hi:[1,0,0]
    v_pk_fma_f32 v[36:37], v[36:37], v[128:129], v[152:153] op_sel_hi:[1,0,1]
    v_pk_fma_f32 v[38:39], v[38:39], v[128:129], v[154:155] op_sel_hi:[1,0,1]
    v_pk_fma_f32 v[64:65], v[64:65], v[130:131], v[156:157] op_sel_hi:[1,0,1]
    v_pk_fma_f32 v[66:67], v[66:67], v[130:131], v[158:159] op_sel_hi:[1,0,1]
    v_pk_fma_f32 v[92:93], v[92:93], v[132:133], v[160:161] op_sel_hi:[1,0,1]
    v_pk_fma_f32 v[94:95], v[94:95], v[132:133], v[162:163] op_sel_hi:[1,0,1]
    v_pk_fma_f32 v[120:121], v[120:121], v[134:135], v[164:165] op_sel_hi:[1,0,1]
    v_pk_fma_f32 v[122:123], v[122:123], v[134:135], v[166:167] op_sel_hi:[1,0,1]
    v_pk_mul_f32 v[152:153], v[36:37], v[36:37]
    v_pk_mul_f32 v[154:155], v[38:39], v[38:39]
    v_pk_mul_f32 v[156:157], v[64:65], v[64:65]
    v_pk_mul_f32 v[158:159], v[66:67], v[66:67]
    v_pk_mul_f32 v[160:161], v[92:93], v[92:93]
    v_pk_mul_f32 v[162:163], v[94:95], v[94:95]
    v_pk_mul_f32 v[164:165], v[120:121], v[120:121]
    v_pk_mul_f32 v[166:167], v[122:123], v[122:123]
    v_pk_fma_f32 v[152:153], v[152:153], v[250:251], v[250:251] op_sel:[0,1,0] op_sel_hi:[1,1,0]
    v_pk_fma_f32 v[154:155], v[154:155], v[250:251], v[250:251] op_sel:[0,1,0] op_sel_hi:[1,1,0]
    v_pk_fma_f32 v[156:157], v[156:157], v[250:251], v[250:251] op_sel:[0,1,0] op_sel_hi:[1,1,0]
    v_pk_fma_f32 v[158:159], v[158:159], v[250:251], v[250:251] op_sel:[0,1,0] op_sel_hi:[1,1,0]
    v_pk_fma_f32 v[160:161], v[160:161], v[250:251], v[250:251] op_sel:[0,1,0] op_sel_hi:[1,1,0]
    v_pk_fma_f32 v[162:163], v[162:163], v[250:251], v[250:251] op_sel:[0,1,0] op_sel_hi:[1,1,0]
    v_pk_fma_f32 v[164:165], v[164:165], v[250:251], v[250:251] op_sel:[0,1,0] op_sel_hi:[1,1,0]
    v_pk_fma_f32 v[166:167], v[166:167], v[250:251], v[250:251] op_sel:[0,1,0] op_sel_hi:[1,1,0]
    v_pk_mul_f32 v[152:153], v[152:153], v[36:37]
    v_pk_mul_f32 v[154:155], v[154:155], v[38:39]
    v_pk_mul_f32 v[156:157], v[156:157], v[64:65]
    v_pk_mul_f32 v[158:159], v[158:159], v[66:67]
    v_pk_mul_f32 v[160:161], v[160:161], v[92:93]
    v_pk_mul_f32 v[162:163], v[162:163], v[94:95]
    v_pk_mul_f32 v[164:165], v[164:165], v[120:121]
    v_pk_mul_f32 v[166:167], v[166:167], v[122:123]
    v_exp_f32 v152, v152
    v_exp_f32 v153, v153
    v_exp_f32 v154, v154
    v_exp_f32 v155, v155
    v_exp_f32 v156, v156
    v_exp_f32 v157, v157
    v_exp_f32 v158, v158
    v_exp_f32 v159, v159
    v_exp_f32 v160, v160
    v_exp_f32 v161, v161
    v_exp_f32 v162, v162
    v_exp_f32 v163, v163
    v_exp_f32 v164, v164
    v_exp_f32 v165, v165
    v_exp_f32 v166, v166
    v_exp_f32 v167, v167
    v_pk_add_f32 v[152:153], v[152:153], v[248:249]
    v_pk_add_f32 v[154:155], v[154:155], v[248:249]
    v_pk_add_f32 v[156:157], v[156:157], v[248:249]
    v_pk_add_f32 v[158:159], v[158:159], v[248:249]
    v_pk_add_f32 v[160:161], v[160:161], v[248:249]
    v_pk_add_f32 v[162:163], v[162:163], v[248:249]
    v_pk_add_f32 v[164:165], v[164:165], v[248:249]
    v_pk_add_f32 v[166:167], v[166:167], v[248:249]
    v_rcp_f32 v152, v152
    v_rcp_f32 v153, v153
    v_rcp_f32 v154, v154
    v_rcp_f32 v155, v155
    v_rcp_f32 v156, v156
    v_rcp_f32 v157, v157
    v_rcp_f32 v158, v158
    v_rcp_f32 v159, v159
    v_rcp_f32 v160, v160
    v_rcp_f32 v161, v161
    v_rcp_f32 v162, v162
    v_rcp_f32 v163, v163
    v_rcp_f32 v164, v164
    v_rcp_f32 v165, v165
    v_rcp_f32 v166, v166
    v_rcp_f32 v167, v167
    v_pk_mul_f32 v[36:37], v[36:37], v[152:153]
    v_pk_mul_f32 v[38:39], v[38:39], v[154:155]
    v_pk_mul_f32 v[64:65], v[64:65], v[156:157]
    v_pk_mul_f32 v[66:67], v[66:67], v[158:159]
    v_pk_mul_f32 v[92:93], v[92:93], v[160:161]
    v_pk_mul_f32 v[94:95], v[94:95], v[162:163]
    v_pk_mul_f32 v[120:121], v[120:121], v[164:165]
    v_pk_mul_f32 v[122:123], v[122:123], v[166:167]
    v_cvt_pk_bf16_f32 v170, v36, v37
    v_cvt_pk_bf16_f32 v171, v38, v39
    v_cvt_pk_bf16_f32 v174, v64, v65
    v_cvt_pk_bf16_f32 v175, v66, v67
    v_cvt_pk_bf16_f32 v178, v92, v93
    v_cvt_pk_bf16_f32 v179, v94, v95
    v_cvt_pk_bf16_f32 v182, v120, v121
    v_cvt_pk_bf16_f32 v183, v122, v123
    ds_write_b128 v8, v[168:171] offset:0
    ds_write_b128 v8, v[172:175] offset:1024
    ds_write_b128 v8, v[176:179] offset:4096
    ds_write_b128 v8, v[180:183] offset:5120
    s_waitcnt lgkmcnt(0)
    v_pk_fma_f32 v[152:153], v[136:137], v[128:129], v[140:141] op_sel:[0,1,0] op_sel_hi:[1,1,1] neg_lo:[1,0,0] neg_hi:[1,0,0]
    v_pk_fma_f32 v[154:155], v[138:139], v[128:129], v[142:143] op_sel:[0,1,0] op_sel_hi:[1,1,1] neg_lo:[1,0,0] neg_hi:[1,0,0]
    v_pk_fma_f32 v[156:157], v[136:137], v[130:131], v[140:141] op_sel:[0,1,0] op_sel_hi:[1,1,1] neg_lo:[1,0,0] neg_hi:[1,0,0]
    v_pk_fma_f32 v[158:159], v[138:139], v[130:131], v[142:143] op_sel:[0,1,0] op_sel_hi:[1,1,1] neg_lo:[1,0,0] neg_hi:[1,0,0]
    v_pk_fma_f32 v[160:161], v[136:137], v[132:133], v[140:141] op_sel:[0,1,0] op_sel_hi:[1,1,1] neg_lo:[1,0,0] neg_hi:[1,0,0]
    v_pk_fma_f32 v[162:163], v[138:139], v[132:133], v[142:143] op_sel:[0,1,0] op_sel_hi:[1,1,1] neg_lo:[1,0,0] neg_hi:[1,0,0]
    v_pk_fma_f32 v[164:165], v[136:137], v[134:135], v[140:141] op_sel:[0,1,0] op_sel_hi:[1,1,1] neg_lo:[1,0,0] neg_hi:[1,0,0]
    v_pk_fma_f32 v[166:167], v[138:139], v[134:135], v[142:143] op_sel:[0,1,0] op_sel_hi:[1,1,1] neg_lo:[1,0,0] neg_hi:[1,0,0]
    v_pk_fma_f32 v[40:41], v[40:41], v[128:129], v[152:153] op_sel_hi:[1,0,1]
    v_pk_fma_f32 v[42:43], v[42:43], v[128:129], v[154:155] op_sel_hi:[1,0,1]
    v_pk_fma_f32 v[68:69], v[68:69], v[130:131], v[156:157] op_sel_hi:[1,0,1]
    v_pk_fma_f32 v[70:71], v[70:71], v[130:131], v[158:159] op_sel_hi:[1,0,1]
    v_pk_fma_f32 v[96:97], v[96:97], v[132:133], v[160:161] op_sel_hi:[1,0,1]
    v_pk_fma_f32 v[98:99], v[98:99], v[132:133], v[162:163] op_sel_hi:[1,0,1]
    v_pk_fma_f32 v[124:125], v[124:125], v[134:135], v[164:165] op_sel_hi:[1,0,1]
    v_pk_fma_f32 v[126:127], v[126:127], v[134:135], v[166:167] op_sel_hi:[1,0,1]
    v_pk_mul_f32 v[152:153], v[40:41], v[40:41]
    v_pk_mul_f32 v[154:155], v[42:43], v[42:43]
    v_pk_mul_f32 v[156:157], v[68:69], v[68:69]
    v_pk_mul_f32 v[158:159], v[70:71], v[70:71]
    v_pk_mul_f32 v[160:161], v[96:97], v[96:97]
    v_pk_mul_f32 v[162:163], v[98:99], v[98:99]
    v_pk_mul_f32 v[164:165], v[124:125], v[124:125]
    v_pk_mul_f32 v[166:167], v[126:127], v[126:127]
    v_pk_fma_f32 v[152:153], v[152:153], v[250:251], v[250:251] op_sel:[0,1,0] op_sel_hi:[1,1,0]
    v_pk_fma_f32 v[154:155], v[154:155], v[250:251], v[250:251] op_sel:[0,1,0] op_sel_hi:[1,1,0]
    v_pk_fma_f32 v[156:157], v[156:157], v[250:251], v[250:251] op_sel:[0,1,0] op_sel_hi:[1,1,0]
    v_pk_fma_f32 v[158:159], v[158:159], v[250:251], v[250:251] op_sel:[0,1,0] op_sel_hi:[1,1,0]
    v_pk_fma_f32 v[160:161], v[160:161], v[250:251], v[250:251] op_sel:[0,1,0] op_sel_hi:[1,1,0]
    v_pk_fma_f32 v[162:163], v[162:163], v[250:251], v[250:251] op_sel:[0,1,0] op_sel_hi:[1,1,0]
    v_pk_fma_f32 v[164:165], v[164:165], v[250:251], v[250:251] op_sel:[0,1,0] op_sel_hi:[1,1,0]
    v_pk_fma_f32 v[166:167], v[166:167], v[250:251], v[250:251] op_sel:[0,1,0] op_sel_hi:[1,1,0]
    v_pk_mul_f32 v[152:153], v[152:153], v[40:41]
    v_pk_mul_f32 v[154:155], v[154:155], v[42:43]
    v_pk_mul_f32 v[156:157], v[156:157], v[68:69]
    v_pk_mul_f32 v[158:159], v[158:159], v[70:71]
    v_pk_mul_f32 v[160:161], v[160:161], v[96:97]
    v_pk_mul_f32 v[162:163], v[162:163], v[98:99]
    v_pk_mul_f32 v[164:165], v[164:165], v[124:125]
    v_pk_mul_f32 v[166:167], v[166:167], v[126:127]
    v_exp_f32 v152, v152
    v_exp_f32 v153, v153
    v_exp_f32 v154, v154
    v_exp_f32 v155, v155
    v_exp_f32 v156, v156
    v_exp_f32 v157, v157
    v_exp_f32 v158, v158
    v_exp_f32 v159, v159
    v_exp_f32 v160, v160
    v_exp_f32 v161, v161
    v_exp_f32 v162, v162
    v_exp_f32 v163, v163
    v_exp_f32 v164, v164
    v_exp_f32 v165, v165
    v_exp_f32 v166, v166
    v_exp_f32 v167, v167
    v_pk_add_f32 v[152:153], v[152:153], v[248:249]
    v_pk_add_f32 v[154:155], v[154:155], v[248:249]
    v_pk_add_f32 v[156:157], v[156:157], v[248:249]
    v_pk_add_f32 v[158:159], v[158:159], v[248:249]
    v_pk_add_f32 v[160:161], v[160:161], v[248:249]
    v_pk_add_f32 v[162:163], v[162:163], v[248:249]
    v_pk_add_f32 v[164:165], v[164:165], v[248:249]
    v_pk_add_f32 v[166:167], v[166:167], v[248:249]
    v_rcp_f32 v152, v152
    v_rcp_f32 v153, v153
    v_rcp_f32 v154, v154
    v_rcp_f32 v155, v155
    v_rcp_f32 v156, v156
    v_rcp_f32 v157, v157
    v_rcp_f32 v158, v158
    v_rcp_f32 v159, v159
    v_rcp_f32 v160, v160
    v_rcp_f32 v161, v161
    v_rcp_f32 v162, v162
    v_rcp_f32 v163, v163
    v_rcp_f32 v164, v164
    v_rcp_f32 v165, v165
    v_rcp_f32 v166, v166
    v_rcp_f32 v167, v167
    v_pk_mul_f32 v[40:41], v[40:41], v[152:153]
    v_pk_mul_f32 v[42:43], v[42:43], v[154:155]
    v_pk_mul_f32 v[68:69], v[68:69], v[156:157]
    v_pk_mul_f32 v[70:71], v[70:71], v[158:159]
    v_pk_mul_f32 v[96:97], v[96:97], v[160:161]
    v_pk_mul_f32 v[98:99], v[98:99], v[162:163]
    v_pk_mul_f32 v[124:125], v[124:125], v[164:165]
    v_pk_mul_f32 v[126:127], v[126:127], v[166:167]
    v_cvt_pk_bf16_f32 v184, v40, v41
    v_cvt_pk_bf16_f32 v185, v42, v43
    v_cvt_pk_bf16_f32 v188, v68, v69
    v_cvt_pk_bf16_f32 v189, v70, v71
    v_cvt_pk_bf16_f32 v192, v96, v97
    v_cvt_pk_bf16_f32 v193, v98, v99
    v_cvt_pk_bf16_f32 v196, v124, v125
    v_cvt_pk_bf16_f32 v197, v126, v127
    v_mov_b32 v13, 156692
    v_mov_b32 v11, 1
    s_waitcnt vmcnt(0)
    s_mov_b64 exec, 1
    ds_add_rtn_u32 v11, v13, v11
    s_waitcnt lgkmcnt(0)
    v_cmp_eq_u32 vcc, 3, v11
    s_nop 1
    s_cbranch_vccz mlp1_fg0
    buffer_store_dword v12, off, s[16:19], s92 sc1
mlp1_fg0:
    s_mov_b64 exec, -1
    ds_write_b64 v8, v[184:185] offset:32768
    ds_write_b64 v8, v[188:189] offset:33792
    ds_write_b64 v8, v[192:193] offset:36864
    ds_write_b64 v8, v[196:197] offset:37888
    s_branch mlp1_e2
mlp1_e1:
    ds_read_b128 v[136:139], v3 offset:64
    ds_read_b128 v[140:143], v3 offset:1088
    s_add_u32 s40, s40, 2048
    s_add_u32 s41, s41, 2048
    ds_read_b128 v[144:147], v3 offset:128
    ds_read_b128 v[148:151], v3 offset:1152
    s_waitcnt lgkmcnt(2)
    v_pk_fma_f32 v[152:153], v[136:137], v[128:129], v[140:141] op_sel:[0,1,0] op_sel_hi:[1,1,1] neg_lo:[1,0,0] neg_hi:[1,0,0]
    v_pk_fma_f32 v[154:155], v[138:139], v[128:129], v[142:143] op_sel:[0,1,0] op_sel_hi:[1,1,1] neg_lo:[1,0,0] neg_hi:[1,0,0]
    v_pk_fma_f32 v[156:157], v[136:137], v[130:131], v[140:141] op_sel:[0,1,0] op_sel_hi:[1,1,1] neg_lo:[1,0,0] neg_hi:[1,0,0]
    v_pk_fma_f32 v[158:159], v[138:139], v[130:131], v[142:143] op_sel:[0,1,0] op_sel_hi:[1,1,1] neg_lo:[1,0,0] neg_hi:[1,0,0]
    v_pk_fma_f32 v[160:161], v[136:137], v[132:133], v[140:141] op_sel:[0,1,0] op_sel_hi:[1,1,1] neg_lo:[1,0,0] neg_hi:[1,0,0]
    v_pk_fma_f32 v[162:163], v[138:139], v[132:133], v[142:143] op_sel:[0,1,0] op_sel_hi:[1,1,1] neg_lo:[1,0,0] neg_hi:[1,0,0]
    v_pk_fma_f32 v[164:165], v[136:137], v[134:135], v[140:141] op_sel:[0,1,0] op_sel_hi:[1,1,1] neg_lo:[1,0,0] neg_hi:[1,0,0]
    v_pk_fma_f32 v[166:167], v[138:139], v[134:135], v[142:143] op_sel:[0,1,0] op_sel_hi:[1,1,1] neg_lo:[1,0,0] neg_hi:[1,0,0]
    v_pk_fma_f32 v[20:21], v[20:21], v[128:129], v[152:153] op_sel_hi:[1,0,1]
    v_pk_fma_f32 v[22:23], v[22:23], v[128:129], v[154:155] op_sel_hi:[1,0,1]
    v_pk_fma_f32 v[48:49], v[48:49], v[130:131], v[156:157] op_sel_hi:[1,0,1]
    v_pk_fma_f32 v[50:51], v[50:51], v[130:131], v[158:159] op_sel_hi:[1,0,1]
    v_pk_fma_f32 v[76:77], v[76:77], v[132:133], v[160:161] op_sel_hi:[1,0,1]
    v_pk_fma_f32 v[78:79], v[78:79], v[132:133], v[162:163] op_sel_hi:[1,0,1]
    v_pk_fma_f32 v[104:105], v[104:105], v[134:135], v[164:165] op_sel_hi:[1,0,1]
    v_pk_fma_f32 v[106:107], v[106:107], v[134:135], v[166:167] op_sel_hi:[1,0,1]
    v_pk_mul_f32 v[152:153], v[20:21], v[20:21]
    v_pk_mul_f32 v[154:155], v[22:23], v[22:23]
    v_pk_mul_f32 v[156:157], v[48:49], v[48:49]
    v_pk_mul_f32 v[158:159], v[50:51], v[50:51]
    v_pk_mul_f32 v[160:161], v[76:77], v[76:77]
    v_pk_mul_f32 v[162:163], v[78:79], v[78:79]
    v_pk_mul_f32 v[164:165], v[104:105], v[104:105]
    v_pk_mul_f32 v[166:167], v[106:107], v[106:107]
    v_pk_fma_f32 v[152:153], v[152:153], v[250:251], v[250:251] op_sel:[0,1,0] op_sel_hi:[1,1,0]
    v_pk_fma_f32 v[154:155], v[154:155], v[250:251], v[250:251] op_sel:[0,1,0] op_sel_hi:[1,1,0]
    v_pk_fma_f32 v[156:157], v[156:157], v[250:251], v[250:251] op_sel:[0,1,0] op_sel_hi:[1,1,0]
    v_pk_fma_f32 v[158:159], v[158:159], v[250:251], v[250:251] op_sel:[0,1,0] op_sel_hi:[1,1,0]
    v_pk_fma_f32 v[160:161], v[160:161], v[250:251], v[250:251] op_sel:[0,1,0] op_sel_hi:[1,1,0]
    v_pk_fma_f32 v[162:163], v[162:163], v[250:251], v[250:251] op_sel:[0,1,0] op_sel_hi:[1,1,0]
    v_pk_fma_f32 v[164:165], v[164:165], v[250:251], v[250:251] op_sel:[0,1,0] op_sel_hi:[1,1,0]
    v_pk_fma_f32 v[166:167], v[166:167], v[250:251], v[250:251] op_sel:[0,1,0] op_sel_hi:[1,1,0]
    v_pk_mul_f32 v[152:153], v[152:153], v[20:21]
    v_pk_mul_f32 v[154:155], v[154:155], v[22:23]
    v_pk_mul_f32 v[156:157], v[156:157], v[48:49]
    v_pk_mul_f32 v[158:159], v[158:159], v[50:51]
    v_pk_mul_f32 v[160:161], v[160:161], v[76:77]
    v_pk_mul_f32 v[162:163], v[162:163], v[78:79]
    v_pk_mul_f32 v[164:165], v[164:165], v[104:105]
    v_pk_mul_f32 v[166:167], v[166:167], v[106:107]
    v_exp_f32 v152, v152
    v_exp_f32 v153, v153
    v_exp_f32 v154, v154
    v_exp_f32 v155, v155
    v_exp_f32 v156, v156
    v_exp_f32 v157, v157
    v_exp_f32 v158, v158
    v_exp_f32 v159, v159
    v_exp_f32 v160, v160
    v_exp_f32 v161, v161
    v_exp_f32 v162, v162
    v_exp_f32 v163, v163
    v_exp_f32 v164, v164
    v_exp_f32 v165, v165
    v_exp_f32 v166, v166
    v_exp_f32 v167, v167
    v_pk_add_f32 v[152:153], v[152:153], v[248:249]
    v_pk_add_f32 v[154:155], v[154:155], v[248:249]
    v_pk_add_f32 v[156:157], v[156:157], v[248:249]
    v_pk_add_f32 v[158:159], v[158:159], v[248:249]
    v_pk_add_f32 v[160:161], v[160:161], v[248:249]
    v_pk_add_f32 v[162:163], v[162:163], v[248:249]
    v_pk_add_f32 v[164:165], v[164:165], v[248:249]
    v_pk_add_f32 v[166:167], v[166:167], v[248:249]
    v_rcp_f32 v152, v152
    v_rcp_f32 v153, v153
    v_rcp_f32 v154, v154
    v_rcp_f32 v155, v155
    v_rcp_f32 v156, v156
    v_rcp_f32 v157, v157
    v_rcp_f32 v158, v158
    v_rcp_f32 v159, v159
    v_rcp_f32 v160, v160
    v_rcp_f32 v161, v161
    v_rcp_f32 v162, v162
    v_rcp_f32 v163, v163
    v_rcp_f32 v164, v164
    v_rcp_f32 v165, v165
    v_rcp_f32 v166, v166
    v_rcp_f32 v167, v167
    v_pk_mul_f32 v[20:21], v[20:21], v[152:153]
    v_pk_mul_f32 v[22:23], v[22:23], v[154:155]
    v_pk_mul_f32 v[48:49], v[48:49], v[156:157]
    v_pk_mul_f32 v[50:51], v[50:51], v[158:159]
    v_pk_mul_f32 v[76:77], v[76:77], v[160:161]
    v_pk_mul_f32 v[78:79], v[78:79], v[162:163]
    v_pk_mul_f32 v[104:105], v[104:105], v[164:165]
    v_pk_mul_f32 v[106:107], v[106:107], v[166:167]
    v_cvt_pk_bf16_f32 v168, v20, v21
    v_cvt_pk_bf16_f32 v169, v22, v23
    v_cvt_pk_bf16_f32 v172, v48, v49
    v_cvt_pk_bf16_f32 v173, v50, v51
    v_cvt_pk_bf16_f32 v176, v76, v77
    v_cvt_pk_bf16_f32 v177, v78, v79
    v_cvt_pk_bf16_f32 v180, v104, v105
    v_cvt_pk_bf16_f32 v181, v106, v107
    ds_read_b128 v[136:139], v3 offset:192
    ds_read_b128 v[140:143], v3 offset:1216
    s_waitcnt lgkmcnt(2)
    v_pk_fma_f32 v[152:153], v[144:145], v[128:129], v[148:149] op_sel:[0,1,0] op_sel_hi:[1,1,1] neg_lo:[1,0,0] neg_hi:[1,0,0]
    v_pk_fma_f32 v[154:155], v[146:147], v[128:129], v[150:151] op_sel:[0,1,0] op_sel_hi:[1,1,1] neg_lo:[1,0,0] neg_hi:[1,0,0]
    v_pk_fma_f32 v[156:157], v[144:145], v[130:131], v[148:149] op_sel:[0,1,0] op_sel_hi:[1,1,1] neg_lo:[1,0,0] neg_hi:[1,0,0]
    v_pk_fma_f32 v[158:159], v[146:147], v[130:131], v[150:151] op_sel:[0,1,0] op_sel_hi:[1,1,1] neg_lo:[1,0,0] neg_hi:[1,0,0]
    v_pk_fma_f32 v[160:161], v[144:145], v[132:133], v[148:149] op_sel:[0,1,0] op_sel_hi:[1,1,1] neg_lo:[1,0,0] neg_hi:[1,0,0]
    v_pk_fma_f32 v[162:163], v[146:147], v[132:133], v[150:151] op_sel:[0,1,0] op_sel_hi:[1,1,1] neg_lo:[1,0,0] neg_hi:[1,0,0]
    v_pk_fma_f32 v[164:165], v[144:145], v[134:135], v[148:149] op_sel:[0,1,0] op_sel_hi:[1,1,1] neg_lo:[1,0,0] neg_hi:[1,0,0]
    v_pk_fma_f32 v[166:167], v[146:147], v[134:135], v[150:151] op_sel:[0,1,0] op_sel_hi:[1,1,1] neg_lo:[1,0,0] neg_hi:[1,0,0]
    v_pk_fma_f32 v[24:25], v[24:25], v[128:129], v[152:153] op_sel_hi:[1,0,1]
    v_pk_fma_f32 v[26:27], v[26:27], v[128:129], v[154:155] op_sel_hi:[1,0,1]
    v_pk_fma_f32 v[52:53], v[52:53], v[130:131], v[156:157] op_sel_hi:[1,0,1]
    v_pk_fma_f32 v[54:55], v[54:55], v[130:131], v[158:159] op_sel_hi:[1,0,1]
    v_pk_fma_f32 v[80:81], v[80:81], v[132:133], v[160:161] op_sel_hi:[1,0,1]
    v_pk_fma_f32 v[82:83], v[82:83], v[132:133], v[162:163] op_sel_hi:[1,0,1]
    v_pk_fma_f32 v[108:109], v[108:109], v[134:135], v[164:165] op_sel_hi:[1,0,1]
    v_pk_fma_f32 v[110:111], v[110:111], v[134:135], v[166:167] op_sel_hi:[1,0,1]
    v_pk_mul_f32 v[152:153], v[24:25], v[24:25]
    v_pk_mul_f32 v[154:155], v[26:27], v[26:27]
    v_pk_mul_f32 v[156:157], v[52:53], v[52:53]
    v_pk_mul_f32 v[158:159], v[54:55], v[54:55]
    v_pk_mul_f32 v[160:161], v[80:81], v[80:81]
    v_pk_mul_f32 v[162:163], v[82:83], v[82:83]
    v_pk_mul_f32 v[164:165], v[108:109], v[108:109]
    v_pk_mul_f32 v[166:167], v[110:111], v[110:111]
    v_pk_fma_f32 v[152:153], v[152:153], v[250:251], v[250:251] op_sel:[0,1,0] op_sel_hi:[1,1,0]
    v_pk_fma_f32 v[154:155], v[154:155], v[250:251], v[250:251] op_sel:[0,1,0] op_sel_hi:[1,1,0]
    v_pk_fma_f32 v[156:157], v[156:157], v[250:251], v[250:251] op_sel:[0,1,0] op_sel_hi:[1,1,0]
    v_pk_fma_f32 v[158:159], v[158:159], v[250:251], v[250:251] op_sel:[0,1,0] op_sel_hi:[1,1,0]
    v_pk_fma_f32 v[160:161], v[160:161], v[250:251], v[250:251] op_sel:[0,1,0] op_sel_hi:[1,1,0]
    v_pk_fma_f32 v[162:163], v[162:163], v[250:251], v[250:251] op_sel:[0,1,0] op_sel_hi:[1,1,0]
    v_pk_fma_f32 v[164:165], v[164:165], v[250:251], v[250:251] op_sel:[0,1,0] op_sel_hi:[1,1,0]
    v_pk_fma_f32 v[166:167], v[166:167], v[250:251], v[250:251] op_sel:[0,1,0] op_sel_hi:[1,1,0]
    v_pk_mul_f32 v[152:153], v[152:153], v[24:25]
    v_pk_mul_f32 v[154:155], v[154:155], v[26:27]
    v_pk_mul_f32 v[156:157], v[156:157], v[52:53]
    v_pk_mul_f32 v[158:159], v[158:159], v[54:55]
    v_pk_mul_f32 v[160:161], v[160:161], v[80:81]
    v_pk_mul_f32 v[162:163], v[162:163], v[82:83]
    v_pk_mul_f32 v[164:165], v[164:165], v[108:109]
    v_pk_mul_f32 v[166:167], v[166:167], v[110:111]
    v_exp_f32 v152, v152
    v_exp_f32 v153, v153
    v_exp_f32 v154, v154
    v_exp_f32 v155, v155
    v_exp_f32 v156, v156
    v_exp_f32 v157, v157
    v_exp_f32 v158, v158
    v_exp_f32 v159, v159
    v_exp_f32 v160, v160
    v_exp_f32 v161, v161
    v_exp_f32 v162, v162
    v_exp_f32 v163, v163
    v_exp_f32 v164, v164
    v_exp_f32 v165, v165
    v_exp_f32 v166, v166
    v_exp_f32 v167, v167
    v_pk_add_f32 v[152:153], v[152:153], v[248:249]
    v_pk_add_f32 v[154:155], v[154:155], v[248:249]
    v_pk_add_f32 v[156:157], v[156:157], v[248:249]
    v_pk_add_f32 v[158:159], v[158:159], v[248:249]
    v_pk_add_f32 v[160:161], v[160:161], v[248:249]
    v_pk_add_f32 v[162:163], v[162:163], v[248:249]
    v_pk_add_f32 v[164:165], v[164:165], v[248:249]
    v_pk_add_f32 v[166:167], v[166:167], v[248:249]
    v_rcp_f32 v152, v152
    v_rcp_f32 v153, v153
    v_rcp_f32 v154, v154
    v_rcp_f32 v155, v155
    v_rcp_f32 v156, v156
    v_rcp_f32 v157, v157
    v_rcp_f32 v158, v158
    v_rcp_f32 v159, v159
    v_rcp_f32 v160, v160
    v_rcp_f32 v161, v161
    v_rcp_f32 v162, v162
    v_rcp_f32 v163, v163
    v_rcp_f32 v164, v164
    v_rcp_f32 v165, v165
    v_rcp_f32 v166, v166
    v_rcp_f32 v167, v167
    v_pk_mul_f32 v[24:25], v[24:25], v[152:153]
    v_pk_mul_f32 v[26:27], v[26:27], v[154:155]
    v_pk_mul_f32 v[52:53], v[52:53], v[156:157]
    v_pk_mul_f32 v[54:55], v[54:55], v[158:159]
    v_pk_mul_f32 v[80:81], v[80:81], v[160:161]
    v_pk_mul_f32 v[82:83], v[82:83], v[162:163]
    v_pk_mul_f32 v[108:109], v[108:109], v[164:165]
    v_pk_mul_f32 v[110:111], v[110:111], v[166:167]
    v_cvt_pk_bf16_f32 v170, v24, v25
    v_cvt_pk_bf16_f32 v171, v26, v27
    v_cvt_pk_bf16_f32 v174, v52, v53
    v_cvt_pk_bf16_f32 v175, v54, v55
    v_cvt_pk_bf16_f32 v178, v80, v81
    v_cvt_pk_bf16_f32 v179, v82, v83
    v_cvt_pk_bf16_f32 v182, v108, v109
    v_cvt_pk_bf16_f32 v183, v110, v111
    ds_write_b128 v7, v[168:171] offset:32768
    ds_write_b128 v7, v[172:175] offset:33792
    ds_write_b128 v7, v[176:179] offset:36864
    ds_write_b128 v7, v[180:183] offset:37888
    buffer_store_dwordx4 v[168:171], v6, s[16:19], s40 offen offset:0 sc1
    buffer_store_dwordx4 v[172:175], v6, s[16:19], s40 offen offset:1024 sc1
    buffer_store_dwordx4 v[176:179], v6, s[16:19], s41 offen offset:0 sc1
    buffer_store_dwordx4 v[180:183], v6, s[16:19], s41 offen offset:1024 sc1
    s_add_u32 s40, s40, 2048
    s_add_u32 s41, s41, 2048
    ds_read_b128 v[144:147], v3 offset:256
    ds_read_b128 v[148:151], v3 offset:1280
    s_waitcnt lgkmcnt(2)
    v_pk_fma_f32 v[152:153], v[136:137], v[128:129], v[140:141] op_sel:[0,1,0] op_sel_hi:[1,1,1] neg_lo:[1,0,0] neg_hi:[1,0,0]
    v_pk_fma_f32 v[154:155], v[138:139], v[128:129], v[142:143] op_sel:[0,1,0] op_sel_hi:[1,1,1] neg_lo:[1,0,0] neg_hi:[1,0,0]
    v_pk_fma_f32 v[156:157], v[136:137], v[130:131], v[140:141] op_sel:[0,1,0] op_sel_hi:[1,1,1] neg_lo:[1,0,0] neg_hi:[1,0,0]
    v_pk_fma_f32 v[158:159], v[138:139], v[130:131], v[142:143] op_sel:[0,1,0] op_sel_hi:[1,1,1] neg_lo:[1,0,0] neg_hi:[1,0,0]
    v_pk_fma_f32 v[160:161], v[136:137], v[132:133], v[140:141] op_sel:[0,1,0] op_sel_hi:[1,1,1] neg_lo:[1,0,0] neg_hi:[1,0,0]
    v_pk_fma_f32 v[162:163], v[138:139], v[132:133], v[142:143] op_sel:[0,1,0] op_sel_hi:[1,1,1] neg_lo:[1,0,0] neg_hi:[1,0,0]
    v_pk_fma_f32 v[164:165], v[136:137], v[134:135], v[140:141] op_sel:[0,1,0] op_sel_hi:[1,1,1] neg_lo:[1,0,0] neg_hi:[1,0,0]
    v_pk_fma_f32 v[166:167], v[138:139], v[134:135], v[142:143] op_sel:[0,1,0] op_sel_hi:[1,1,1] neg_lo:[1,0,0] neg_hi:[1,0,0]
    v_pk_fma_f32 v[28:29], v[28:29], v[128:129], v[152:153] op_sel_hi:[1,0,1]
    v_pk_fma_f32 v[30:31], v[30:31], v[128:129], v[154:155] op_sel_hi:[1,0,1]
    v_pk_fma_f32 v[56:57], v[56:57], v[130:131], v[156:157] op_sel_hi:[1,0,1]
    v_pk_fma_f32 v[58:59], v[58:59], v[130:131], v[158:159] op_sel_hi:[1,0,1]
    v_pk_fma_f32 v[84:85], v[84:85], v[132:133], v[160:161] op_sel_hi:[1,0,1]
    v_pk_fma_f32 v[86:87], v[86:87], v[132:133], v[162:163] op_sel_hi:[1,0,1]
    v_pk_fma_f32 v[112:113], v[112:113], v[134:135], v[164:165] op_sel_hi:[1,0,1]
    v_pk_fma_f32 v[114:115], v[114:115], v[134:135], v[166:167] op_sel_hi:[1,0,1]
    v_pk_mul_f32 v[152:153], v[28:29], v[28:29]
    v_pk_mul_f32 v[154:155], v[30:31], v[30:31]
    v_pk_mul_f32 v[156:157], v[56:57], v[56:57]
    v_pk_mul_f32 v[158:159], v[58:59], v[58:59]
    v_pk_mul_f32 v[160:161], v[84:85], v[84:85]
    v_pk_mul_f32 v[162:163], v[86:87], v[86:87]
    v_pk_mul_f32 v[164:165], v[112:113], v[112:113]
    v_pk_mul_f32 v[166:167], v[114:115], v[114:115]
    v_pk_fma_f32 v[152:153], v[152:153], v[250:251], v[250:251] op_sel:[0,1,0] op_sel_hi:[1,1,0]
    v_pk_fma_f32 v[154:155], v[154:155], v[250:251], v[250:251] op_sel:[0,1,0] op_sel_hi:[1,1,0]
    v_pk_fma_f32 v[156:157], v[156:157], v[250:251], v[250:251] op_sel:[0,1,0] op_sel_hi:[1,1,0]
    v_pk_fma_f32 v[158:159], v[158:159], v[250:251], v[250:251] op_sel:[0,1,0] op_sel_hi:[1,1,0]
    v_pk_fma_f32 v[160:161], v[160:161], v[250:251], v[250:251] op_sel:[0,1,0] op_sel_hi:[1,1,0]
    v_pk_fma_f32 v[162:163], v[162:163], v[250:251], v[250:251] op_sel:[0,1,0] op_sel_hi:[1,1,0]
    v_pk_fma_f32 v[164:165], v[164:165], v[250:251], v[250:251] op_sel:[0,1,0] op_sel_hi:[1,1,0]
    v_pk_fma_f32 v[166:167], v[166:167], v[250:251], v[250:251] op_sel:[0,1,0] op_sel_hi:[1,1,0]
    v_pk_mul_f32 v[152:153], v[152:153], v[28:29]
    v_pk_mul_f32 v[154:155], v[154:155], v[30:31]
    v_pk_mul_f32 v[156:157], v[156:157], v[56:57]
    v_pk_mul_f32 v[158:159], v[158:159], v[58:59]
    v_pk_mul_f32 v[160:161], v[160:161], v[84:85]
    v_pk_mul_f32 v[162:163], v[162:163], v[86:87]
    v_pk_mul_f32 v[164:165], v[164:165], v[112:113]
    v_pk_mul_f32 v[166:167], v[166:167], v[114:115]
    v_exp_f32 v152, v152
    v_exp_f32 v153, v153
    v_exp_f32 v154, v154
    v_exp_f32 v155, v155
    v_exp_f32 v156, v156
    v_exp_f32 v157, v157
    v_exp_f32 v158, v158
    v_exp_f32 v159, v159
    v_exp_f32 v160, v160
    v_exp_f32 v161, v161
    v_exp_f32 v162, v162
    v_exp_f32 v163, v163
    v_exp_f32 v164, v164
    v_exp_f32 v165, v165
    v_exp_f32 v166, v166
    v_exp_f32 v167, v167
    v_pk_add_f32 v[152:153], v[152:153], v[248:249]
    v_pk_add_f32 v[154:155], v[154:155], v[248:249]
    v_pk_add_f32 v[156:157], v[156:157], v[248:249]
    v_pk_add_f32 v[158:159], v[158:159], v[248:249]
    v_pk_add_f32 v[160:161], v[160:161], v[248:249]
    v_pk_add_f32 v[162:163], v[162:163], v[248:249]
    v_pk_add_f32 v[164:165], v[164:165], v[248:249]
    v_pk_add_f32 v[166:167], v[166:167], v[248:249]
    v_rcp_f32 v152, v152
    v_rcp_f32 v153, v153
    v_rcp_f32 v154, v154
    v_rcp_f32 v155, v155
    v_rcp_f32 v156, v156
    v_rcp_f32 v157, v157
    v_rcp_f32 v158, v158
    v_rcp_f32 v159, v159
    v_rcp_f32 v160, v160
    v_rcp_f32 v161, v161
    v_rcp_f32 v162, v162
    v_rcp_f32 v163, v163
    v_rcp_f32 v164, v164
    v_rcp_f32 v165, v165
    v_rcp_f32 v166, v166
    v_rcp_f32 v167, v167
    v_pk_mul_f32 v[28:29], v[28:29], v[152:153]
    v_pk_mul_f32 v[30:31], v[30:31], v[154:155]
    v_pk_mul_f32 v[56:57], v[56:57], v[156:157]
    v_pk_mul_f32 v[58:59], v[58:59], v[158:159]
    v_pk_mul_f32 v[84:85], v[84:85], v[160:161]
    v_pk_mul_f32 v[86:87], v[86:87], v[162:163]
    v_pk_mul_f32 v[112:113], v[112:113], v[164:165]
    v_pk_mul_f32 v[114:115], v[114:115], v[166:167]
    v_cvt_pk_bf16_f32 v168, v28, v29
    v_cvt_pk_bf16_f32 v169, v30, v31
    v_cvt_pk_bf16_f32 v172, v56, v57
    v_cvt_pk_bf16_f32 v173, v58, v59
    v_cvt_pk_bf16_f32 v176, v84, v85
    v_cvt_pk_bf16_f32 v177, v86, v87
    v_cvt_pk_bf16_f32 v180, v112, v113
    v_cvt_pk_bf16_f32 v181, v114, v115
    ds_read_b128 v[136:139], v3 offset:320
    ds_read_b128 v[140:143], v3 offset:1344
    s_waitcnt lgkmcnt(2)
    v_pk_fma_f32 v[152:153], v[144:145], v[128:129], v[148:149] op_sel:[0,1,0] op_sel_hi:[1,1,1] neg_lo:[1,0,0] neg_hi:[1,0,0]
    v_pk_fma_f32 v[154:155], v[146:147], v[128:129], v[150:151] op_sel:[0,1,0] op_sel_hi:[1,1,1] neg_lo:[1,0,0] neg_hi:[1,0,0]
    v_pk_fma_f32 v[156:157], v[144:145], v[130:131], v[148:149] op_sel:[0,1,0] op_sel_hi:[1,1,1] neg_lo:[1,0,0] neg_hi:[1,0,0]
    v_pk_fma_f32 v[158:159], v[146:147], v[130:131], v[150:151] op_sel:[0,1,0] op_sel_hi:[1,1,1] neg_lo:[1,0,0] neg_hi:[1,0,0]
    v_pk_fma_f32 v[160:161], v[144:145], v[132:133], v[148:149] op_sel:[0,1,0] op_sel_hi:[1,1,1] neg_lo:[1,0,0] neg_hi:[1,0,0]
    v_pk_fma_f32 v[162:163], v[146:147], v[132:133], v[150:151] op_sel:[0,1,0] op_sel_hi:[1,1,1] neg_lo:[1,0,0] neg_hi:[1,0,0]
    v_pk_fma_f32 v[164:165], v[144:145], v[134:135], v[148:149] op_sel:[0,1,0] op_sel_hi:[1,1,1] neg_lo:[1,0,0] neg_hi:[1,0,0]
    v_pk_fma_f32 v[166:167], v[146:147], v[134:135], v[150:151] op_sel:[0,1,0] op_sel_hi:[1,1,1] neg_lo:[1,0,0] neg_hi:[1,0,0]
    v_pk_fma_f32 v[32:33], v[32:33], v[128:129], v[152:153] op_sel_hi:[1,0,1]
    v_pk_fma_f32 v[34:35], v[34:35], v[128:129], v[154:155] op_sel_hi:[1,0,1]
    v_pk_fma_f32 v[60:61], v[60:61], v[130:131], v[156:157] op_sel_hi:[1,0,1]
    v_pk_fma_f32 v[62:63], v[62:63], v[130:131], v[158:159] op_sel_hi:[1,0,1]
    v_pk_fma_f32 v[88:89], v[88:89], v[132:133], v[160:161] op_sel_hi:[1,0,1]
    v_pk_fma_f32 v[90:91], v[90:91], v[132:133], v[162:163] op_sel_hi:[1,0,1]
    v_pk_fma_f32 v[116:117], v[116:117], v[134:135], v[164:165] op_sel_hi:[1,0,1]
    v_pk_fma_f32 v[118:119], v[118:119], v[134:135], v[166:167] op_sel_hi:[1,0,1]
    v_pk_mul_f32 v[152:153], v[32:33], v[32:33]
    v_pk_mul_f32 v[154:155], v[34:35], v[34:35]
    v_pk_mul_f32 v[156:157], v[60:61], v[60:61]
    v_pk_mul_f32 v[158:159], v[62:63], v[62:63]
    v_pk_mul_f32 v[160:161], v[88:89], v[88:89]
    v_pk_mul_f32 v[162:163], v[90:91], v[90:91]
    v_pk_mul_f32 v[164:165], v[116:117], v[116:117]
    v_pk_mul_f32 v[166:167], v[118:119], v[118:119]
    v_pk_fma_f32 v[152:153], v[152:153], v[250:251], v[250:251] op_sel:[0,1,0] op_sel_hi:[1,1,0]
    v_pk_fma_f32 v[154:155], v[154:155], v[250:251], v[250:251] op_sel:[0,1,0] op_sel_hi:[1,1,0]
    v_pk_fma_f32 v[156:157], v[156:157], v[250:251], v[250:251] op_sel:[0,1,0] op_sel_hi:[1,1,0]
    v_pk_fma_f32 v[158:159], v[158:159], v[250:251], v[250:251] op_sel:[0,1,0] op_sel_hi:[1,1,0]
    v_pk_fma_f32 v[160:161], v[160:161], v[250:251], v[250:251] op_sel:[0,1,0] op_sel_hi:[1,1,0]
    v_pk_fma_f32 v[162:163], v[162:163], v[250:251], v[250:251] op_sel:[0,1,0] op_sel_hi:[1,1,0]
    v_pk_fma_f32 v[164:165], v[164:165], v[250:251], v[250:251] op_sel:[0,1,0] op_sel_hi:[1,1,0]
    v_pk_fma_f32 v[166:167], v[166:167], v[250:251], v[250:251] op_sel:[0,1,0] op_sel_hi:[1,1,0]
    v_pk_mul_f32 v[152:153], v[152:153], v[32:33]
    v_pk_mul_f32 v[154:155], v[154:155], v[34:35]
    v_pk_mul_f32 v[156:157], v[156:157], v[60:61]
    v_pk_mul_f32 v[158:159], v[158:159], v[62:63]
    v_pk_mul_f32 v[160:161], v[160:161], v[88:89]
    v_pk_mul_f32 v[162:163], v[162:163], v[90:91]
    v_pk_mul_f32 v[164:165], v[164:165], v[116:117]
    v_pk_mul_f32 v[166:167], v[166:167], v[118:119]
    v_exp_f32 v152, v152
    v_exp_f32 v153, v153
    v_exp_f32 v154, v154
    v_exp_f32 v155, v155
    v_exp_f32 v156, v156
    v_exp_f32 v157, v157
    v_exp_f32 v158, v158
    v_exp_f32 v159, v159
    v_exp_f32 v160, v160
    v_exp_f32 v161, v161
    v_exp_f32 v162, v162
    v_exp_f32 v163, v163
    v_exp_f32 v164, v164
    v_exp_f32 v165, v165
    v_exp_f32 v166, v166
    v_exp_f32 v167, v167
    v_pk_add_f32 v[152:153], v[152:153], v[248:249]
    v_pk_add_f32 v[154:155], v[154:155], v[248:249]
    v_pk_add_f32 v[156:157], v[156:157], v[248:249]
    v_pk_add_f32 v[158:159], v[158:159], v[248:249]
    v_pk_add_f32 v[160:161], v[160:161], v[248:249]
    v_pk_add_f32 v[162:163], v[162:163], v[248:249]
    v_pk_add_f32 v[164:165], v[164:165], v[248:249]
    v_pk_add_f32 v[166:167], v[166:167], v[248:249]
    v_rcp_f32 v152, v152
    v_rcp_f32 v153, v153
    v_rcp_f32 v154, v154
    v_rcp_f32 v155, v155
    v_rcp_f32 v156, v156
    v_rcp_f32 v157, v157
    v_rcp_f32 v158, v158
    v_rcp_f32 v159, v159
    v_rcp_f32 v160, v160
    v_rcp_f32 v161, v161
    v_rcp_f32 v162, v162
    v_rcp_f32 v163, v163
    v_rcp_f32 v164, v164
    v_rcp_f32 v165, v165
    v_rcp_f32 v166, v166
    v_rcp_f32 v167, v167
    v_pk_mul_f32 v[32:33], v[32:33], v[152:153]
    v_pk_mul_f32 v[34:35], v[34:35], v[154:155]
    v_pk_mul_f32 v[60:61], v[60:61], v[156:157]
    v_pk_mul_f32 v[62:63], v[62:63], v[158:159]
    v_pk_mul_f32 v[88:89], v[88:89], v[160:161]
    v_pk_mul_f32 v[90:91], v[90:91], v[162:163]
    v_pk_mul_f32 v[116:117], v[116:117], v[164:165]
    v_pk_mul_f32 v[118:119], v[118:119], v[166:167]
    v_cvt_pk_bf16_f32 v170, v32, v33
    v_cvt_pk_bf16_f32 v171, v34, v35
    v_cvt_pk_bf16_f32 v174, v60, v61
    v_cvt_pk_bf16_f32 v175, v62, v63
    v_cvt_pk_bf16_f32 v178, v88, v89
    v_cvt_pk_bf16_f32 v179, v90, v91
    v_cvt_pk_bf16_f32 v182, v116, v117
    v_cvt_pk_bf16_f32 v183, v118, v119
    ds_write_b128 v7, v[168:171] offset:34816
    ds_write_b128 v7, v[172:175] offset:35840
    ds_write_b128 v7, v[176:179] offset:38912
    ds_write_b128 v7, v[180:183] offset:39936
    buffer_store_dwordx4 v[168:171], v6, s[16:19], s40 offen offset:0 sc1
    buffer_store_dwordx4 v[172:175], v6, s[16:19], s40 offen offset:1024 sc1
    buffer_store_dwordx4 v[176:179], v6, s[16:19], s41 offen offset:0 sc1
    buffer_store_dwordx4 v[180:183], v6, s[16:19], s41 offen offset:1024 sc1
    s_add_u32 s40, s40, 2048
    s_add_u32 s41, s41, 2048
    ds_read_b128 v[144:147], v3 offset:384
    ds_read_b128 v[148:151], v3 offset:1408
    s_waitcnt lgkmcnt(2)
    v_pk_fma_f32 v[152:153], v[136:137], v[128:129], v[140:141] op_sel:[0,1,0] op_sel_hi:[1,1,1] neg_lo:[1,0,0] neg_hi:[1,0,0]
    v_pk_fma_f32 v[154:155], v[138:139], v[128:129], v[142:143] op_sel:[0,1,0] op_sel_hi:[1,1,1] neg_lo:[1,0,0] neg_hi:[1,0,0]
    v_pk_fma_f32 v[156:157], v[136:137], v[130:131], v[140:141] op_sel:[0,1,0] op_sel_hi:[1,1,1] neg_lo:[1,0,0] neg_hi:[1,0,0]
    v_pk_fma_f32 v[158:159], v[138:139], v[130:131], v[142:143] op_sel:[0,1,0] op_sel_hi:[1,1,1] neg_lo:[1,0,0] neg_hi:[1,0,0]
    v_pk_fma_f32 v[160:161], v[136:137], v[132:133], v[140:141] op_sel:[0,1,0] op_sel_hi:[1,1,1] neg_lo:[1,0,0] neg_hi:[1,0,0]
    v_pk_fma_f32 v[162:163], v[138:139], v[132:133], v[142:143] op_sel:[0,1,0] op_sel_hi:[1,1,1] neg_lo:[1,0,0] neg_hi:[1,0,0]
    v_pk_fma_f32 v[164:165], v[136:137], v[134:135], v[140:141] op_sel:[0,1,0] op_sel_hi:[1,1,1] neg_lo:[1,0,0] neg_hi:[1,0,0]
    v_pk_fma_f32 v[166:167], v[138:139], v[134:135], v[142:143] op_sel:[0,1,0] op_sel_hi:[1,1,1] neg_lo:[1,0,0] neg_hi:[1,0,0]
    v_pk_fma_f32 v[36:37], v[36:37], v[128:129], v[152:153] op_sel_hi:[1,0,1]
    v_pk_fma_f32 v[38:39], v[38:39], v[128:129], v[154:155] op_sel_hi:[1,0,1]
    v_pk_fma_f32 v[64:65], v[64:65], v[130:131], v[156:157] op_sel_hi:[1,0,1]
    v_pk_fma_f32 v[66:67], v[66:67], v[130:131], v[158:159] op_sel_hi:[1,0,1]
    v_pk_fma_f32 v[92:93], v[92:93], v[132:133], v[160:161] op_sel_hi:[1,0,1]
    v_pk_fma_f32 v[94:95], v[94:95], v[132:133], v[162:163] op_sel_hi:[1,0,1]
    v_pk_fma_f32 v[120:121], v[120:121], v[134:135], v[164:165] op_sel_hi:[1,0,1]
    v_pk_fma_f32 v[122:123], v[122:123], v[134:135], v[166:167] op_sel_hi:[1,0,1]
    v_pk_mul_f32 v[152:153], v[36:37], v[36:37]
    v_pk_mul_f32 v[154:155], v[38:39], v[38:39]
    v_pk_mul_f32 v[156:157], v[64:65], v[64:65]
    v_pk_mul_f32 v[158:159], v[66:67], v[66:67]
    v_pk_mul_f32 v[160:161], v[92:93], v[92:93]
    v_pk_mul_f32 v[162:163], v[94:95], v[94:95]
    v_pk_mul_f32 v[164:165], v[120:121], v[120:121]
    v_pk_mul_f32 v[166:167], v[122:123], v[122:123]
    v_pk_fma_f32 v[152:153], v[152:153], v[250:251], v[250:251] op_sel:[0,1,0] op_sel_hi:[1,1,0]
    v_pk_fma_f32 v[154:155], v[154:155], v[250:251], v[250:251] op_sel:[0,1,0] op_sel_hi:[1,1,0]
    v_pk_fma_f32 v[156:157], v[156:157], v[250:251], v[250:251] op_sel:[0,1,0] op_sel_hi:[1,1,0]
    v_pk_fma_f32 v[158:159], v[158:159], v[250:251], v[250:251] op_sel:[0,1,0] op_sel_hi:[1,1,0]
    v_pk_fma_f32 v[160:161], v[160:161], v[250:251], v[250:251] op_sel:[0,1,0] op_sel_hi:[1,1,0]
    v_pk_fma_f32 v[162:163], v[162:163], v[250:251], v[250:251] op_sel:[0,1,0] op_sel_hi:[1,1,0]
    v_pk_fma_f32 v[164:165], v[164:165], v[250:251], v[250:251] op_sel:[0,1,0] op_sel_hi:[1,1,0]
    v_pk_fma_f32 v[166:167], v[166:167], v[250:251], v[250:251] op_sel:[0,1,0] op_sel_hi:[1,1,0]
    v_pk_mul_f32 v[152:153], v[152:153], v[36:37]
    v_pk_mul_f32 v[154:155], v[154:155], v[38:39]
    v_pk_mul_f32 v[156:157], v[156:157], v[64:65]
    v_pk_mul_f32 v[158:159], v[158:159], v[66:67]
    v_pk_mul_f32 v[160:161], v[160:161], v[92:93]
    v_pk_mul_f32 v[162:163], v[162:163], v[94:95]
    v_pk_mul_f32 v[164:165], v[164:165], v[120:121]
    v_pk_mul_f32 v[166:167], v[166:167], v[122:123]
    v_exp_f32 v152, v152
    v_exp_f32 v153, v153
    v_exp_f32 v154, v154
    v_exp_f32 v155, v155
    v_exp_f32 v156, v156
    v_exp_f32 v157, v157
    v_exp_f32 v158, v158
    v_exp_f32 v159, v159
    v_exp_f32 v160, v160
    v_exp_f32 v161, v161
    v_exp_f32 v162, v162
    v_exp_f32 v163, v163
    v_exp_f32 v164, v164
    v_exp_f32 v165, v165
    v_exp_f32 v166, v166
    v_exp_f32 v167, v167
    v_pk_add_f32 v[152:153], v[152:153], v[248:249]
    v_pk_add_f32 v[154:155], v[154:155], v[248:249]
    v_pk_add_f32 v[156:157], v[156:157], v[248:249]
    v_pk_add_f32 v[158:159], v[158:159], v[248:249]
    v_pk_add_f32 v[160:161], v[160:161], v[248:249]
    v_pk_add_f32 v[162:163], v[162:163], v[248:249]
    v_pk_add_f32 v[164:165], v[164:165], v[248:249]
    v_pk_add_f32 v[166:167], v[166:167], v[248:249]
    v_rcp_f32 v152, v152
    v_rcp_f32 v153, v153
    v_rcp_f32 v154, v154
    v_rcp_f32 v155, v155
    v_rcp_f32 v156, v156
    v_rcp_f32 v157, v157
    v_rcp_f32 v158, v158
    v_rcp_f32 v159, v159
    v_rcp_f32 v160, v160
    v_rcp_f32 v161, v161
    v_rcp_f32 v162, v162
    v_rcp_f32 v163, v163
    v_rcp_f32 v164, v164
    v_rcp_f32 v165, v165
    v_rcp_f32 v166, v166
    v_rcp_f32 v167, v167
    v_pk_mul_f32 v[36:37], v[36:37], v[152:153]
    v_pk_mul_f32 v[38:39], v[38:39], v[154:155]
    v_pk_mul_f32 v[64:65], v[64:65], v[156:157]
    v_pk_mul_f32 v[66:67], v[66:67], v[158:159]
    v_pk_mul_f32 v[92:93], v[92:93], v[160:161]
    v_pk_mul_f32 v[94:95], v[94:95], v[162:163]
    v_pk_mul_f32 v[120:121], v[120:121], v[164:165]
    v_pk_mul_f32 v[122:123], v[122:123], v[166:167]
    v_cvt_pk_bf16_f32 v168, v36, v37
    v_cvt_pk_bf16_f32 v169, v38, v39
    v_cvt_pk_bf16_f32 v172, v64, v65
    v_cvt_pk_bf16_f32 v173, v66, v67
    v_cvt_pk_bf16_f32 v176, v92, v93
    v_cvt_pk_bf16_f32 v177, v94, v95
    v_cvt_pk_bf16_f32 v180, v120, v121
    v_cvt_pk_bf16_f32 v181, v122, v123
    ds_read_b128 v[136:139], v3 offset:0
    ds_read_b128 v[140:143], v3 offset:1024
    s_waitcnt lgkmcnt(2)
    v_pk_fma_f32 v[152:153], v[144:145], v[128:129], v[148:149] op_sel:[0,1,0] op_sel_hi:[1,1,1] neg_lo:[1,0,0] neg_hi:[1,0,0]
    v_pk_fma_f32 v[154:155], v[146:147], v[128:129], v[150:151] op_sel:[0,1,0] op_sel_hi:[1,1,1] neg_lo:[1,0,0] neg_hi:[1,0,0]
    v_pk_fma_f32 v[156:157], v[144:145], v[130:131], v[148:149] op_sel:[0,1,0] op_sel_hi:[1,1,1] neg_lo:[1,0,0] neg_hi:[1,0,0]
    v_pk_fma_f32 v[158:159], v[146:147], v[130:131], v[150:151] op_sel:[0,1,0] op_sel_hi:[1,1,1] neg_lo:[1,0,0] neg_hi:[1,0,0]
    v_pk_fma_f32 v[160:161], v[144:145], v[132:133], v[148:149] op_sel:[0,1,0] op_sel_hi:[1,1,1] neg_lo:[1,0,0] neg_hi:[1,0,0]
    v_pk_fma_f32 v[162:163], v[146:147], v[132:133], v[150:151] op_sel:[0,1,0] op_sel_hi:[1,1,1] neg_lo:[1,0,0] neg_hi:[1,0,0]
    v_pk_fma_f32 v[164:165], v[144:145], v[134:135], v[148:149] op_sel:[0,1,0] op_sel_hi:[1,1,1] neg_lo:[1,0,0] neg_hi:[1,0,0]
    v_pk_fma_f32 v[166:167], v[146:147], v[134:135], v[150:151] op_sel:[0,1,0] op_sel_hi:[1,1,1] neg_lo:[1,0,0] neg_hi:[1,0,0]
    v_pk_fma_f32 v[40:41], v[40:41], v[128:129], v[152:153] op_sel_hi:[1,0,1]
    v_pk_fma_f32 v[42:43], v[42:43], v[128:129], v[154:155] op_sel_hi:[1,0,1]
    v_pk_fma_f32 v[68:69], v[68:69], v[130:131], v[156:157] op_sel_hi:[1,0,1]
    v_pk_fma_f32 v[70:71], v[70:71], v[130:131], v[158:159] op_sel_hi:[1,0,1]
    v_pk_fma_f32 v[96:97], v[96:97], v[132:133], v[160:161] op_sel_hi:[1,0,1]
    v_pk_fma_f32 v[98:99], v[98:99], v[132:133], v[162:163] op_sel_hi:[1,0,1]
    v_pk_fma_f32 v[124:125], v[124:125], v[134:135], v[164:165] op_sel_hi:[1,0,1]
    v_pk_fma_f32 v[126:127], v[126:127], v[134:135], v[166:167] op_sel_hi:[1,0,1]
    v_pk_mul_f32 v[152:153], v[40:41], v[40:41]
    v_pk_mul_f32 v[154:155], v[42:43], v[42:43]
    v_pk_mul_f32 v[156:157], v[68:69], v[68:69]
    v_pk_mul_f32 v[158:159], v[70:71], v[70:71]
    v_pk_mul_f32 v[160:161], v[96:97], v[96:97]
    v_pk_mul_f32 v[162:163], v[98:99], v[98:99]
    v_pk_mul_f32 v[164:165], v[124:125], v[124:125]
    v_pk_mul_f32 v[166:167], v[126:127], v[126:127]
    v_pk_fma_f32 v[152:153], v[152:153], v[250:251], v[250:251] op_sel:[0,1,0] op_sel_hi:[1,1,0]
    v_pk_fma_f32 v[154:155], v[154:155], v[250:251], v[250:251] op_sel:[0,1,0] op_sel_hi:[1,1,0]
    v_pk_fma_f32 v[156:157], v[156:157], v[250:251], v[250:251] op_sel:[0,1,0] op_sel_hi:[1,1,0]
    v_pk_fma_f32 v[158:159], v[158:159], v[250:251], v[250:251] op_sel:[0,1,0] op_sel_hi:[1,1,0]
    v_pk_fma_f32 v[160:161], v[160:161], v[250:251], v[250:251] op_sel:[0,1,0] op_sel_hi:[1,1,0]
    v_pk_fma_f32 v[162:163], v[162:163], v[250:251], v[250:251] op_sel:[0,1,0] op_sel_hi:[1,1,0]
    v_pk_fma_f32 v[164:165], v[164:165], v[250:251], v[250:251] op_sel:[0,1,0] op_sel_hi:[1,1,0]
    v_pk_fma_f32 v[166:167], v[166:167], v[250:251], v[250:251] op_sel:[0,1,0] op_sel_hi:[1,1,0]
    v_pk_mul_f32 v[152:153], v[152:153], v[40:41]
    v_pk_mul_f32 v[154:155], v[154:155], v[42:43]
    v_pk_mul_f32 v[156:157], v[156:157], v[68:69]
    v_pk_mul_f32 v[158:159], v[158:159], v[70:71]
    v_pk_mul_f32 v[160:161], v[160:161], v[96:97]
    v_pk_mul_f32 v[162:163], v[162:163], v[98:99]
    v_pk_mul_f32 v[164:165], v[164:165], v[124:125]
    v_pk_mul_f32 v[166:167], v[166:167], v[126:127]
    v_exp_f32 v152, v152
    v_exp_f32 v153, v153
    v_exp_f32 v154, v154
    v_exp_f32 v155, v155
    v_exp_f32 v156, v156
    v_exp_f32 v157, v157
    v_exp_f32 v158, v158
    v_exp_f32 v159, v159
    v_exp_f32 v160, v160
    v_exp_f32 v161, v161
    v_exp_f32 v162, v162
    v_exp_f32 v163, v163
    v_exp_f32 v164, v164
    v_exp_f32 v165, v165
    v_exp_f32 v166, v166
    v_exp_f32 v167, v167
    v_pk_add_f32 v[152:153], v[152:153], v[248:249]
    v_pk_add_f32 v[154:155], v[154:155], v[248:249]
    v_pk_add_f32 v[156:157], v[156:157], v[248:249]
    v_pk_add_f32 v[158:159], v[158:159], v[248:249]
    v_pk_add_f32 v[160:161], v[160:161], v[248:249]
    v_pk_add_f32 v[162:163], v[162:163], v[248:249]
    v_pk_add_f32 v[164:165], v[164:165], v[248:249]
    v_pk_add_f32 v[166:167], v[166:167], v[248:249]
    v_rcp_f32 v152, v152
    v_rcp_f32 v153, v153
    v_rcp_f32 v154, v154
    v_rcp_f32 v155, v155
    v_rcp_f32 v156, v156
    v_rcp_f32 v157, v157
    v_rcp_f32 v158, v158
    v_rcp_f32 v159, v159
    v_rcp_f32 v160, v160
    v_rcp_f32 v161, v161
    v_rcp_f32 v162, v162
    v_rcp_f32 v163, v163
    v_rcp_f32 v164, v164
    v_rcp_f32 v165, v165
    v_rcp_f32 v166, v166
    v_rcp_f32 v167, v167
    v_pk_mul_f32 v[40:41], v[40:41], v[152:153]
    v_pk_mul_f32 v[42:43], v[42:43], v[154:155]
    v_pk_mul_f32 v[68:69], v[68:69], v[156:157]
    v_pk_mul_f32 v[70:71], v[70:71], v[158:159]
    v_pk_mul_f32 v[96:97], v[96:97], v[160:161]
    v_pk_mul_f32 v[98:99], v[98:99], v[162:163]
    v_pk_mul_f32 v[124:125], v[124:125], v[164:165]
    v_pk_mul_f32 v[126:127], v[126:127], v[166:167]
    v_cvt_pk_bf16_f32 v170, v40, v41
    v_cvt_pk_bf16_f32 v171, v42, v43
    v_cvt_pk_bf16_f32 v174, v68, v69
    v_cvt_pk_bf16_f32 v175, v70, v71
    v_cvt_pk_bf16_f32 v178, v96, v97
    v_cvt_pk_bf16_f32 v179, v98, v99
    v_cvt_pk_bf16_f32 v182, v124, v125
    v_cvt_pk_bf16_f32 v183, v126, v127
    ds_write_b128 v8, v[168:171] offset:2048
    ds_write_b128 v8, v[172:175] offset:3072
    ds_write_b128 v8, v[176:179] offset:6144
    ds_write_b128 v8, v[180:183] offset:7168
    s_waitcnt lgkmcnt(0)
    v_pk_fma_f32 v[152:153], v[136:137], v[128:129], v[140:141] op_sel:[0,1,0] op_sel_hi:[1,1,1] neg_lo:[1,0,0] neg_hi:[1,0,0]
    v_pk_fma_f32 v[154:155], v[138:139], v[128:129], v[142:143] op_sel:[0,1,0] op_sel_hi:[1,1,1] neg_lo:[1,0,0] neg_hi:[1,0,0]
    v_pk_fma_f32 v[156:157], v[136:137], v[130:131], v[140:141] op_sel:[0,1,0] op_sel_hi:[1,1,1] neg_lo:[1,0,0] neg_hi:[1,0,0]
    v_pk_fma_f32 v[158:159], v[138:139], v[130:131], v[142:143] op_sel:[0,1,0] op_sel_hi:[1,1,1] neg_lo:[1,0,0] neg_hi:[1,0,0]
    v_pk_fma_f32 v[160:161], v[136:137], v[132:133], v[140:141] op_sel:[0,1,0] op_sel_hi:[1,1,1] neg_lo:[1,0,0] neg_hi:[1,0,0]
    v_pk_fma_f32 v[162:163], v[138:139], v[132:133], v[142:143] op_sel:[0,1,0] op_sel_hi:[1,1,1] neg_lo:[1,0,0] neg_hi:[1,0,0]
    v_pk_fma_f32 v[164:165], v[136:137], v[134:135], v[140:141] op_sel:[0,1,0] op_sel_hi:[1,1,1] neg_lo:[1,0,0] neg_hi:[1,0,0]
    v_pk_fma_f32 v[166:167], v[138:139], v[134:135], v[142:143] op_sel:[0,1,0] op_sel_hi:[1,1,1] neg_lo:[1,0,0] neg_hi:[1,0,0]
    v_pk_fma_f32 v[16:17], v[16:17], v[128:129], v[152:153] op_sel_hi:[1,0,1]
    v_pk_fma_f32 v[18:19], v[18:19], v[128:129], v[154:155] op_sel_hi:[1,0,1]
    v_pk_fma_f32 v[44:45], v[44:45], v[130:131], v[156:157] op_sel_hi:[1,0,1]
    v_pk_fma_f32 v[46:47], v[46:47], v[130:131], v[158:159] op_sel_hi:[1,0,1]
    v_pk_fma_f32 v[72:73], v[72:73], v[132:133], v[160:161] op_sel_hi:[1,0,1]
    v_pk_fma_f32 v[74:75], v[74:75], v[132:133], v[162:163] op_sel_hi:[1,0,1]
    v_pk_fma_f32 v[100:101], v[100:101], v[134:135], v[164:165] op_sel_hi:[1,0,1]
    v_pk_fma_f32 v[102:103], v[102:103], v[134:135], v[166:167] op_sel_hi:[1,0,1]
    v_pk_mul_f32 v[152:153], v[16:17], v[16:17]
    v_pk_mul_f32 v[154:155], v[18:19], v[18:19]
    v_pk_mul_f32 v[156:157], v[44:45], v[44:45]
    v_pk_mul_f32 v[158:159], v[46:47], v[46:47]
    v_pk_mul_f32 v[160:161], v[72:73], v[72:73]
    v_pk_mul_f32 v[162:163], v[74:75], v[74:75]
    v_pk_mul_f32 v[164:165], v[100:101], v[100:101]
    v_pk_mul_f32 v[166:167], v[102:103], v[102:103]
    v_pk_fma_f32 v[152:153], v[152:153], v[250:251], v[250:251] op_sel:[0,1,0] op_sel_hi:[1,1,0]
    v_pk_fma_f32 v[154:155], v[154:155], v[250:251], v[250:251] op_sel:[0,1,0] op_sel_hi:[1,1,0]
    v_pk_fma_f32 v[156:157], v[156:157], v[250:251], v[250:251] op_sel:[0,1,0] op_sel_hi:[1,1,0]
    v_pk_fma_f32 v[158:159], v[158:159], v[250:251], v[250:251] op_sel:[0,1,0] op_sel_hi:[1,1,0]
    v_pk_fma_f32 v[160:161], v[160:161], v[250:251], v[250:251] op_sel:[0,1,0] op_sel_hi:[1,1,0]
    v_pk_fma_f32 v[162:163], v[162:163], v[250:251], v[250:251] op_sel:[0,1,0] op_sel_hi:[1,1,0]
    v_pk_fma_f32 v[164:165], v[164:165], v[250:251], v[250:251] op_sel:[0,1,0] op_sel_hi:[1,1,0]
    v_pk_fma_f32 v[166:167], v[166:167], v[250:251], v[250:251] op_sel:[0,1,0] op_sel_hi:[1,1,0]
    v_pk_mul_f32 v[152:153], v[152:153], v[16:17]
    v_pk_mul_f32 v[154:155], v[154:155], v[18:19]
    v_pk_mul_f32 v[156:157], v[156:157], v[44:45]
    v_pk_mul_f32 v[158:159], v[158:159], v[46:47]
    v_pk_mul_f32 v[160:161], v[160:161], v[72:73]
    v_pk_mul_f32 v[162:163], v[162:163], v[74:75]
    v_pk_mul_f32 v[164:165], v[164:165], v[100:101]
    v_pk_mul_f32 v[166:167], v[166:167], v[102:103]
    v_exp_f32 v152, v152
    v_exp_f32 v153, v153
    v_exp_f32 v154, v154
    v_exp_f32 v155, v155
    v_exp_f32 v156, v156
    v_exp_f32 v157, v157
    v_exp_f32 v158, v158
    v_exp_f32 v159, v159
    v_exp_f32 v160, v160
    v_exp_f32 v161, v161
    v_exp_f32 v162, v162
    v_exp_f32 v163, v163
    v_exp_f32 v164, v164
    v_exp_f32 v165, v165
    v_exp_f32 v166, v166
    v_exp_f32 v167, v167
    v_pk_add_f32 v[152:153], v[152:153], v[248:249]
    v_pk_add_f32 v[154:155], v[154:155], v[248:249]
    v_pk_add_f32 v[156:157], v[156:157], v[248:249]
    v_pk_add_f32 v[158:159], v[158:159], v[248:249]
    v_pk_add_f32 v[160:161], v[160:161], v[248:249]
    v_pk_add_f32 v[162:163], v[162:163], v[248:249]
    v_pk_add_f32 v[164:165], v[164:165], v[248:249]
    v_pk_add_f32 v[166:167], v[166:167], v[248:249]
    v_rcp_f32 v152, v152
    v_rcp_f32 v153, v153
    v_rcp_f32 v154, v154
    v_rcp_f32 v155, v155
    v_rcp_f32 v156, v156
    v_rcp_f32 v157, v157
    v_rcp_f32 v158, v158
    v_rcp_f32 v159, v159
    v_rcp_f32 v160, v160
    v_rcp_f32 v161, v161
    v_rcp_f32 v162, v162
    v_rcp_f32 v163, v163
    v_rcp_f32 v164, v164
    v_rcp_f32 v165, v165
    v_rcp_f32 v166, v166
    v_rcp_f32 v167, v167
    v_pk_mul_f32 v[16:17], v[16:17], v[152:153]
    v_pk_mul_f32 v[18:19], v[18:19], v[154:155]
    v_pk_mul_f32 v[44:45], v[44:45], v[156:157]
    v_pk_mul_f32 v[46:47], v[46:47], v[158:159]
    v_pk_mul_f32 v[72:73], v[72:73], v[160:161]
    v_pk_mul_f32 v[74:75], v[74:75], v[162:163]
    v_pk_mul_f32 v[100:101], v[100:101], v[164:165]
    v_pk_mul_f32 v[102:103], v[102:103], v[166:167]
    v_cvt_pk_bf16_f32 v186, v16, v17
    v_cvt_pk_bf16_f32 v187, v18, v19
    v_cvt_pk_bf16_f32 v190, v44, v45
    v_cvt_pk_bf16_f32 v191, v46, v47
    v_cvt_pk_bf16_f32 v194, v72, v73
    v_cvt_pk_bf16_f32 v195, v74, v75
    v_cvt_pk_bf16_f32 v198, v100, v101
    v_cvt_pk_bf16_f32 v199, v102, v103
    v_mov_b32 v13, 156692
    v_mov_b32 v11, 1
    s_waitcnt vmcnt(0)
    s_mov_b64 exec, 1
    ds_add_rtn_u32 v11, v13, v11
    s_waitcnt lgkmcnt(0)
    v_cmp_eq_u32 vcc, 3, v11
    s_nop 1
    s_cbranch_vccz mlp1_fg1
    buffer_store_dword v12, off, s[16:19], s92 sc1
mlp1_fg1:
    s_mov_b64 exec, -1
    ds_write_b64 v8, v[186:187] offset:32776
    ds_write_b64 v8, v[190:191] offset:33800
    ds_write_b64 v8, v[194:195] offset:36872
    ds_write_b64 v8, v[198:199] offset:37896
mlp1_e2:
    s_mov_b32 s29, s54
    s_lshr_b32 s38, s3, 1
    s_and_b32 s39, s3, 1
    v_lshrrev_b32 v14, 4, v1
    v_and_b32 v15, 15, v1
    s_mul_i32 s34, s38, 8192
    v_lshl_add_u32 v2, v1, 4, s34
    s_mul_i32 s34, s39, 4096
    s_add_u32 s34, s34, 16384
    v_lshl_add_u32 v6, v1, 4, s34
    s_waitcnt lgkmcnt(0)
    v_mov_b32 v16, 0
    v_mov_b32 v17, 0
    v_mov_b32 v18, 0
    v_mov_b32 v19, 0
    v_mov_b32 v20, 0
    v_mov_b32 v21, 0
    v_mov_b32 v22, 0
    v_mov_b32 v23, 0
    v_mov_b32 v24, 0
    v_mov_b32 v25, 0
    v_mov_b32 v26, 0
    v_mov_b32 v27, 0
    v_mov_b32 v28, 0
    v_mov_b32 v29, 0
    v_mov_b32 v30, 0
    v_mov_b32 v31, 0
    v_mov_b32 v32, 0
    v_mov_b32 v33, 0
    v_mov_b32 v34, 0
    v_mov_b32 v35, 0
    v_mov_b32 v36, 0
    v_mov_b32 v37, 0
    v_mov_b32 v38, 0
    v_mov_b32 v39, 0
    v_mov_b32 v40, 0
    v_mov_b32 v41, 0
    v_mov_b32 v42, 0
    v_mov_b32 v43, 0
    v_mov_b32 v44, 0
    v_mov_b32 v45, 0
    v_mov_b32 v46, 0
    v_mov_b32 v47, 0
    v_mov_b32 v48, 0
    v_mov_b32 v49, 0
    v_mov_b32 v50, 0
    v_mov_b32 v51, 0
    v_mov_b32 v52, 0
    v_mov_b32 v53, 0
    v_mov_b32 v54, 0
    v_mov_b32 v55, 0
    v_mov_b32 v56, 0
    v_mov_b32 v57, 0
    v_mov_b32 v58, 0
    v_mov_b32 v59, 0
    v_mov_b32 v60, 0
    v_mov_b32 v61, 0
    v_mov_b32 v62, 0
    v_mov_b32 v63, 0
    v_mov_b32 v64, 0
    v_mov_b32 v65, 0
    v_mov_b32 v66, 0
    v_mov_b32 v67, 0
    v_mov_b32 v68, 0
    v_mov_b32 v69, 0
    v_mov_b32 v70, 0
    v_mov_b32 v71, 0
    v_mov_b32 v72, 0
    v_mov_b32 v73, 0
    v_mov_b32 v74, 0
    v_mov_b32 v75, 0
    v_mov_b32 v76, 0
    v_mov_b32 v77, 0
    v_mov_b32 v78, 0
    v_mov_b32 v79, 0
    s_mov_b32 s31, 0
    v_add_u32 v4, s31, v2
    v_add_u32 v10, s31, v6
    s_add_u32 s31, s31, 32768
    s_cmp_eq_u32 s31, 98304
    s_cselect_b32 s31, 0, s31
    s_barrier
    s_lshl_b32 s92, s28, 1
    s_add_u32 s92, s92, s55
    s_lshl_b32 s92, s92, 3
    s_add_u32 s92, s92, s29
    s_lshl_b32 s92, s92, 2
    s_add_u32 s92, s92, 0
    s_lshl_b32 s92, s92, 5
    s_add_u32 s92, s92, 39845888
    s_add_u32 s93, s92, 65536
    v_mov_b32 v12, 1
    ds_read_b128 v[112:115], v10 offset:0
    ds_read_b128 v[80:83], v4 offset:0
    ds_read_b128 v[88:91], v4 offset:1024
    ds_read_b128 v[96:99], v4 offset:4096
    ds_read_b128 v[104:107], v4 offset:5120
    ds_read_b128 v[120:123], v10 offset:1024
    ds_read_b128 v[128:131], v10 offset:2048
    ds_read_b128 v[136:139], v10 offset:3072
    s_mov_b32 s30, 0
    s_mov_b32 s53, 28
.p2align 6
mlp2_cloop:
    s_waitcnt lgkmcnt(6)
    v_mfma_f32_16x16x32_bf16 v[16:19], v[112:115], v[80:83], v[16:19]
    ds_read_b128 v[116:119], v10 offset:8192
    s_waitcnt lgkmcnt(6)
    v_mfma_f32_16x16x32_bf16 v[32:35], v[112:115], v[88:91], v[32:35]
    ds_read_b128 v[84:87], v4 offset:2048
    s_waitcnt lgkmcnt(6)
    v_mfma_f32_16x16x32_bf16 v[48:51], v[112:115], v[96:99], v[48:51]
    ds_read_b128 v[92:95], v4 offset:3072
    s_waitcnt lgkmcnt(6)
    v_mfma_f32_16x16x32_bf16 v[64:67], v[112:115], v[104:107], v[64:67]
    ds_read_b128 v[100:103], v4 offset:6144
    s_waitcnt lgkmcnt(6)
    v_mfma_f32_16x16x32_bf16 v[20:23], v[120:123], v[80:83], v[20:23]
    ds_read_b128 v[108:111], v4 offset:7168
    v_mfma_f32_16x16x32_bf16 v[36:39], v[120:123], v[88:91], v[36:39]
    ds_read_b128 v[124:127], v10 offset:9216
    v_mfma_f32_16x16x32_bf16 v[52:55], v[120:123], v[96:99], v[52:55]
    ds_read_b128 v[132:135], v10 offset:10240
    v_mfma_f32_16x16x32_bf16 v[68:71], v[120:123], v[104:107], v[68:71]
    ds_read_b128 v[140:143], v10 offset:11264
    s_waitcnt lgkmcnt(9)
    v_mfma_f32_16x16x32_bf16 v[24:27], v[128:131], v[80:83], v[24:27]
    v_mfma_f32_16x16x32_bf16 v[40:43], v[128:131], v[88:91], v[40:43]
    v_mfma_f32_16x16x32_bf16 v[56:59], v[128:131], v[96:99], v[56:59]
    v_mfma_f32_16x16x32_bf16 v[72:75], v[128:131], v[104:107], v[72:75]
    s_waitcnt lgkmcnt(8)
    v_mfma_f32_16x16x32_bf16 v[28:31], v[136:139], v[80:83], v[28:31]
    v_mfma_f32_16x16x32_bf16 v[44:47], v[136:139], v[88:91], v[44:47]
    v_mfma_f32_16x16x32_bf16 v[60:63], v[136:139], v[96:99], v[60:63]
    v_mfma_f32_16x16x32_bf16 v[76:79], v[136:139], v[104:107], v[76:79]
    s_waitcnt lgkmcnt(0)
    v_mfma_f32_16x16x32_bf16 v[16:19], v[116:119], v[84:87], v[16:19]
    v_add_u32 v4, s31, v2
    v_mfma_f32_16x16x32_bf16 v[32:35], v[116:119], v[92:95], v[32:35]
    v_add_u32 v10, s31, v6
    s_barrier
    v_mfma_f32_16x16x32_bf16 v[48:51], v[116:119], v[100:103], v[48:51]
    ds_read_b128 v[112:115], v10 offset:0
    v_mfma_f32_16x16x32_bf16 v[64:67], v[116:119], v[108:111], v[64:67]
    ds_read_b128 v[80:83], v4 offset:0
    v_mfma_f32_16x16x32_bf16 v[20:23], v[124:127], v[84:87], v[20:23]
    ds_read_b128 v[88:91], v4 offset:1024
    v_mfma_f32_16x16x32_bf16 v[36:39], v[124:127], v[92:95], v[36:39]
    ds_read_b128 v[96:99], v4 offset:4096
    v_mfma_f32_16x16x32_bf16 v[52:55], v[124:127], v[100:103], v[52:55]
    ds_read_b128 v[104:107], v4 offset:5120
    v_mfma_f32_16x16x32_bf16 v[68:71], v[124:127], v[108:111], v[68:71]
    ds_read_b128 v[120:123], v10 offset:1024
    v_mfma_f32_16x16x32_bf16 v[24:27], v[132:135], v[84:87], v[24:27]
    ds_read_b128 v[128:131], v10 offset:2048
    v_mfma_f32_16x16x32_bf16 v[40:43], v[132:135], v[92:95], v[40:43]
    ds_read_b128 v[136:139], v10 offset:3072
    v_mfma_f32_16x16x32_bf16 v[56:59], v[132:135], v[100:103], v[56:59]
    s_add_u32 s31, s31, 32768
    s_cmp_eq_u32 s31, 98304
    v_mfma_f32_16x16x32_bf16 v[72:75], v[132:135], v[108:111], v[72:75]
    s_cselect_b32 s31, 0, s31
    v_mfma_f32_16x16x32_bf16 v[28:31], v[140:143], v[84:87], v[28:31]
    v_mfma_f32_16x16x32_bf16 v[44:47], v[140:143], v[92:95], v[44:47]
    v_mfma_f32_16x16x32_bf16 v[60:63], v[140:143], v[100:103], v[60:63]
    s_add_u32 s30, s30, 1
    s_cmp_lt_u32 s30, s53
    v_mfma_f32_16x16x32_bf16 v[76:79], v[140:143], v[108:111], v[76:79]
    s_cbranch_scc1 mlp2_cloop
    s_waitcnt lgkmcnt(0)
    s_nop 7
    s_lshl_b32 s34, s3, 12
    s_add_u32 s34, s34, 114688
    v_lshl_add_u32 v8, v1, 4, s34
    s_lshl_b32 s34, s39, 7
    s_add_u32 s34, s34, 131072
    v_lshl_add_u32 v9, v14, 3, s34
    ds_read_b128 v[224:227], v8 offset:0
    ds_read_b128 v[228:231], v8 offset:2048
    ds_read_b128 v[232:235], v8 offset:1024
    ds_read_b128 v[236:239], v8 offset:3072
    ds_read_b64 v[240:241], v9 offset:0
    ds_read_b64 v[242:243], v9 offset:32
    ds_read_b64 v[244:245], v9 offset:64
    ds_read_b64 v[246:247], v9 offset:96
    s_lshl_b32 s34, s28, 3
    s_add_u32 s34, s34, s29
    s_lshl_b32 s34, s34, 1
    s_add_u32 s34, s34, s55
    s_lshl_b32 s34, s34, 2
    s_add_u32 s34, s34, s3
    s_lshl_b32 s34, s34, 12
    s_add_u32 s42, s34, 67108864
    s_xor_b32 s43, s42, 16384
    v_lshlrev_b32 v13, 4, v1
    s_cmp_eq_u32 s55, 0
    s_cbranch_scc1 mlp2_k0
    v_cvt_pk_bf16_f32 v160, v16, v17
    v_cvt_pk_bf16_f32 v161, v18, v19
    v_cvt_pk_bf16_f32 v162, v20, v21
    v_cvt_pk_bf16_f32 v163, v22, v23
    buffer_store_dwordx4 v[160:163], v13, s[16:19], s43 offen offset:0 sc1
    v_cvt_pk_bf16_f32 v164, v24, v25
    v_cvt_pk_bf16_f32 v165, v26, v27
    v_cvt_pk_bf16_f32 v166, v28, v29
    v_cvt_pk_bf16_f32 v167, v30, v31
    buffer_store_dwordx4 v[164:167], v13, s[16:19], s43 offen offset:1024 sc1
    v_cvt_pk_bf16_f32 v168, v32, v33
    v_cvt_pk_bf16_f32 v169, v34, v35
    v_cvt_pk_bf16_f32 v170, v36, v37
    v_cvt_pk_bf16_f32 v171, v38, v39
    buffer_store_dwordx4 v[168:171], v13, s[16:19], s43 offen offset:2048 sc1
    v_cvt_pk_bf16_f32 v172, v40, v41
    v_cvt_pk_bf16_f32 v173, v42, v43
    v_cvt_pk_bf16_f32 v174, v44, v45
    v_cvt_pk_bf16_f32 v175, v46, v47
    buffer_store_dwordx4 v[172:175], v13, s[16:19], s43 offen offset:3072 sc1
    v_mov_b32 v16, v48
    v_mov_b32 v17, v49
    v_mov_b32 v18, v50
    v_mov_b32 v19, v51
    v_mov_b32 v20, v52
    v_mov_b32 v21, v53
    v_mov_b32 v22, v54
    v_mov_b32 v23, v55
    v_mov_b32 v24, v56
    v_mov_b32 v25, v57
    v_mov_b32 v26, v58
    v_mov_b32 v27, v59
    v_mov_b32 v28, v60
    v_mov_b32 v29, v61
    v_mov_b32 v30, v62
    v_mov_b32 v31, v63
    v_mov_b32 v32, v64
    v_mov_b32 v33, v65
    v_mov_b32 v34, v66
    v_mov_b32 v35, v67
    v_mov_b32 v36, v68
    v_mov_b32 v37, v69
    v_mov_b32 v38, v70
    v_mov_b32 v39, v71
    v_mov_b32 v40, v72
    v_mov_b32 v41, v73
    v_mov_b32 v42, v74
    v_mov_b32 v43, v75
    v_mov_b32 v44, v76
    v_mov_b32 v45, v77
    v_mov_b32 v46, v78
    v_mov_b32 v47, v79
    s_branch mlp2_k1
mlp2_k0:
    v_cvt_pk_bf16_f32 v160, v48, v49
    v_cvt_pk_bf16_f32 v161, v50, v51
    v_cvt_pk_bf16_f32 v162, v52, v53
    v_cvt_pk_bf16_f32 v163, v54, v55
    buffer_store_dwordx4 v[160:163], v13, s[16:19], s43 offen offset:0 sc1
    v_cvt_pk_bf16_f32 v164, v56, v57
    v_cvt_pk_bf16_f32 v165, v58, v59
    v_cvt_pk_bf16_f32 v166, v60, v61
    v_cvt_pk_bf16_f32 v167, v62, v63
    buffer_store_dwordx4 v[164:167], v13, s[16:19], s43 offen offset:1024 sc1
    v_cvt_pk_bf16_f32 v168, v64, v65
    v_cvt_pk_bf16_f32 v169, v66, v67
    v_cvt_pk_bf16_f32 v170, v68, v69
    v_cvt_pk_bf16_f32 v171, v70, v71
    buffer_store_dwordx4 v[168:171], v13, s[16:19], s43 offen offset:2048 sc1
    v_cvt_pk_bf16_f32 v172, v72, v73
    v_cvt_pk_bf16_f32 v173, v74, v75
    v_cvt_pk_bf16_f32 v174, v76, v77
    v_cvt_pk_bf16_f32 v175, v78, v79
    buffer_store_dwordx4 v[172:175], v13, s[16:19], s43 offen offset:3072 sc1
mlp2_k1:
    s_lshl_b32 s34, s28, 7
    s_lshl_b32 s35, s38, 6
    s_add_u32 s34, s34, s35
    s_lshl_b32 s35, s55, 5
    s_add_u32 s34, s34, s35
    v_add_u32 v6, s34, v15
    v_lshlrev_b32 v6, 11, v6
    v_and_b32 v7, 1, v14
    v_lshl_add_u32 v6, v7, 5, v6
    v_lshrrev_b32 v7, 1, v14
    v_lshl_add_u32 v6, v7, 4, v6
    s_lshl_b32 s40, s29, 8
    s_lshl_b32 s35, s39, 7
    s_add_u32 s40, s40, s35
    s_add_u32 s41, s40, 32768
    s_waitcnt lgkmcnt(0)
    v_lshlrev_b32 v112, 16, v240
    v_and_b32 v113, 0xffff0000, v240
    v_lshlrev_b32 v114, 16, v241
    v_and_b32 v115, 0xffff0000, v241
    v_lshlrev_b32 v116, 16, v242
    v_and_b32 v117, 0xffff0000, v242
    v_lshlrev_b32 v118, 16, v243
    v_and_b32 v119, 0xffff0000, v243
    v_lshlrev_b32 v120, 16, v244
    v_and_b32 v121, 0xffff0000, v244
    v_lshlrev_b32 v122, 16, v245
    v_and_b32 v123, 0xffff0000, v245
    v_lshlrev_b32 v124, 16, v246
    v_and_b32 v125, 0xffff0000, v246
    v_lshlrev_b32 v126, 16, v247
    v_and_b32 v127, 0xffff0000, v247
    v_lshlrev_b32 v96, 16, v224
    v_and_b32 v97, 0xffff0000, v224
    v_lshlrev_b32 v98, 16, v225
    v_and_b32 v99, 0xffff0000, v225
    v_lshlrev_b32 v100, 16, v226
    v_and_b32 v101, 0xffff0000, v226
    v_lshlrev_b32 v102, 16, v227
    v_and_b32 v103, 0xffff0000, v227
    v_lshlrev_b32 v104, 16, v228
    v_and_b32 v105, 0xffff0000, v228
    v_lshlrev_b32 v106, 16, v229
    v_and_b32 v107, 0xffff0000, v229
    v_lshlrev_b32 v108, 16, v230
    v_and_b32 v109, 0xffff0000, v230
    v_lshlrev_b32 v110, 16, v231
    v_and_b32 v111, 0xffff0000, v231
    v_pk_add_f32 v[16:17], v[16:17], v[112:113]
    v_pk_add_f32 v[18:19], v[18:19], v[114:115]
    v_pk_add_f32 v[20:21], v[20:21], v[116:117]
    v_pk_add_f32 v[22:23], v[22:23], v[118:119]
    v_pk_add_f32 v[24:25], v[24:25], v[120:121]
    v_pk_add_f32 v[26:27], v[26:27], v[122:123]
    v_pk_add_f32 v[28:29], v[28:29], v[124:125]
    v_pk_add_f32 v[30:31], v[30:31], v[126:127]
    v_pk_add_f32 v[16:17], v[16:17], v[96:97]
    v_pk_add_f32 v[18:19], v[18:19], v[98:99]
    v_pk_add_f32 v[20:21], v[20:21], v[100:101]
    v_pk_add_f32 v[22:23], v[22:23], v[102:103]
    v_pk_add_f32 v[24:25], v[24:25], v[104:105]
    v_pk_add_f32 v[26:27], v[26:27], v[106:107]
    v_pk_add_f32 v[28:29], v[28:29], v[108:109]
    v_pk_add_f32 v[30:31], v[30:31], v[110:111]
    v_lshlrev_b32 v96, 16, v232
    v_and_b32 v97, 0xffff0000, v232
    v_lshlrev_b32 v98, 16, v233
    v_and_b32 v99, 0xffff0000, v233
    v_lshlrev_b32 v100, 16, v234
    v_and_b32 v101, 0xffff0000, v234
    v_lshlrev_b32 v102, 16, v235
    v_and_b32 v103, 0xffff0000, v235
    v_lshlrev_b32 v104, 16, v236
    v_and_b32 v105, 0xffff0000, v236
    v_lshlrev_b32 v106, 16, v237
    v_and_b32 v107, 0xffff0000, v237
    v_lshlrev_b32 v108, 16, v238
    v_and_b32 v109, 0xffff0000, v238
    v_lshlrev_b32 v110, 16, v239
    v_and_b32 v111, 0xffff0000, v239
    v_pk_add_f32 v[32:33], v[32:33], v[112:113]
    v_pk_add_f32 v[34:35], v[34:35], v[114:115]
    v_pk_add_f32 v[36:37], v[36:37], v[116:117]
    v_pk_add_f32 v[38:39], v[38:39], v[118:119]
    v_pk_add_f32 v[40:41], v[40:41], v[120:121]
    v_pk_add_f32 v[42:43], v[42:43], v[122:123]
    v_pk_add_f32 v[44:45], v[44:45], v[124:125]
    v_pk_add_f32 v[46:47], v[46:47], v[126:127]
    v_pk_add_f32 v[32:33], v[32:33], v[96:97]
    v_pk_add_f32 v[34:35], v[34:35], v[98:99]
    v_pk_add_f32 v[36:37], v[36:37], v[100:101]
    v_pk_add_f32 v[38:39], v[38:39], v[102:103]
    v_pk_add_f32 v[40:41], v[40:41], v[104:105]
    v_pk_add_f32 v[42:43], v[42:43], v[106:107]
    v_pk_add_f32 v[44:45], v[44:45], v[108:109]
    v_pk_add_f32 v[46:47], v[46:47], v[110:111]
    s_waitcnt vmcnt(0)
    s_mov_b32 s30, 0
mlp2_rx:
    buffer_load_dwordx4 v[176:179], v13, s[16:19], s42 offen offset:0 sc1
    buffer_load_dwordx4 v[180:183], v13, s[16:19], s42 offen offset:1024 sc1
    buffer_load_dwordx4 v[184:187], v13, s[16:19], s42 offen offset:2048 sc1
    buffer_load_dwordx4 v[188:191], v13, s[16:19], s42 offen offset:3072 sc1
mlp2_rx1:
    s_add_u32 s30, s30, 1
    s_waitcnt vmcnt(0)
    v_max3_u32 v4, v176, v177, v178
    v_max3_u32 v5, v179, v180, v181
    v_max3_u32 v5, v5, v182, v183
    v_max3_u32 v4, v4, v184, v185
    v_max3_u32 v5, v5, v186, v187
    v_max3_u32 v4, v4, v188, v189
    v_max3_u32 v5, v5, v190, v191
    v_max_u32 v4, v4, v5
    v_cmp_eq_u32 vcc, -1, v4
    s_cmp_gt_u32 s30, 0x100000
    s_cbranch_scc1 mlp2_rxd
    s_cbranch_vccnz mlp2_rx
mlp2_rxd:
    v_lshlrev_b32 v80, 16, v176
    v_and_b32 v81, 0xffff0000, v176
    v_lshlrev_b32 v82, 16, v177
    v_and_b32 v83, 0xffff0000, v177
    v_lshlrev_b32 v84, 16, v178
    v_and_b32 v85, 0xffff0000, v178
    v_lshlrev_b32 v86, 16, v179
    v_and_b32 v87, 0xffff0000, v179
    v_lshlrev_b32 v88, 16, v180
    v_and_b32 v89, 0xffff0000, v180
    v_lshlrev_b32 v90, 16, v181
    v_and_b32 v91, 0xffff0000, v181
    v_lshlrev_b32 v92, 16, v182
    v_and_b32 v93, 0xffff0000, v182
    v_lshlrev_b32 v94, 16, v183
    v_and_b32 v95, 0xffff0000, v183
    v_lshlrev_b32 v96, 16, v184
    v_and_b32 v97, 0xffff0000, v184
    v_lshlrev_b32 v98, 16, v185
    v_and_b32 v99, 0xffff0000, v185
    v_lshlrev_b32 v100, 16, v186
    v_and_b32 v101, 0xffff0000, v186
    v_lshlrev_b32 v102, 16, v187
    v_and_b32 v103, 0xffff0000, v187
    v_lshlrev_b32 v104, 16, v188
    v_and_b32 v105, 0xffff0000, v188
    v_lshlrev_b32 v106, 16, v189
    v_and_b32 v107, 0xffff0000, v189
    v_lshlrev_b32 v108, 16, v190
    v_and_b32 v109, 0xffff0000, v190
    v_lshlrev_b32 v110, 16, v191
    v_and_b32 v111, 0xffff0000, v191
    v_pk_add_f32 v[16:17], v[16:17], v[80:81]
    v_pk_add_f32 v[18:19], v[18:19], v[82:83]
    v_pk_add_f32 v[20:21], v[20:21], v[84:85]
    v_pk_add_f32 v[22:23], v[22:23], v[86:87]
    v_pk_add_f32 v[24:25], v[24:25], v[88:89]
    v_pk_add_f32 v[26:27], v[26:27], v[90:91]
    v_pk_add_f32 v[28:29], v[28:29], v[92:93]
    v_pk_add_f32 v[30:31], v[30:31], v[94:95]
    v_pk_add_f32 v[32:33], v[32:33], v[96:97]
    v_pk_add_f32 v[34:35], v[34:35], v[98:99]
    v_pk_add_f32 v[36:37], v[36:37], v[100:101]
    v_pk_add_f32 v[38:39], v[38:39], v[102:103]
    v_pk_add_f32 v[40:41], v[40:41], v[104:105]
    v_pk_add_f32 v[42:43], v[42:43], v[106:107]
    v_pk_add_f32 v[44:45], v[44:45], v[108:109]
    v_pk_add_f32 v[46:47], v[46:47], v[110:111]
    v_cvt_pk_bf16_f32 v16, v16, v17
    v_cvt_pk_bf16_f32 v17, v18, v19
    v_cvt_pk_bf16_f32 v18, v20, v21
    v_cvt_pk_bf16_f32 v19, v22, v23
    v_cvt_pk_bf16_f32 v20, v24, v25
    v_cvt_pk_bf16_f32 v21, v26, v27
    v_cvt_pk_bf16_f32 v22, v28, v29
    v_cvt_pk_bf16_f32 v23, v30, v31
    s_nop 1
    v_permlane16_swap_b32 v16, v18
    v_permlane16_swap_b32 v17, v19
    v_permlane16_swap_b32 v20, v22
    v_permlane16_swap_b32 v21, v23
    buffer_store_dwordx4 v[16:19], v6, s[20:23], s40 offen offset:0 sc1
    buffer_store_dwordx4 v[20:23], v6, s[20:23], s40 offen offset:64 sc1
    v_cvt_pk_bf16_f32 v32, v32, v33
    v_cvt_pk_bf16_f32 v33, v34, v35
    v_cvt_pk_bf16_f32 v34, v36, v37
    v_cvt_pk_bf16_f32 v35, v38, v39
    v_cvt_pk_bf16_f32 v36, v40, v41
    v_cvt_pk_bf16_f32 v37, v42, v43
    v_cvt_pk_bf16_f32 v38, v44, v45
    v_cvt_pk_bf16_f32 v39, v46, v47
    s_nop 1
    v_permlane16_swap_b32 v32, v34
    v_permlane16_swap_b32 v33, v35
    v_permlane16_swap_b32 v36, v38
    v_permlane16_swap_b32 v37, v39
    buffer_store_dwordx4 v[32:35], v6, s[20:23], s41 offen offset:0 sc1
    buffer_store_dwordx4 v[36:39], v6, s[20:23], s41 offen offset:64 sc1
    s_endpgm
text_end:
.section .rodata,"a"
.p2align 6
.amdhsa_kernel qkv_kernel
  .amdhsa_next_free_vgpr 256
  .amdhsa_next_free_sgpr 102
  .amdhsa_accum_offset 256
  .amdhsa_group_segment_fixed_size 0
  .amdhsa_float_denorm_mode_32 3
  .amdhsa_kernarg_size 88
  .amdhsa_user_sgpr_count 2
  .amdhsa_user_sgpr_kernarg_segment_ptr 1
  .amdhsa_system_sgpr_workgroup_id_x 1
.end_amdhsa_kernel
.p2align 6
.amdhsa_kernel attn_kernel
  .amdhsa_next_free_vgpr 256
  .amdhsa_next_free_sgpr 102
  .amdhsa_accum_offset 256
  .amdhsa_group_segment_fixed_size 0
  .amdhsa_float_denorm_mode_32 3
  .amdhsa_kernarg_size 88
  .amdhsa_user_sgpr_count 2
  .amdhsa_user_sgpr_kernarg_segment_ptr 1
  .amdhsa_system_sgpr_workgroup_id_x 1
.end_amdhsa_kernel
```
